```python
import torch

def _softmax(x, axis=-1):
    return torch.softmax(x, dim=axis)
def _gelu(x):
    return torch.nn.functional.gelu(x, approximate="tanh")
def _silu(x):
    return torch.nn.functional.silu(x)
def _sigmoid(x):
    return torch.sigmoid(x)
def _layernorm(x, axis=-1, eps=1e-5):
    m = x.mean(dim=axis, keepdim=True)
    v = x.var(dim=axis, keepdim=True, unbiased=False)
    return (x - m) / torch.sqrt(v + eps)
def _scatter_add(tgt, idx, src, axis=0):
    return tgt.clone().index_add_(axis, idx, src)
def _segment_sum(src, seg, n):
    out = torch.zeros((n,) + src.shape[1:], dtype=src.dtype)
    return out.index_add_(0, seg, src)
def _pad(x, pw):
    flat = tuple(v for pair in reversed(pw) for v in pair)
    return torch.nn.functional.pad(x, flat)

kernel_name = 'sequential_preLN__ssm_conv_s4__geglu_ffn__prompt'

def setup_inputs():

    _w = (lambda a: (lambda t: t.to(torch.bfloat16) if t.is_floating_point() else t)(torch.as_tensor(a)))
    def _A_setup():
        B, L, D, N = 1, 2048, 640, 128
        A_re = -(lambda _x: torch.exp(torch.as_tensor(_x)))((lambda *s: torch.randn(*s, dtype=torch.bfloat16) * 6.4)(D, N))
        A_im = torch.pi * (lambda *s: torch.randn(*s, dtype=torch.bfloat16) * 0.05)(D, N)
        B_re = (lambda *s: torch.randn(*s, dtype=torch.bfloat16) * 0.05)(D, N)
        B_im = (lambda *s: torch.randn(*s, dtype=torch.bfloat16) * 0.05)(D, N)
        C_re = (lambda *s: torch.randn(*s, dtype=torch.bfloat16) * 0.05)(D, N)
        C_im = (lambda *s: torch.randn(*s, dtype=torch.bfloat16) * 0.05)(D, N)
        log_dt = (lambda *s: torch.randn(*s, dtype=torch.bfloat16) * 0.05)(D) * 0.5 - 4.0
        Dskip = (lambda *s: torch.randn(*s, dtype=torch.bfloat16) * 0.05)(D)
        return {
            "u": _w((lambda *s: torch.randn(*s, dtype=torch.bfloat16) * 0.05)(B, L, D)),
            "A_re": _w(A_re),
            "A_im": _w(A_im),
            "B_re": _w(B_re),
            "B_im": _w(B_im),
            "C_re": _w(C_re),
            "C_im": _w(C_im),
            "log_dt": _w(log_dt),
            "Dskip": _w(Dskip),
        }
    _A_in = _A_setup()

    def _B_setup():
        B, S, D, F = 1, 2048, 640, 1728
        return {
            "x": _w((lambda *s: torch.randn(*s, dtype=torch.bfloat16) * 0.05)(B, S, D)),
            "w_gate": _w((lambda *s: torch.randn(*s, dtype=torch.bfloat16) * 0.05)(D, F)),
            "w_up": _w((lambda *s: torch.randn(*s, dtype=torch.bfloat16) * 0.05)(D, F)),
            "w_down": _w((lambda *s: torch.randn(*s, dtype=torch.bfloat16) * 0.05)(F, D)),
        }
    _B_in = _B_setup()

    return {
        "A_u": _A_in["u"],
        "A_A_re": _A_in["A_re"],
        "A_A_im": _A_in["A_im"],
        "A_B_re": _A_in["B_re"],
        "A_B_im": _A_in["B_im"],
        "A_C_re": _A_in["C_re"],
        "A_C_im": _A_in["C_im"],
        "A_log_dt": _A_in["log_dt"],
        "A_Dskip": _A_in["Dskip"],
        "B_x": _B_in["x"],
        "B_w_gate": _B_in["w_gate"],
        "B_w_up": _B_in["w_up"],
        "B_w_down": _B_in["w_down"],
    }

def reference(A_u, A_A_re, A_A_im, A_B_re, A_B_im, A_C_re, A_C_im, A_log_dt, A_Dskip, B_x, B_w_gate, B_w_up, B_w_down):
    def _A_ref(u, A_re, A_im, B_re, B_im, C_re, C_im, log_dt, Dskip):
        Bsz, L, D = u.shape
        dt = torch.exp(log_dt)[:, None]
        A = A_re + 1j * A_im
        Bc = B_re + 1j * B_im
        Cc = C_re + 1j * C_im
        logdA = dt * A
        dB = dt * Bc
        l = (lambda x, dt: x.to(dt))(torch.arange(L), A_re.dtype)
        P = torch.exp(logdA[:, :, None] * l[None, None, :])
        K = torch.einsum("dn,dnl,dn->dl", Cc, P, dB).real
        L2 = 2 * L
        Kp = _pad(K, ((0, 0), (0, L)))
        up = (lambda x, *d: x.permute(*d))(u, 0, 2, 1)
        up = _pad(up, ((0, 0), (0, 0), (0, L)))
        Kf = (lambda x, axes=(-2,-1): torch.fft.rfft2(x.float(), dim=axes))(Kp[:, None, :], axes=(-2, -1))
        Uf = (lambda x, axes=(-2,-1): torch.fft.rfft2(x.float(), dim=axes))(up[:, :, None, :], axes=(-2, -1))
        Yf = Uf * Kf[None, :, :, :]
        y = (lambda x, s, axes=(-2,-1): torch.fft.irfft2(x, s=s, dim=axes).to(torch.bfloat16))(Yf, (1, L2), axes=(-2, -1))[:, :, 0, :L]
        y = (lambda x, *d: x.permute(*d))(y, 0, 2, 1) + u * Dskip[None, None, :]
        return y

    def _B_ref(x, w_gate, w_up, w_down):
        return (_gelu(x @ w_gate) * (x @ w_up)) @ w_down

    x = A_u
    h = x + _A_ref(_layernorm(x, axis=-1), A_A_re, A_A_im, A_B_re, A_B_im, A_C_re, A_C_im, A_log_dt, A_Dskip)
    h2 = h + _B_ref(_layernorm(h, axis=-1), B_w_gate, B_w_up, B_w_down)
    return h2
```

```asm
; @launch grid=(256,1,1) block=(256,1,1) lds=163840
.amdgcn_target "amdgcn-amd-amdhsa--gfx950"
.text
.globl sequential_preLN__ssm_conv_s4__geglu_ffn__prompt_kernel
.p2align 8
.type sequential_preLN__ssm_conv_s4__geglu_ffn__prompt_kernel,@function
sequential_preLN__ssm_conv_s4__geglu_ffn__prompt_kernel:
    s_cmp_ge_u32 s2, 256
    s_cbranch_scc1 END
    s_load_dwordx16 s[32:47], s[0:1], 0
    s_load_dwordx16 s[48:63], s[0:1], 64
    s_getpc_b64 s[92:93]
A_pc:
    s_lshr_b32 s88, s2, 3
    v_lshrrev_b32 v210, 6, v0
    v_lshl_add_u32 v210, s88, 2, v210
    v_and_b32 v211, 63, v0
    v_mul_u32_u24 v210, 8, v210
    v_add_lshl_u32 v210, v210, v211, 7
    v_min_u32 v210, (code_end-A_pc-4)&-4, v210
    v_mov_b32 v211, s93
    v_add_co_u32 v210, vcc, s92, v210
    s_mov_b64 exec, 0xff
    s_nop 0
    v_addc_co_u32 v211, vcc, 0, v211, vcc
    global_load_dword v210, v[210:211], off
    s_mov_b64 exec, -1
    v_lshrrev_b32 v2, 6, v0
    v_and_b32 v1, 63, v0
    s_and_b32 s64, s2, 7
    s_lshr_b32 s65, s2, 3
    v_readfirstlane_b32 s28, v2
    s_lshr_b32 s77, s65, 2
    s_lshr_b32 s78, s64, 1
    s_and_b32 s84, s64, 1
    s_lshl_b32 s84, s84, 2
    s_and_b32 s88, s65, 3
    s_add_u32 s84, s84, s88
    s_mul_i32 s3, s88, 2
    s_add_u32 s3, s3, s77
    s_and_b32 s3, s3, 7
    s_lshl_b32 s80, s84, 2
    s_add_u32 s80, s80, s28
    s_lshl_b32 s87, s80, 3
    s_add_u32 s87, s87, s3
    s_lshl_b32 s87, s87, 2
    s_add_u32 s87, s87, s78
    s_lshl_b32 s87, s87, 7
    s_add_u32 s87, s87, 327680
    s_lshl_b32 s92, s64, 5
    s_add_u32 s92, s92, s65
    s_and_b32 s88, s92, 127
    s_cmp_ge_u32 s88, 78
    s_cselect_b32 s89, 78, 0
    s_cselect_b32 s90, 77, 0
    s_cselect_b32 s91, 25, 26
    s_cselect_b32 s96, 14, 12
    s_cselect_b32 s97, 36, 0
    s_cselect_b32 s95, 3, 0
    s_sub_u32 s90, s88, s90
    s_sub_u32 s88, s88, s89
    s_mul_i32 s90, s90, 2521
    s_lshr_b32 s90, s90, 16
    s_mul_i32 s91, s91, s90
    s_sub_u32 s88, s88, s91
    s_add_u32 s95, s95, s90
    s_mul_i32 s90, s90, s96
    s_add_u32 s97, s97, s90
    s_lshr_b32 s89, s92, 7
    s_mul_i32 s90, s89, 5
    s_add_u32 s95, s95, s90
    s_lshl_b32 s95, s95, 6
    s_lshl_b32 s89, s89, 6
    s_add_u32 s97, s97, s89
    s_add_u32 s89, s97, s88
    s_sub_u32 s97, s92, s97
    s_sub_u32 s97, s97, s96
    s_sub_u32 s90, s96, 1
    s_cmp_ge_u32 s88, s96
    s_cselect_b32 s31, 1, 0
    s_cselect_b32 s66, s97, s89
    s_cselect_b32 s90, s90, s88
    s_lshl_b32 s88, s88, 1
    s_add_u32 s90, s90, s88
    s_add_u32 s90, s90, s95
    v_lshrrev_b32 v3, 6, v0
    v_bfe_u32 v4, v0, 5, 1
    v_lshl_add_u32 v3, v3, 5, v4
    v_and_b32 v4, 31, v0
    v_mul_u32_u24 v5, 1280, v3
    v_lshl_add_u32 v5, v4, 4, v5
    v_lshlrev_b32 v6, 3, v4
    v_sub_u32 v6, v5, v6
    s_lshr_b32 s89, s2, 4
    s_mul_i32 s89, s89, 48
    s_add_u32 s89, s89, s2
    s_mul_i32 s89, s89, 2560
    s_lshl_b32 s91, s90, 8
    v_and_b32 v7, 127, v0
    v_lshl_add_u32 v7, v7, 1, s91
    s_lshl_b32 s91, s90, 1
    s_and_b32 s91, s91, -4
    s_and_b32 s67, s90, 1
    s_lshl_b32 s67, s67, 4
    v_mov_b32 v196, 0
    v_mov_b32 v192, -1
    v_mov_b32 v193, -1
    v_mov_b32 v194, -1
    v_mov_b32 v195, -1
    s_waitcnt lgkmcnt(0)
    s_mov_b32 s4, s62
    s_mov_b32 s5, s63
    s_mov_b32 s6, 67108864
    s_mov_b32 s7, 0x00020000
    s_mov_b32 s8, s32
    s_mov_b32 s9, s33
    s_mov_b32 s10, 2621440
    s_mov_b32 s11, 0x00020000
    buffer_load_dword v196, v196, s[4:7], 0 offen sc1
    buffer_load_dwordx4 v[8:11], v5, s[8:11], s89 offen
    buffer_load_dwordx4 v[12:15], v5, s[8:11], s89 offen offset:512
    buffer_load_dwordx2 v[16:17], v6, s[8:11], s89 offen offset:1024
    s_load_dwordx2 s[98:99], s[46:47], s91
    s_load_dwordx2 s[74:75], s[48:49], s91
    global_load_short_d16_hi v20, v7, s[34:35] offset:0 nt
    global_load_short_d16_hi v21, v7, s[36:37] offset:0 nt
    global_load_short_d16_hi v28, v7, s[34:35] offset:256 nt
    global_load_short_d16_hi v29, v7, s[36:37] offset:256 nt
    global_load_short_d16_hi v36, v7, s[34:35] offset:512 nt
    global_load_short_d16_hi v37, v7, s[36:37] offset:512 nt
    s_cmp_lt_u32 s28, 2
    s_cbranch_scc1 A_p1
    global_load_short_d16_hi v22, v7, s[38:39] offset:0 nt
    global_load_short_d16_hi v23, v7, s[40:41] offset:0 nt
    global_load_short_d16_hi v24, v7, s[42:43] offset:0 nt
    global_load_short_d16_hi v25, v7, s[44:45] offset:0 nt
    global_load_short_d16_hi v30, v7, s[38:39] offset:256 nt
    global_load_short_d16_hi v31, v7, s[40:41] offset:256 nt
    global_load_short_d16_hi v32, v7, s[42:43] offset:256 nt
    global_load_short_d16_hi v33, v7, s[44:45] offset:256 nt
    global_load_short_d16_hi v38, v7, s[38:39] offset:512 nt
    global_load_short_d16_hi v39, v7, s[40:41] offset:512 nt
    global_load_short_d16_hi v40, v7, s[42:43] offset:512 nt
    global_load_short_d16_hi v41, v7, s[44:45] offset:512 nt
A_p1:
    v_lshrrev_b32 v2, 3, v0
    s_mov_b32 s89, 81920
    v_mul_lo_u32 v2, v2, s89
    v_and_b32 v4, 7, v0
    s_and_b32 s88, s65, 6
    v_xor_b32 v5, s88, v4
    v_lshl_add_u32 v254, v5, 4, v2
    s_and_b32 s89, s66, 6
    s_cmp_eq_u32 s31, 1
    s_cselect_b32 s88, s88, s89
    v_xor_b32 v5, s88, v4
    v_lshl_add_u32 v253, v5, 4, v2
    s_lshl_b32 s88, s64, 5
    s_add_u32 s88, s88, s65
    s_lshl_b32 s88, s88, 7
    s_add_u32 s68, s88, 1048576
    s_add_u32 s88, s68, 32768
    s_lshl_b32 s89, s66, 7
    s_add_u32 s89, s89, 1114112
    s_cmp_eq_u32 s31, 1
    s_cselect_b32 s69, s68, s88
    s_cselect_b32 s70, s88, s89
    buffer_store_dwordx4 v[192:195], v254, s[4:7], s68 offen sc1
    buffer_store_dwordx4 v[192:195], v254, s[4:7], s69 offen sc1
    buffer_store_dwordx4 v[192:195], v253, s[4:7], s70 offen sc1
    s_and_b32 s88, s64, 3
    s_mul_i32 s89, s88, 14
    s_cmp_eq_u32 s88, 3
    s_cselect_b32 s88, 4, 0
    s_add_u32 s89, s89, s88
    s_and_b32 s88, s64, 4
    s_lshl_b32 s88, s88, 4
    s_add_u32 s89, s89, s88
    s_sub_u32 s61, s66, s89
    s_lshl_b32 s88, s61, 6
    s_mul_i32 s89, s78, 864
    s_and_b32 s89, s89, -64
    s_add_u32 s60, s88, s89
    s_and_b32 s88, s64, 1
    s_cmp_lt_u32 s61, 14
    s_cselect_b32 s61, s88, 2
    s_mul_i32 s88, s61, 3456
    s_add_u32 s88, s88, s60
    s_lshl_b32 s88, s88, 1
    s_add_u32 s88, s88, 262144
    s_cmp_lt_u32 s61, 2
    s_cselect_b32 s89, s31, 0
    s_cmp_eq_u32 s28, 0
    s_cselect_b32 s89, s89, 0
    s_cmp_eq_u32 s89, 1
    s_cselect_b32 s88, s88, s87
    v_mov_b32 v2, s87
    v_mov_b32 v4, s88
    v_cmp_gt_u32 vcc, 8, v1
    s_nop 1
    v_cndmask_b32 v2, v4, v2, vcc
    v_and_b32 v4, 7, v1
    v_lshl_add_u32 v2, v4, 4, v2
    s_mov_b64 exec, 0xffff
    buffer_store_dwordx4 v[192:195], v2, s[4:7], 0 offen sc1
    s_mov_b64 exec, -1
    s_mov_b32 s12, s52
    s_mov_b32 s13, s53
    s_mov_b32 s14, 2211840
    s_mov_b32 s15, 0x00020000
    s_sub_u32 s16, s54, 3712
    s_subb_u32 s17, s55, 0
    s_mov_b32 s18, 2215552
    s_mov_b32 s19, 0x00020000
    s_mov_b32 s82, s58
    s_mov_b32 s83, s59
    s_mov_b32 s20, s56
    s_mov_b32 s21, s57
    s_mov_b32 s22, 2211840
    s_mov_b32 s23, 0x00020000
    s_lshl_b32 s88, s78, 3
    s_add_u32 s88, s88, s77
    s_and_b32 s86, s88, 3
    s_mul_i32 s79, s88, 27
    s_lshr_b32 s79, s79, 2
    s_lshr_b32 s88, s88, 2
    s_and_b32 s85, s88, 1
    s_lshl_b32 s85, s85, 2
    s_lshr_b32 s88, s88, 1
    s_add_u32 s85, s85, s88
    s_lshl_b32 s85, s85, 3
    s_add_u32 s85, s85, s84
    s_mul_i32 s85, s85, 16640
    s_lshl_b32 s88, s28, 4
    s_add_u32 s88, s88, s86
    s_lshl_b32 s88, s88, 8
    s_add_u32 s85, s85, s88
    s_add_u32 s85, s85, 16777216
    s_mul_i32 s89, s80, 81920
    s_add_u32 s89, s89, 1048576
    s_add_u32 s88, s3, 0
    s_and_b32 s88, s88, 7
    s_lshl_b32 s88, s88, 12
    s_add_u32 s44, s88, s89
    s_add_u32 s88, s3, 1
    s_and_b32 s88, s88, 7
    s_lshl_b32 s88, s88, 12
    s_add_u32 s45, s88, s89
    s_add_u32 s88, s3, 2
    s_and_b32 s88, s88, 7
    s_lshl_b32 s88, s88, 12
    s_add_u32 s46, s88, s89
    s_add_u32 s88, s3, 3
    s_and_b32 s88, s88, 7
    s_lshl_b32 s88, s88, 12
    s_add_u32 s47, s88, s89
    s_add_u32 s88, s3, 4
    s_and_b32 s88, s88, 7
    s_lshl_b32 s88, s88, 12
    s_add_u32 s48, s88, s89
    s_add_u32 s88, s3, 5
    s_and_b32 s88, s88, 7
    s_lshl_b32 s88, s88, 12
    s_add_u32 s49, s88, s89
    s_add_u32 s88, s3, 6
    s_and_b32 s88, s88, 7
    s_lshl_b32 s88, s88, 12
    s_add_u32 s50, s88, s89
    s_add_u32 s88, s3, 7
    s_and_b32 s88, s88, 7
    s_lshl_b32 s88, s88, 12
    s_add_u32 s51, s88, s89
    s_lshr_b32 s90, s3, 1
    s_add_u32 s88, s90, 0
    s_and_b32 s88, s88, 3
    s_lshl_b32 s88, s88, 12
    s_add_u32 s52, s88, s89
    s_add_u32 s88, s90, 1
    s_and_b32 s88, s88, 3
    s_lshl_b32 s88, s88, 12
    s_add_u32 s53, s88, s89
    s_add_u32 s88, s90, 2
    s_and_b32 s88, s88, 3
    s_lshl_b32 s88, s88, 12
    s_add_u32 s54, s88, s89
    s_add_u32 s88, s90, 3
    s_and_b32 s88, s88, 3
    s_lshl_b32 s88, s88, 12
    s_add_u32 s55, s88, s89
    v_lshlrev_b32 v252, 4, v1
    s_mul_i32 s88, s28, 56
    v_add_u32 v2, s88, v1
    v_mul_u32_u24 v4, 9363, v2
    v_lshrrev_b32 v4, 16, v4
    v_mul_u32_u24 v5, 7, v4
    v_sub_u32 v5, v2, v5
    v_min_u32 v4, 31, v4
    v_and_b32 v6, 1, v4
    v_lshlrev_b32 v6, 3, v6
    v_bfe_u32 v7, v4, 1, 3
    v_and_b32 v4, 16, v4
    v_or3_b32 v4, v4, v6, v7
    s_lshl_b32 s88, s79, 4
    v_lshl_add_u32 v251, v5, 4, s88
    s_lshl_b32 s88, s3, 7
    s_add_u32 s88, s88, 141024
    v_lshl_add_u32 v250, v4, 2, s88
    s_movk_i32 s32, 3456
    v_and_b32 v2, 127, v0
    v_cmp_le_u32 vcc, 78, v2
    v_mov_b32 v4, 2521
    v_mov_b32 v5, 2622
    v_cndmask_b32 v4, v4, v5, vcc
    v_subrev_u32 v5, 78, v2
    v_cndmask_b32 v2, v2, v5, vcc
    v_mul_u32_u24 v4, v4, v2
    v_lshrrev_b32 v4, 16, v4
    v_cndmask_b32 v5, 26, 25, vcc
    v_mul_u32_u24 v5, v5, v4
    v_sub_u32 v2, v2, v5
    v_cndmask_b32 v5, 12, 14, vcc
    v_cndmask_b32 v6, 0, 36, vcc
    v_mad_u32_u24 v6, v5, v4, v6
    v_cndmask_b32 v7, 0, 3, vcc
    v_add_u32 v4, v4, v7
    v_lshrrev_b32 v7, 7, v0
    v_mad_u32_u24 v4, v7, 5, v4
    v_lshl_add_u32 v6, v7, 6, v6
    v_add_u32 v6, v6, v2
    v_cmp_ge_u32 vcc, v2, v5
    s_nop 1
    v_cndmask_b32 v5, v2, v5, vcc
    v_lshl_add_u32 v5, v2, 1, v5
    v_lshl_add_u32 v4, v4, 6, v5
    v_lshlrev_b32 v7, 2, v4
    v_cndmask_b32 v5, 0, 4, vcc
    v_sub_u32 v5, v7, v5
    v_and_b32 v2, 60, v1
    ds_bpermute_b32 v186, v2, v5
    ds_bpermute_b32 v187, v2, v5 offset:64
    ds_bpermute_b32 v188, v2, v5 offset:128
    ds_bpermute_b32 v189, v2, v5 offset:192
    v_add_u32 v7, 147168, v7
    v_and_b32 v2, 6, v0
    v_lshlrev_b32 v2, 4, v2
    v_lshl_add_u32 v2, v0, 7, v2
    v_add_u32 v5, 32768, v2
    ds_write2_b32 v7, v2, v5 offset1:1
    v_and_b32 v2, 6, v6
    v_lshlrev_b32 v2, 4, v2
    v_lshl_add_u32 v2, v6, 7, v2
    v_add_u32 v2, 65536, v2
    v_mov_b32 v5, 149728
    v_cndmask_b32 v7, v7, v5, vcc
    ds_write_b32 v7, v2 offset:8
    v_mul_u32_u24 v4, 3456, v4
    v_lshlrev_b32 v5, 2, v0
    v_add_u32 v5, 141024, v5
    ds_write2st64_b32 v5, v4, v4 offset1:4
    v_add_u32 v4, 6912, v4
    v_lshlrev_b32 v6, 2, v6
    v_add_u32 v6, 143072, v6
    v_add_u32 v5, 4096, v5
    v_cndmask_b32 v6, v6, v5, vcc
    ds_write2st64_b32 v6, v4, v4 offset1:2
    v_lshrrev_b32 v4, 5, v1
    v_bfe_u32 v5, v1, 4, 1
    v_and_b32 v6, 15, v1
    v_lshlrev_b32 v6, 4, v6
    v_lshl_add_u32 v7, v5, 10, v6
    v_mul_u32_u24 v248, 1064960, v4
    v_add_u32 v248, v248, v7
    v_lshl_add_u32 v4, v5, 1, v4
    v_xor_b32 v4, s78, v4
    v_lshl_add_u32 v249, v4, 10, v6
    v_subrev_u32 v2, 104, v0
    v_and_b32 v2, 63, v2
    v_bfe_u32 v4, v2, 3, 2
    v_mul_u32_u24 v4, 1088, v4
    v_lshrrev_b32 v5, 5, v2
    v_lshl_add_u32 v6, v5, 1, 5
    v_mul_u32_u24 v5, 4368, v5
    v_and_b32 v2, 7, v2
    v_min_u32 v2, v2, v6
    v_lshl_add_u32 v2, v2, 2, v4
    v_add3_u32 v2, v2, v5, 0
    v_lshlrev_b32 v4, 2, v0
    v_add_u32 v4, 8704, v4
    v_cmp_gt_u32 vcc, 104, v0
    s_nop 1
    v_cndmask_b32 v2, v2, v4, vcc
    v_add_u32 v178, 101376, v2
    v_mov_b32 v4, 0
    v_and_b32 v5, 7, v0
    v_lshlrev_b32 v5, 2, v5
    v_add_u32 v5, 162752, v5
    ds_write_b32 v5, v4
    v_and_b32 v2, 3, v0
    v_mul_u32_u24 v4, 2624, v2
    v_add_u32 v4, 101376, v4
    v_lshrrev_b32 v5, 6, v0
    v_bfe_u32 v6, v0, 2, 4
    v_lshl_add_u32 v5, v5, 6, v6
    v_mul_u32_u24 v5, 16640, v5
    v_lshl_add_u32 v190, v2, 4, v5
    v_and_b32 v5, 31, v0
    v_bfe_u32 v6, v0, 5, 1
    v_lshl_add_u32 v5, v5, 1, v6
    s_mul_i32 s88, s28, 2624
    s_add_u32 s88, s88, 101376
    v_lshl_add_u32 v62, v5, 4, s88
    v_lshl_add_u32 v63, v5, 3, s88
    s_lshl_b32 s88, s64, 5
    s_add_u32 s88, s88, s65
    s_mul_i32 s88, s88, 16640
    s_add_u32 s81, s88, 16777216
    v_mov_b32 v60, v4
    s_mov_b32 s30, 20000
    s_lshl_b32 s88, s28, 12
    v_add_u32 v197, s88, v252
    s_lshr_b32 s88, s2, 2
    s_mul_i32 s89, s88, 37
    s_lshr_b32 s89, s89, 8
    s_mul_i32 s90, s89, 7
    s_sub_u32 s88, s88, s90
    s_lshl_b32 s90, s88, 1
    s_and_b32 s91, s89, 1
    s_add_u32 s90, s90, s91
    s_lshr_b32 s91, s89, 1
    s_mul_i32 s91, s91, 14
    s_add_u32 s90, s90, s91
    s_and_b32 s92, s2, 3
    s_mul_i32 s91, s92, 112
    s_add_u32 s90, s90, s91
    s_mul_i32 s90, s90, 5120
    s_add_u32 s90, s90, 12582912
    s_lshl_b32 s91, s28, 11
    s_add_u32 s62, s90, s91
    s_cmp_ge_u32 s28, 2
    s_cselect_b32 s91, 282624, 0
    s_add_u32 s62, s62, s91
    s_add_u32 s63, s62, 1024
    s_mul_i32 s91, s28, 286720
    s_add_u32 s90, s90, s91
    s_add_u32 s35, s90, 4096
    s_mul_i32 s89, s89, 216
    s_lshr_b32 s90, s88, 1
    s_lshl_b32 s90, s90, 4
    s_add_u32 s89, s89, s90
    s_and_b32 s90, s88, 1
    s_lshl_b32 s90, s90, 2
    s_add_u32 s89, s89, s90
    s_mul_i32 s89, s89, 1280
    s_mul_i32 s92, s92, 320
    s_add_u32 s89, s89, s92
    s_lshr_b32 s90, s28, 1
    s_add_u32 s90, s90, s28
    s_lshl_b32 s90, s90, 6
    s_add_u32 s89, s89, s90
    s_cmp_ge_u32 s2, 224
    s_cselect_b32 s89, 0x10000000, s89
    s_cmp_eq_u32 s88, 6
    s_cselect_b32 s88, 2, 3
    v_lshrrev_b32 v4, 5, v1
    v_bfe_u32 v5, v1, 3, 1
    v_lshl_add_u32 v4, v4, 1, v5
    v_mul_u32_u24 v4, 27, v4
    v_lshrrev_b32 v4, 2, v4
    v_bfe_u32 v5, v1, 4, 1
    v_lshlrev_b32 v5, s88, v5
    v_lshl_add_u32 v4, v4, 3, v5
    v_bfe_u32 v5, v1, 1, 2
    v_add_u32 v4, v4, v5
    v_mul_u32_u24 v4, 1280, v4
    v_and_b32 v5, 1, v1
    v_lshl_add_u32 v4, v5, 4, v4
    s_lshl_b32 s90, s28, 5
    s_sub_u32 s90, 128, s90
    s_cmp_ge_u32 s28, 2
    s_cselect_b32 s88, 0x10000000, s90
    v_add_u32 v176, s89, v4
    v_add_u32 v177, s88, v176
    v_bfe_u32 v2, v1, 4, 1
    v_lshrrev_b32 v3, 5, v1
    v_bfe_u32 v4, v1, 2, 1
    v_bfe_u32 v5, v1, 3, 1
    v_and_b32 v6, 3, v1
    v_lshl_add_u32 v232, v5, 1, v2
    v_lshl_add_u32 v5, v232, 1, v4
    v_lshl_add_u32 v7, v3, 3, v5
    v_lshlrev_b32 v7, 7, v7
    v_lshl_add_u32 v7, v6, 3, v7
    s_lshl_b32 s88, s28, 12
    s_add_u32 s88, s88, 88960
    v_add_u32 v7, s88, v7
    v_xor_b32 v232, s78, v232
    v_lshl_add_u32 v224, v232, 5, v7
    v_xor_b32 v225, 32, v224
    v_xor_b32 v226, 64, v224
    v_xor_b32 v227, 0x60, v224
    v_lshl_add_u32 v4, v5, 1, v3
    v_mul_u32_u24 v4, 112, v4
    v_and_b32 v7, 1, v6
    v_lshrrev_b32 v6, 1, v6
    v_lshl_add_u32 v5, v7, 4, v4
    v_lshl_add_u32 v228, v6, 3, v5
    v_add_u32 v229, 59392, v228
    v_mul_u32_u24 v6, 3712, v6
    v_lshl_add_u32 v4, v7, 3, v4
    v_add_u32 v4, v4, v6
    v_add_u32 v230, 96, v4
    v_add_u32 v231, 59488, v4
    v_bfe_u32 v4, v1, 3, 2
    v_lshlrev_b32 v4, 2, v4
    v_lshl_add_u32 v4, v1, 4, v4
    v_add_u32 v232, s88, v4
    v_mov_b32 v4, 0x3f803f80
    v_accvgpr_write_b32 a252, v4
    v_accvgpr_write_b32 a253, v4
    v_accvgpr_write_b32 a254, v4
    v_accvgpr_write_b32 a255, v4
    s_mov_b32 s36, 0x22222222
    s_mov_b32 s37, 0x22222222
    s_mov_b32 s38, 0x44444444
    s_mov_b32 s39, 0x44444444
    s_mov_b32 s40, 0x88888888
    s_mov_b32 s41, 0x88888888
    s_mov_b32 s42, 0x00f0000f
    s_mov_b32 s43, 0xf0000f00
    s_lshl_b32 s56, s80, 12
    s_add_u32 s56, s56, 327680
    s_lshl_b32 s57, s79, 5
    s_add_u32 s57, s57, 262144
    s_add_u32 s58, s57, 6912
    s_bitcmp0_b32 s3, 0
    s_cselect_b32 s59, 1.0, 0
    s_mov_b32 s88, 0x3f803f80
    s_mov_b32 s90, 0x05040100
    s_mov_b32 s91, 0x07060302
    s_cmp_lt_u32 s28, 2
    s_waitcnt vmcnt(24)
    s_cbranch_scc0 XW_1
    s_waitcnt vmcnt(12)
XW_1:
    v_dot2_f32_bf16 v44, v8, s88, 0
    v_dot2_f32_bf16 v45, v8, v8, 0
    v_dot2_f32_bf16 v46, v9, s88, 0
    v_dot2_f32_bf16 v47, v9, v9, 0
    v_dot2_f32_bf16 v44, v10, s88, v44
    v_dot2_f32_bf16 v45, v10, v10, v45
    v_dot2_f32_bf16 v46, v11, s88, v46
    v_dot2_f32_bf16 v47, v11, v11, v47
    s_waitcnt vmcnt(23)
    s_cbranch_scc0 XW_2
    s_waitcnt vmcnt(11)
XW_2:
    v_dot2_f32_bf16 v44, v12, s88, v44
    v_dot2_f32_bf16 v45, v12, v12, v45
    v_dot2_f32_bf16 v46, v13, s88, v46
    v_dot2_f32_bf16 v47, v13, v13, v47
    v_dot2_f32_bf16 v44, v14, s88, v44
    v_dot2_f32_bf16 v45, v14, v14, v45
    v_dot2_f32_bf16 v46, v15, s88, v46
    v_dot2_f32_bf16 v47, v15, v15, v47
    s_waitcnt vmcnt(22)
    s_cbranch_scc0 XW_3
    s_waitcnt vmcnt(10)
XW_3:
    v_dot2_f32_bf16 v44, v16, s88, v44
    v_dot2_f32_bf16 v45, v16, v16, v45
    v_dot2_f32_bf16 v46, v17, s88, v46
    v_dot2_f32_bf16 v47, v17, v17, v47
    v_permlane32_swap_b32 v8, v10
    v_permlane32_swap_b32 v9, v11
    v_permlane32_swap_b32 v12, v14
    v_permlane32_swap_b32 v13, v15
    v_permlane32_swap_b32 v16, v17
    v_readfirstlane_b32 s29, v196
    v_add_f32 v44, v44, v46
    v_add_f32 v45, v45, v47
    v_perm_b32 v64, v10, v8, s90
    v_perm_b32 v65, v10, v8, s91
    v_perm_b32 v66, v11, v9, s90
    v_perm_b32 v67, v11, v9, s91
    ds_write_b128 v62, v[64:67]
    v_perm_b32 v68, v14, v12, s90
    v_perm_b32 v69, v14, v12, s91
    v_perm_b32 v70, v15, v13, s90
    v_perm_b32 v71, v15, v13, s91
    ds_write_b128 v62, v[68:71] offset:1024
    v_perm_b32 v72, v17, v16, s90
    v_perm_b32 v73, v17, v16, s91
    ds_write_b64 v63, v[72:73] offset:2048
    s_add_u32 s29, s29, 0x9E37
    s_or_b32 s29, s29, 0xffff0000
    s_lshl_b32 s89, s2, 6
    s_add_u32 s92, s89, 16777216
    v_add_f32_dpp v44, v44, v44 quad_perm:[1,0,3,2] row_mask:0xf bank_mask:0xf
    v_add_f32_dpp v45, v45, v45 quad_perm:[1,0,3,2] row_mask:0xf bank_mask:0xf
    v_mov_b32 v99, s29
    v_add_f32_dpp v44, v44, v44 quad_perm:[2,3,0,1] row_mask:0xf bank_mask:0xf
    v_add_f32_dpp v45, v45, v45 quad_perm:[2,3,0,1] row_mask:0xf bank_mask:0xf
    v_mov_b32 v103, s29
    s_waitcnt lgkmcnt(0)
    v_add_u32 v186, v186, v60
    v_add_u32 v187, v187, v60
    v_add_u32 v188, v188, v60
    v_add_u32 v189, v189, v60
    s_barrier
    ds_read2_b32 v[96:97], v186 offset1:1
    ds_read_b32 v98, v186 offset:8
    ds_read2_b32 v[100:101], v187 offset1:1
    ds_read_b32 v102, v187 offset:8
    ds_read2_b32 v[104:105], v188 offset1:1
    ds_read_b32 v106, v188 offset:8
    ds_read2_b32 v[108:109], v189 offset1:1
    ds_read_b32 v110, v189 offset:8
    v_add_f32_dpp v44, v44, v44 row_half_mirror row_mask:0xf bank_mask:0xf
    v_add_f32_dpp v45, v45, v45 row_half_mirror row_mask:0xf bank_mask:0xf
    v_mov_b32 v107, s29
    v_add_f32_dpp v44, v44, v44 row_mirror row_mask:0xf bank_mask:0xf
    v_add_f32_dpp v45, v45, v45 row_mirror row_mask:0xf bank_mask:0xf
    v_mov_b32 v111, s29
    v_mov_b32 v46, v44
    v_mov_b32 v47, v45
    s_nop 0
    v_permlane16_swap_b32 v44, v46
    v_permlane16_swap_b32 v45, v47
    v_add_f32 v44, v44, v46
    v_add_f32 v45, v45, v47
    s_waitcnt lgkmcnt(6)
    buffer_store_dwordx4 v[96:99], v190, s[4:7], s92 offen sc1
    s_add_u32 s92, s92, 266240
    s_waitcnt lgkmcnt(4)
    buffer_store_dwordx4 v[100:103], v190, s[4:7], s92 offen sc1
    s_add_u32 s92, s92, 266240
    s_waitcnt lgkmcnt(2)
    buffer_store_dwordx4 v[104:107], v190, s[4:7], s92 offen sc1
    s_add_u32 s92, s92, 266240
    s_waitcnt lgkmcnt(0)
    buffer_store_dwordx4 v[108:111], v190, s[4:7], s92 offen sc1
    v_mul_f32 v44, 0x3acccccd, v44
    v_mul_f32 v45, 0x3acccccd, v45
    v_fma_f32 v45, -v44, v44, v45
    v_max_f32 v45, 0, v45
    v_cvt_pk_bf16_f32 v46, v44, v45
    v_and_b32 v45, 0xffff0000, v46
    v_add_f32 v45, 0x3727c5ac, v45
    v_cvt_pk_bf16_f32 v45, v45, v45
    v_and_b32 v45, 0xffff0000, v45
    v_sqrt_f32 v45, v45
    v_mov_b32 v51, s29
    s_lshl_b32 s93, s28, 4
    v_cvt_pk_bf16_f32 v46, -v44, v45
    s_add_u32 s89, s89, s93
    v_and_b32 v48, 0xffff0000, v46
    v_mov_b32 v47, v46
    v_rcp_f32 v48, v48
    s_add_u32 s89, s89, 65536
    v_permlane32_swap_b32 v46, v47
    v_mov_b32 v49, v48
    v_mov_b32 v2, 0
    v_perm_b32 v50, v47, v46, s90
    v_permlane32_swap_b32 v48, v49
    s_mov_b64 exec, 1
    s_waitcnt vmcnt(4)
    buffer_store_dwordx4 v[48:51], v2, s[4:7], s89 offen sc1
    s_mov_b64 exec, -1
    s_mul_i32 s93, s28, 3072
    s_add_u32 m0, s93, 150336
    s_nop 0
    buffer_load_dwordx4 v176, s[20:23], 0 offen offset:0 lds
    s_add_u32 m0, m0, 992
    s_nop 0
    buffer_load_dwordx4 v176, s[20:23], 0 offen offset:32 lds
    s_add_u32 m0, m0, 1056
    s_nop 0
    buffer_load_dwordx4 v177, s[20:23], 0 offen offset:0 lds
    s_lshr_b64 s[92:93], s[98:99], s67
    s_lshr_b64 s[74:75], s[74:75], s67
    s_lshl_b32 s88, s92, 16
    s_and_b32 s89, s92, 0xffff0000
    s_lshl_b32 s90, s93, 16
    s_lshl_b32 s76, s75, 16
    s_and_b32 s75, s74, 0xffff0000
    s_lshl_b32 s74, s74, 16
    v_mov_b32 v2, s88
    v_writelane_b32 v2, s89, 1
    v_writelane_b32 v2, s90, 2
    v_mov_b32 v6, 0x3fb8aa3b
    v_mul_f32 v4, 0x3fb8aa3b, v2
    v_fma_f32 v5, v2, v6, -v4
    v_fmac_f32 v5, 0x32a57060, v2
    v_exp_f32 v4, v4
    v_mul_f32 v5, 0x3f317218, v5
    v_fma_f32 v4, v4, v5, v4
    v_cvt_pk_bf16_f32 v4, v4, v4
    v_and_b32 v4, 0xffff0000, v4
    s_nop 0
    v_readlane_b32 s71, v4, 0
    v_readlane_b32 s72, v4, 1
    v_readlane_b32 s73, v4, 2
    v_lshrrev_b32 v2, 5, v1
    v_and_b32 v3, 31, v1
    v_lshlrev_b32 v3, 3, v3
    v_lshl_add_u32 v2, v2, 9, v3
    s_mul_i32 s88, s28, 3072
    s_add_u32 s88, s88, 150336
    v_add_u32 v164, s88, v2
    s_cmp_ge_u32 s2, 224
    s_cselect_b32 s88, 0x10000000, 0
    v_add_u32 v165, s88, v252
    s_cmp_ge_u32 s28, 2
    s_cselect_b32 s88, 0x10000000, 0
    v_add_u32 v166, s88, v165
    v_and_b32 v2, 1, v1
    v_and_b32 v3, 2, v1
    v_mul_u32_u24 v3, 504, v3
    v_lshl_add_u32 v2, v2, 3, v3
    v_add_u32 v167, v2, v164
    s_and_b32 s88, s28, 1
    s_lshl_b32 s88, s88, 8
    s_mov_b32 m0, s88
    s_cmp_ge_u32 s28, 2
    s_cbranch_scc1 A_pa
    s_cmp_eq_u32 s31, 1
    s_cbranch_scc1 A_b1
    v_mul_f32 v20, s71, v20
    v_mul_f32 v21, s71, v21
    v_mul_f32 v20, 0x3fb8aa3b, v20
    v_mul_f32 v21, 0.15915494, v21
    v_mul_f32 v56, 0x41000000, v20
    v_mul_f32 v45, 0x41000000, v21
    v_mul_f32 v57, 0x42800000, v20
    v_mul_f32 v49, 0x42800000, v21
    v_exp_f32 v56, v56
    v_fract_f32 v45, v45
    v_exp_f32 v57, v57
    v_fract_f32 v49, v49
    v_cos_f32 v44, v45
    v_sin_f32 v45, v45
    v_cos_f32 v48, v49
    v_sin_f32 v49, v49
    v_mul_f32 v44, v44, v56
    v_mul_f32 v45, v45, v56
    v_mul_f32 v48, v48, v57
    v_mul_f32 v49, v49, v57
    v_mov_b32 v58, 0x00003f80
    ds_write_addtid_b32 v58 offset:16896
    v_pk_mul_f32 v[50:51], v[48:49], v[48:49] op_sel:[0,0] op_sel_hi:[0,1]
    v_pk_mul_f32 v[46:47], v[44:45], v[44:45] op_sel:[0,0] op_sel_hi:[0,1]
    v_pk_fma_f32 v[50:51], v[48:49], v[48:49], v[50:51] op_sel:[1,1,0] op_sel_hi:[1,0,1] neg_lo:[0,1,0]
    v_pk_fma_f32 v[46:47], v[44:45], v[44:45], v[46:47] op_sel:[1,1,0] op_sel_hi:[1,0,1] neg_lo:[0,1,0]
    v_cvt_pk_bf16_f32 v60, v44, v45
    ds_write_addtid_b32 v60 offset:17424
    v_cvt_pk_bf16_f32 v61, v48, v49
    ds_write_addtid_b32 v61 offset:21120
    v_pk_mul_f32 v[52:53], v[50:51], v[48:49] op_sel:[0,0] op_sel_hi:[0,1]
    v_pk_fma_f32 v[52:53], v[50:51], v[48:49], v[52:53] op_sel:[1,1,0] op_sel_hi:[1,0,1] neg_lo:[0,1,0]
    v_cvt_pk_bf16_f32 v62, v46, v47
    ds_write_addtid_b32 v62 offset:17952
    v_cvt_pk_bf16_f32 v63, v50, v51
    ds_write_addtid_b32 v63 offset:25344
    v_cvt_pk_bf16_f32 v60, v52, v53
    ds_write_addtid_b32 v60 offset:29568
    v_pk_mul_f32 v[64:65], v[46:47], v[44:45] op_sel:[0,0] op_sel_hi:[0,1]
    v_pk_mul_f32 v[66:67], v[48:49], v[44:45] op_sel:[0,0] op_sel_hi:[0,1]
    v_pk_mul_f32 v[68:69], v[50:51], v[44:45] op_sel:[0,0] op_sel_hi:[0,1]
    v_pk_mul_f32 v[70:71], v[52:53], v[44:45] op_sel:[0,0] op_sel_hi:[0,1]
    v_pk_fma_f32 v[64:65], v[46:47], v[44:45], v[64:65] op_sel:[1,1,0] op_sel_hi:[1,0,1] neg_lo:[0,1,0]
    v_pk_fma_f32 v[66:67], v[48:49], v[44:45], v[66:67] op_sel:[1,1,0] op_sel_hi:[1,0,1] neg_lo:[0,1,0]
    v_pk_fma_f32 v[68:69], v[50:51], v[44:45], v[68:69] op_sel:[1,1,0] op_sel_hi:[1,0,1] neg_lo:[0,1,0]
    v_pk_fma_f32 v[70:71], v[52:53], v[44:45], v[70:71] op_sel:[1,1,0] op_sel_hi:[1,0,1] neg_lo:[0,1,0]
    v_cvt_pk_bf16_f32 v61, v64, v65
    ds_write_addtid_b32 v61 offset:18480
    v_cvt_pk_bf16_f32 v62, v66, v67
    ds_write_addtid_b32 v62 offset:21648
    v_cvt_pk_bf16_f32 v63, v68, v69
    ds_write_addtid_b32 v63 offset:25872
    v_cvt_pk_bf16_f32 v60, v70, v71
    ds_write_addtid_b32 v60 offset:30096
    v_pk_mul_f32 v[46:47], v[64:65], v[44:45] op_sel:[0,0] op_sel_hi:[0,1]
    v_pk_mul_f32 v[48:49], v[66:67], v[44:45] op_sel:[0,0] op_sel_hi:[0,1]
    v_pk_mul_f32 v[50:51], v[68:69], v[44:45] op_sel:[0,0] op_sel_hi:[0,1]
    v_pk_mul_f32 v[52:53], v[70:71], v[44:45] op_sel:[0,0] op_sel_hi:[0,1]
    v_pk_fma_f32 v[46:47], v[64:65], v[44:45], v[46:47] op_sel:[1,1,0] op_sel_hi:[1,0,1] neg_lo:[0,1,0]
    v_pk_fma_f32 v[48:49], v[66:67], v[44:45], v[48:49] op_sel:[1,1,0] op_sel_hi:[1,0,1] neg_lo:[0,1,0]
    v_pk_fma_f32 v[50:51], v[68:69], v[44:45], v[50:51] op_sel:[1,1,0] op_sel_hi:[1,0,1] neg_lo:[0,1,0]
    v_pk_fma_f32 v[52:53], v[70:71], v[44:45], v[52:53] op_sel:[1,1,0] op_sel_hi:[1,0,1] neg_lo:[0,1,0]
    v_cvt_pk_bf16_f32 v61, v46, v47
    ds_write_addtid_b32 v61 offset:19008
    v_cvt_pk_bf16_f32 v62, v48, v49
    ds_write_addtid_b32 v62 offset:22176
    v_cvt_pk_bf16_f32 v63, v50, v51
    ds_write_addtid_b32 v63 offset:26400
    v_cvt_pk_bf16_f32 v60, v52, v53
    ds_write_addtid_b32 v60 offset:30624
    v_pk_mul_f32 v[64:65], v[46:47], v[44:45] op_sel:[0,0] op_sel_hi:[0,1]
    v_pk_mul_f32 v[66:67], v[48:49], v[44:45] op_sel:[0,0] op_sel_hi:[0,1]
    v_pk_mul_f32 v[68:69], v[50:51], v[44:45] op_sel:[0,0] op_sel_hi:[0,1]
    v_pk_mul_f32 v[70:71], v[52:53], v[44:45] op_sel:[0,0] op_sel_hi:[0,1]
    v_pk_fma_f32 v[64:65], v[46:47], v[44:45], v[64:65] op_sel:[1,1,0] op_sel_hi:[1,0,1] neg_lo:[0,1,0]
    v_pk_fma_f32 v[66:67], v[48:49], v[44:45], v[66:67] op_sel:[1,1,0] op_sel_hi:[1,0,1] neg_lo:[0,1,0]
    v_pk_fma_f32 v[68:69], v[50:51], v[44:45], v[68:69] op_sel:[1,1,0] op_sel_hi:[1,0,1] neg_lo:[0,1,0]
    v_pk_fma_f32 v[70:71], v[52:53], v[44:45], v[70:71] op_sel:[1,1,0] op_sel_hi:[1,0,1] neg_lo:[0,1,0]
    v_cvt_pk_bf16_f32 v61, v64, v65
    ds_write_addtid_b32 v61 offset:19536
    v_cvt_pk_bf16_f32 v62, v66, v67
    ds_write_addtid_b32 v62 offset:22704
    v_cvt_pk_bf16_f32 v63, v68, v69
    ds_write_addtid_b32 v63 offset:26928
    v_cvt_pk_bf16_f32 v60, v70, v71
    ds_write_addtid_b32 v60 offset:31152
    v_pk_mul_f32 v[46:47], v[64:65], v[44:45] op_sel:[0,0] op_sel_hi:[0,1]
    v_pk_mul_f32 v[48:49], v[66:67], v[44:45] op_sel:[0,0] op_sel_hi:[0,1]
    v_pk_mul_f32 v[50:51], v[68:69], v[44:45] op_sel:[0,0] op_sel_hi:[0,1]
    v_pk_mul_f32 v[52:53], v[70:71], v[44:45] op_sel:[0,0] op_sel_hi:[0,1]
    v_pk_fma_f32 v[46:47], v[64:65], v[44:45], v[46:47] op_sel:[1,1,0] op_sel_hi:[1,0,1] neg_lo:[0,1,0]
    v_pk_fma_f32 v[48:49], v[66:67], v[44:45], v[48:49] op_sel:[1,1,0] op_sel_hi:[1,0,1] neg_lo:[0,1,0]
    v_pk_fma_f32 v[50:51], v[68:69], v[44:45], v[50:51] op_sel:[1,1,0] op_sel_hi:[1,0,1] neg_lo:[0,1,0]
    v_pk_fma_f32 v[52:53], v[70:71], v[44:45], v[52:53] op_sel:[1,1,0] op_sel_hi:[1,0,1] neg_lo:[0,1,0]
    v_cvt_pk_bf16_f32 v61, v46, v47
    ds_write_addtid_b32 v61 offset:20064
    v_cvt_pk_bf16_f32 v62, v48, v49
    ds_write_addtid_b32 v62 offset:23232
    v_cvt_pk_bf16_f32 v63, v50, v51
    ds_write_addtid_b32 v63 offset:27456
    v_cvt_pk_bf16_f32 v60, v52, v53
    ds_write_addtid_b32 v60 offset:31680
    v_pk_mul_f32 v[64:65], v[46:47], v[44:45] op_sel:[0,0] op_sel_hi:[0,1]
    v_pk_mul_f32 v[66:67], v[48:49], v[44:45] op_sel:[0,0] op_sel_hi:[0,1]
    v_pk_mul_f32 v[68:69], v[50:51], v[44:45] op_sel:[0,0] op_sel_hi:[0,1]
    v_pk_mul_f32 v[70:71], v[52:53], v[44:45] op_sel:[0,0] op_sel_hi:[0,1]
    v_pk_fma_f32 v[64:65], v[46:47], v[44:45], v[64:65] op_sel:[1,1,0] op_sel_hi:[1,0,1] neg_lo:[0,1,0]
    v_pk_fma_f32 v[66:67], v[48:49], v[44:45], v[66:67] op_sel:[1,1,0] op_sel_hi:[1,0,1] neg_lo:[0,1,0]
    v_pk_fma_f32 v[68:69], v[50:51], v[44:45], v[68:69] op_sel:[1,1,0] op_sel_hi:[1,0,1] neg_lo:[0,1,0]
    v_pk_fma_f32 v[70:71], v[52:53], v[44:45], v[70:71] op_sel:[1,1,0] op_sel_hi:[1,0,1] neg_lo:[0,1,0]
    v_cvt_pk_bf16_f32 v61, v64, v65
    ds_write_addtid_b32 v61 offset:20592
    v_cvt_pk_bf16_f32 v62, v66, v67
    ds_write_addtid_b32 v62 offset:23760
    v_cvt_pk_bf16_f32 v63, v68, v69
    ds_write_addtid_b32 v63 offset:27984
    v_cvt_pk_bf16_f32 v60, v70, v71
    ds_write_addtid_b32 v60 offset:32208
    v_pk_mul_f32 v[48:49], v[66:67], v[44:45] op_sel:[0,0] op_sel_hi:[0,1]
    v_pk_mul_f32 v[50:51], v[68:69], v[44:45] op_sel:[0,0] op_sel_hi:[0,1]
    v_pk_mul_f32 v[52:53], v[70:71], v[44:45] op_sel:[0,0] op_sel_hi:[0,1]
    v_pk_fma_f32 v[48:49], v[66:67], v[44:45], v[48:49] op_sel:[1,1,0] op_sel_hi:[1,0,1] neg_lo:[0,1,0]
    v_pk_fma_f32 v[50:51], v[68:69], v[44:45], v[50:51] op_sel:[1,1,0] op_sel_hi:[1,0,1] neg_lo:[0,1,0]
    v_pk_fma_f32 v[52:53], v[70:71], v[44:45], v[52:53] op_sel:[1,1,0] op_sel_hi:[1,0,1] neg_lo:[0,1,0]
    v_cvt_pk_bf16_f32 v61, v48, v49
    ds_write_addtid_b32 v61 offset:24288
    v_cvt_pk_bf16_f32 v62, v50, v51
    ds_write_addtid_b32 v62 offset:28512
    v_cvt_pk_bf16_f32 v63, v52, v53
    ds_write_addtid_b32 v63 offset:32736
    v_pk_mul_f32 v[66:67], v[48:49], v[44:45] op_sel:[0,0] op_sel_hi:[0,1]
    v_pk_mul_f32 v[68:69], v[50:51], v[44:45] op_sel:[0,0] op_sel_hi:[0,1]
    v_pk_mul_f32 v[70:71], v[52:53], v[44:45] op_sel:[0,0] op_sel_hi:[0,1]
    v_pk_fma_f32 v[66:67], v[48:49], v[44:45], v[66:67] op_sel:[1,1,0] op_sel_hi:[1,0,1] neg_lo:[0,1,0]
    v_pk_fma_f32 v[68:69], v[50:51], v[44:45], v[68:69] op_sel:[1,1,0] op_sel_hi:[1,0,1] neg_lo:[0,1,0]
    v_pk_fma_f32 v[70:71], v[52:53], v[44:45], v[70:71] op_sel:[1,1,0] op_sel_hi:[1,0,1] neg_lo:[0,1,0]
    v_cvt_pk_bf16_f32 v60, v66, v67
    ds_write_addtid_b32 v60 offset:24816
    v_cvt_pk_bf16_f32 v61, v68, v69
    ds_write_addtid_b32 v61 offset:29040
    v_cvt_pk_bf16_f32 v62, v70, v71
    ds_write_addtid_b32 v62 offset:33264
A_b1:
    s_add_u32 m0, m0, 33792
    v_mul_f32 v28, s72, v28
    v_mul_f32 v29, s72, v29
    v_mul_f32 v28, 0x3fb8aa3b, v28
    v_mul_f32 v29, 0.15915494, v29
    v_mul_f32 v56, 0x41000000, v28
    v_mul_f32 v45, 0x41000000, v29
    v_mul_f32 v57, 0x42800000, v28
    v_mul_f32 v49, 0x42800000, v29
    v_exp_f32 v56, v56
    v_fract_f32 v45, v45
    v_exp_f32 v57, v57
    v_fract_f32 v49, v49
    v_cos_f32 v44, v45
    v_sin_f32 v45, v45
    v_cos_f32 v48, v49
    v_sin_f32 v49, v49
    v_mul_f32 v44, v44, v56
    v_mul_f32 v45, v45, v56
    v_mul_f32 v48, v48, v57
    v_mul_f32 v49, v49, v57
    v_mov_b32 v58, 0x00003f80
    ds_write_addtid_b32 v58 offset:16896
    v_pk_mul_f32 v[50:51], v[48:49], v[48:49] op_sel:[0,0] op_sel_hi:[0,1]
    v_pk_mul_f32 v[46:47], v[44:45], v[44:45] op_sel:[0,0] op_sel_hi:[0,1]
    v_pk_fma_f32 v[50:51], v[48:49], v[48:49], v[50:51] op_sel:[1,1,0] op_sel_hi:[1,0,1] neg_lo:[0,1,0]
    v_pk_fma_f32 v[46:47], v[44:45], v[44:45], v[46:47] op_sel:[1,1,0] op_sel_hi:[1,0,1] neg_lo:[0,1,0]
    v_cvt_pk_bf16_f32 v63, v44, v45
    ds_write_addtid_b32 v63 offset:17424
    v_cvt_pk_bf16_f32 v60, v48, v49
    ds_write_addtid_b32 v60 offset:21120
    v_pk_mul_f32 v[52:53], v[50:51], v[48:49] op_sel:[0,0] op_sel_hi:[0,1]
    v_pk_fma_f32 v[52:53], v[50:51], v[48:49], v[52:53] op_sel:[1,1,0] op_sel_hi:[1,0,1] neg_lo:[0,1,0]
    v_cvt_pk_bf16_f32 v61, v46, v47
    ds_write_addtid_b32 v61 offset:17952
    v_cvt_pk_bf16_f32 v62, v50, v51
    ds_write_addtid_b32 v62 offset:25344
    v_cvt_pk_bf16_f32 v63, v52, v53
    ds_write_addtid_b32 v63 offset:29568
    v_pk_mul_f32 v[64:65], v[46:47], v[44:45] op_sel:[0,0] op_sel_hi:[0,1]
    v_pk_mul_f32 v[66:67], v[48:49], v[44:45] op_sel:[0,0] op_sel_hi:[0,1]
    v_pk_mul_f32 v[68:69], v[50:51], v[44:45] op_sel:[0,0] op_sel_hi:[0,1]
    v_pk_mul_f32 v[70:71], v[52:53], v[44:45] op_sel:[0,0] op_sel_hi:[0,1]
    v_pk_fma_f32 v[64:65], v[46:47], v[44:45], v[64:65] op_sel:[1,1,0] op_sel_hi:[1,0,1] neg_lo:[0,1,0]
    v_pk_fma_f32 v[66:67], v[48:49], v[44:45], v[66:67] op_sel:[1,1,0] op_sel_hi:[1,0,1] neg_lo:[0,1,0]
    v_pk_fma_f32 v[68:69], v[50:51], v[44:45], v[68:69] op_sel:[1,1,0] op_sel_hi:[1,0,1] neg_lo:[0,1,0]
    v_pk_fma_f32 v[70:71], v[52:53], v[44:45], v[70:71] op_sel:[1,1,0] op_sel_hi:[1,0,1] neg_lo:[0,1,0]
    v_cvt_pk_bf16_f32 v60, v64, v65
    ds_write_addtid_b32 v60 offset:18480
    v_cvt_pk_bf16_f32 v61, v66, v67
    ds_write_addtid_b32 v61 offset:21648
    v_cvt_pk_bf16_f32 v62, v68, v69
    ds_write_addtid_b32 v62 offset:25872
    v_cvt_pk_bf16_f32 v63, v70, v71
    ds_write_addtid_b32 v63 offset:30096
    v_pk_mul_f32 v[46:47], v[64:65], v[44:45] op_sel:[0,0] op_sel_hi:[0,1]
    v_pk_mul_f32 v[48:49], v[66:67], v[44:45] op_sel:[0,0] op_sel_hi:[0,1]
    v_pk_mul_f32 v[50:51], v[68:69], v[44:45] op_sel:[0,0] op_sel_hi:[0,1]
    v_pk_mul_f32 v[52:53], v[70:71], v[44:45] op_sel:[0,0] op_sel_hi:[0,1]
    v_pk_fma_f32 v[46:47], v[64:65], v[44:45], v[46:47] op_sel:[1,1,0] op_sel_hi:[1,0,1] neg_lo:[0,1,0]
    v_pk_fma_f32 v[48:49], v[66:67], v[44:45], v[48:49] op_sel:[1,1,0] op_sel_hi:[1,0,1] neg_lo:[0,1,0]
    v_pk_fma_f32 v[50:51], v[68:69], v[44:45], v[50:51] op_sel:[1,1,0] op_sel_hi:[1,0,1] neg_lo:[0,1,0]
    v_pk_fma_f32 v[52:53], v[70:71], v[44:45], v[52:53] op_sel:[1,1,0] op_sel_hi:[1,0,1] neg_lo:[0,1,0]
    v_cvt_pk_bf16_f32 v60, v46, v47
    ds_write_addtid_b32 v60 offset:19008
    v_cvt_pk_bf16_f32 v61, v48, v49
    ds_write_addtid_b32 v61 offset:22176
    v_cvt_pk_bf16_f32 v62, v50, v51
    ds_write_addtid_b32 v62 offset:26400
    v_cvt_pk_bf16_f32 v63, v52, v53
    ds_write_addtid_b32 v63 offset:30624
    v_pk_mul_f32 v[64:65], v[46:47], v[44:45] op_sel:[0,0] op_sel_hi:[0,1]
    v_pk_mul_f32 v[66:67], v[48:49], v[44:45] op_sel:[0,0] op_sel_hi:[0,1]
    v_pk_mul_f32 v[68:69], v[50:51], v[44:45] op_sel:[0,0] op_sel_hi:[0,1]
    v_pk_mul_f32 v[70:71], v[52:53], v[44:45] op_sel:[0,0] op_sel_hi:[0,1]
    v_pk_fma_f32 v[64:65], v[46:47], v[44:45], v[64:65] op_sel:[1,1,0] op_sel_hi:[1,0,1] neg_lo:[0,1,0]
    v_pk_fma_f32 v[66:67], v[48:49], v[44:45], v[66:67] op_sel:[1,1,0] op_sel_hi:[1,0,1] neg_lo:[0,1,0]
    v_pk_fma_f32 v[68:69], v[50:51], v[44:45], v[68:69] op_sel:[1,1,0] op_sel_hi:[1,0,1] neg_lo:[0,1,0]
    v_pk_fma_f32 v[70:71], v[52:53], v[44:45], v[70:71] op_sel:[1,1,0] op_sel_hi:[1,0,1] neg_lo:[0,1,0]
    v_cvt_pk_bf16_f32 v60, v64, v65
    ds_write_addtid_b32 v60 offset:19536
    v_cvt_pk_bf16_f32 v61, v66, v67
    ds_write_addtid_b32 v61 offset:22704
    v_cvt_pk_bf16_f32 v62, v68, v69
    ds_write_addtid_b32 v62 offset:26928
    v_cvt_pk_bf16_f32 v63, v70, v71
    ds_write_addtid_b32 v63 offset:31152
    v_pk_mul_f32 v[46:47], v[64:65], v[44:45] op_sel:[0,0] op_sel_hi:[0,1]
    v_pk_mul_f32 v[48:49], v[66:67], v[44:45] op_sel:[0,0] op_sel_hi:[0,1]
    v_pk_mul_f32 v[50:51], v[68:69], v[44:45] op_sel:[0,0] op_sel_hi:[0,1]
    v_pk_mul_f32 v[52:53], v[70:71], v[44:45] op_sel:[0,0] op_sel_hi:[0,1]
    v_pk_fma_f32 v[46:47], v[64:65], v[44:45], v[46:47] op_sel:[1,1,0] op_sel_hi:[1,0,1] neg_lo:[0,1,0]
    v_pk_fma_f32 v[48:49], v[66:67], v[44:45], v[48:49] op_sel:[1,1,0] op_sel_hi:[1,0,1] neg_lo:[0,1,0]
    v_pk_fma_f32 v[50:51], v[68:69], v[44:45], v[50:51] op_sel:[1,1,0] op_sel_hi:[1,0,1] neg_lo:[0,1,0]
    v_pk_fma_f32 v[52:53], v[70:71], v[44:45], v[52:53] op_sel:[1,1,0] op_sel_hi:[1,0,1] neg_lo:[0,1,0]
    v_cvt_pk_bf16_f32 v60, v46, v47
    ds_write_addtid_b32 v60 offset:20064
    v_cvt_pk_bf16_f32 v61, v48, v49
    ds_write_addtid_b32 v61 offset:23232
    v_cvt_pk_bf16_f32 v62, v50, v51
    ds_write_addtid_b32 v62 offset:27456
    v_cvt_pk_bf16_f32 v63, v52, v53
    ds_write_addtid_b32 v63 offset:31680
    v_pk_mul_f32 v[64:65], v[46:47], v[44:45] op_sel:[0,0] op_sel_hi:[0,1]
    v_pk_mul_f32 v[66:67], v[48:49], v[44:45] op_sel:[0,0] op_sel_hi:[0,1]
    v_pk_mul_f32 v[68:69], v[50:51], v[44:45] op_sel:[0,0] op_sel_hi:[0,1]
    v_pk_mul_f32 v[70:71], v[52:53], v[44:45] op_sel:[0,0] op_sel_hi:[0,1]
    v_pk_fma_f32 v[64:65], v[46:47], v[44:45], v[64:65] op_sel:[1,1,0] op_sel_hi:[1,0,1] neg_lo:[0,1,0]
    v_pk_fma_f32 v[66:67], v[48:49], v[44:45], v[66:67] op_sel:[1,1,0] op_sel_hi:[1,0,1] neg_lo:[0,1,0]
    v_pk_fma_f32 v[68:69], v[50:51], v[44:45], v[68:69] op_sel:[1,1,0] op_sel_hi:[1,0,1] neg_lo:[0,1,0]
    v_pk_fma_f32 v[70:71], v[52:53], v[44:45], v[70:71] op_sel:[1,1,0] op_sel_hi:[1,0,1] neg_lo:[0,1,0]
    v_cvt_pk_bf16_f32 v60, v64, v65
    ds_write_addtid_b32 v60 offset:20592
    v_cvt_pk_bf16_f32 v61, v66, v67
    ds_write_addtid_b32 v61 offset:23760
    v_cvt_pk_bf16_f32 v62, v68, v69
    ds_write_addtid_b32 v62 offset:27984
    v_cvt_pk_bf16_f32 v63, v70, v71
    ds_write_addtid_b32 v63 offset:32208
    v_pk_mul_f32 v[48:49], v[66:67], v[44:45] op_sel:[0,0] op_sel_hi:[0,1]
    v_pk_mul_f32 v[50:51], v[68:69], v[44:45] op_sel:[0,0] op_sel_hi:[0,1]
    v_pk_mul_f32 v[52:53], v[70:71], v[44:45] op_sel:[0,0] op_sel_hi:[0,1]
    v_pk_fma_f32 v[48:49], v[66:67], v[44:45], v[48:49] op_sel:[1,1,0] op_sel_hi:[1,0,1] neg_lo:[0,1,0]
    v_pk_fma_f32 v[50:51], v[68:69], v[44:45], v[50:51] op_sel:[1,1,0] op_sel_hi:[1,0,1] neg_lo:[0,1,0]
    v_pk_fma_f32 v[52:53], v[70:71], v[44:45], v[52:53] op_sel:[1,1,0] op_sel_hi:[1,0,1] neg_lo:[0,1,0]
    v_cvt_pk_bf16_f32 v60, v48, v49
    ds_write_addtid_b32 v60 offset:24288
    v_cvt_pk_bf16_f32 v61, v50, v51
    ds_write_addtid_b32 v61 offset:28512
    v_cvt_pk_bf16_f32 v62, v52, v53
    ds_write_addtid_b32 v62 offset:32736
    v_pk_mul_f32 v[66:67], v[48:49], v[44:45] op_sel:[0,0] op_sel_hi:[0,1]
    v_pk_mul_f32 v[68:69], v[50:51], v[44:45] op_sel:[0,0] op_sel_hi:[0,1]
    v_pk_mul_f32 v[70:71], v[52:53], v[44:45] op_sel:[0,0] op_sel_hi:[0,1]
    v_pk_fma_f32 v[66:67], v[48:49], v[44:45], v[66:67] op_sel:[1,1,0] op_sel_hi:[1,0,1] neg_lo:[0,1,0]
    v_pk_fma_f32 v[68:69], v[50:51], v[44:45], v[68:69] op_sel:[1,1,0] op_sel_hi:[1,0,1] neg_lo:[0,1,0]
    v_pk_fma_f32 v[70:71], v[52:53], v[44:45], v[70:71] op_sel:[1,1,0] op_sel_hi:[1,0,1] neg_lo:[0,1,0]
    v_cvt_pk_bf16_f32 v63, v66, v67
    ds_write_addtid_b32 v63 offset:24816
    v_cvt_pk_bf16_f32 v60, v68, v69
    ds_write_addtid_b32 v60 offset:29040
    v_cvt_pk_bf16_f32 v61, v70, v71
    ds_write_addtid_b32 v61 offset:33264
    s_add_u32 m0, m0, 33792
    v_mul_f32 v36, s73, v36
    v_mul_f32 v37, s73, v37
    v_mul_f32 v36, 0x3fb8aa3b, v36
    v_mul_f32 v37, 0.15915494, v37
    v_mul_f32 v56, 0x41000000, v36
    v_mul_f32 v45, 0x41000000, v37
    v_mul_f32 v57, 0x42800000, v36
    v_mul_f32 v49, 0x42800000, v37
    v_exp_f32 v56, v56
    v_fract_f32 v45, v45
    v_exp_f32 v57, v57
    v_fract_f32 v49, v49
    v_cos_f32 v44, v45
    v_sin_f32 v45, v45
    v_cos_f32 v48, v49
    v_sin_f32 v49, v49
    v_mul_f32 v44, v44, v56
    v_mul_f32 v45, v45, v56
    v_mul_f32 v48, v48, v57
    v_mul_f32 v49, v49, v57
    v_mov_b32 v58, 0x00003f80
    ds_write_addtid_b32 v58 offset:16896
    v_pk_mul_f32 v[50:51], v[48:49], v[48:49] op_sel:[0,0] op_sel_hi:[0,1]
    v_pk_mul_f32 v[46:47], v[44:45], v[44:45] op_sel:[0,0] op_sel_hi:[0,1]
    v_pk_fma_f32 v[50:51], v[48:49], v[48:49], v[50:51] op_sel:[1,1,0] op_sel_hi:[1,0,1] neg_lo:[0,1,0]
    v_pk_fma_f32 v[46:47], v[44:45], v[44:45], v[46:47] op_sel:[1,1,0] op_sel_hi:[1,0,1] neg_lo:[0,1,0]
    v_cvt_pk_bf16_f32 v62, v44, v45
    ds_write_addtid_b32 v62 offset:17424
    v_cvt_pk_bf16_f32 v63, v48, v49
    ds_write_addtid_b32 v63 offset:21120
    v_pk_mul_f32 v[52:53], v[50:51], v[48:49] op_sel:[0,0] op_sel_hi:[0,1]
    v_pk_fma_f32 v[52:53], v[50:51], v[48:49], v[52:53] op_sel:[1,1,0] op_sel_hi:[1,0,1] neg_lo:[0,1,0]
    v_cvt_pk_bf16_f32 v60, v46, v47
    ds_write_addtid_b32 v60 offset:17952
    v_cvt_pk_bf16_f32 v61, v50, v51
    ds_write_addtid_b32 v61 offset:25344
    v_cvt_pk_bf16_f32 v62, v52, v53
    ds_write_addtid_b32 v62 offset:29568
    v_pk_mul_f32 v[64:65], v[46:47], v[44:45] op_sel:[0,0] op_sel_hi:[0,1]
    v_pk_mul_f32 v[66:67], v[48:49], v[44:45] op_sel:[0,0] op_sel_hi:[0,1]
    v_pk_mul_f32 v[68:69], v[50:51], v[44:45] op_sel:[0,0] op_sel_hi:[0,1]
    v_pk_mul_f32 v[70:71], v[52:53], v[44:45] op_sel:[0,0] op_sel_hi:[0,1]
    v_pk_fma_f32 v[64:65], v[46:47], v[44:45], v[64:65] op_sel:[1,1,0] op_sel_hi:[1,0,1] neg_lo:[0,1,0]
    v_pk_fma_f32 v[66:67], v[48:49], v[44:45], v[66:67] op_sel:[1,1,0] op_sel_hi:[1,0,1] neg_lo:[0,1,0]
    v_pk_fma_f32 v[68:69], v[50:51], v[44:45], v[68:69] op_sel:[1,1,0] op_sel_hi:[1,0,1] neg_lo:[0,1,0]
    v_pk_fma_f32 v[70:71], v[52:53], v[44:45], v[70:71] op_sel:[1,1,0] op_sel_hi:[1,0,1] neg_lo:[0,1,0]
    v_cvt_pk_bf16_f32 v63, v64, v65
    ds_write_addtid_b32 v63 offset:18480
    v_cvt_pk_bf16_f32 v60, v66, v67
    ds_write_addtid_b32 v60 offset:21648
    v_cvt_pk_bf16_f32 v61, v68, v69
    ds_write_addtid_b32 v61 offset:25872
    v_cvt_pk_bf16_f32 v62, v70, v71
    ds_write_addtid_b32 v62 offset:30096
    v_pk_mul_f32 v[46:47], v[64:65], v[44:45] op_sel:[0,0] op_sel_hi:[0,1]
    v_pk_mul_f32 v[48:49], v[66:67], v[44:45] op_sel:[0,0] op_sel_hi:[0,1]
    v_pk_mul_f32 v[50:51], v[68:69], v[44:45] op_sel:[0,0] op_sel_hi:[0,1]
    v_pk_mul_f32 v[52:53], v[70:71], v[44:45] op_sel:[0,0] op_sel_hi:[0,1]
    v_pk_fma_f32 v[46:47], v[64:65], v[44:45], v[46:47] op_sel:[1,1,0] op_sel_hi:[1,0,1] neg_lo:[0,1,0]
    v_pk_fma_f32 v[48:49], v[66:67], v[44:45], v[48:49] op_sel:[1,1,0] op_sel_hi:[1,0,1] neg_lo:[0,1,0]
    v_pk_fma_f32 v[50:51], v[68:69], v[44:45], v[50:51] op_sel:[1,1,0] op_sel_hi:[1,0,1] neg_lo:[0,1,0]
    v_pk_fma_f32 v[52:53], v[70:71], v[44:45], v[52:53] op_sel:[1,1,0] op_sel_hi:[1,0,1] neg_lo:[0,1,0]
    v_cvt_pk_bf16_f32 v63, v46, v47
    ds_write_addtid_b32 v63 offset:19008
    v_cvt_pk_bf16_f32 v60, v48, v49
    ds_write_addtid_b32 v60 offset:22176
    v_cvt_pk_bf16_f32 v61, v50, v51
    ds_write_addtid_b32 v61 offset:26400
    v_cvt_pk_bf16_f32 v62, v52, v53
    ds_write_addtid_b32 v62 offset:30624
    v_pk_mul_f32 v[64:65], v[46:47], v[44:45] op_sel:[0,0] op_sel_hi:[0,1]
    v_pk_mul_f32 v[66:67], v[48:49], v[44:45] op_sel:[0,0] op_sel_hi:[0,1]
    v_pk_mul_f32 v[68:69], v[50:51], v[44:45] op_sel:[0,0] op_sel_hi:[0,1]
    v_pk_mul_f32 v[70:71], v[52:53], v[44:45] op_sel:[0,0] op_sel_hi:[0,1]
    v_pk_fma_f32 v[64:65], v[46:47], v[44:45], v[64:65] op_sel:[1,1,0] op_sel_hi:[1,0,1] neg_lo:[0,1,0]
    v_pk_fma_f32 v[66:67], v[48:49], v[44:45], v[66:67] op_sel:[1,1,0] op_sel_hi:[1,0,1] neg_lo:[0,1,0]
    v_pk_fma_f32 v[68:69], v[50:51], v[44:45], v[68:69] op_sel:[1,1,0] op_sel_hi:[1,0,1] neg_lo:[0,1,0]
    v_pk_fma_f32 v[70:71], v[52:53], v[44:45], v[70:71] op_sel:[1,1,0] op_sel_hi:[1,0,1] neg_lo:[0,1,0]
    v_cvt_pk_bf16_f32 v63, v64, v65
    ds_write_addtid_b32 v63 offset:19536
    v_cvt_pk_bf16_f32 v60, v66, v67
    ds_write_addtid_b32 v60 offset:22704
    v_cvt_pk_bf16_f32 v61, v68, v69
    ds_write_addtid_b32 v61 offset:26928
    v_cvt_pk_bf16_f32 v62, v70, v71
    ds_write_addtid_b32 v62 offset:31152
    v_pk_mul_f32 v[46:47], v[64:65], v[44:45] op_sel:[0,0] op_sel_hi:[0,1]
    v_pk_mul_f32 v[48:49], v[66:67], v[44:45] op_sel:[0,0] op_sel_hi:[0,1]
    v_pk_mul_f32 v[50:51], v[68:69], v[44:45] op_sel:[0,0] op_sel_hi:[0,1]
    v_pk_mul_f32 v[52:53], v[70:71], v[44:45] op_sel:[0,0] op_sel_hi:[0,1]
    v_pk_fma_f32 v[46:47], v[64:65], v[44:45], v[46:47] op_sel:[1,1,0] op_sel_hi:[1,0,1] neg_lo:[0,1,0]
    v_pk_fma_f32 v[48:49], v[66:67], v[44:45], v[48:49] op_sel:[1,1,0] op_sel_hi:[1,0,1] neg_lo:[0,1,0]
    v_pk_fma_f32 v[50:51], v[68:69], v[44:45], v[50:51] op_sel:[1,1,0] op_sel_hi:[1,0,1] neg_lo:[0,1,0]
    v_pk_fma_f32 v[52:53], v[70:71], v[44:45], v[52:53] op_sel:[1,1,0] op_sel_hi:[1,0,1] neg_lo:[0,1,0]
    v_cvt_pk_bf16_f32 v63, v46, v47
    ds_write_addtid_b32 v63 offset:20064
    v_cvt_pk_bf16_f32 v60, v48, v49
    ds_write_addtid_b32 v60 offset:23232
    v_cvt_pk_bf16_f32 v61, v50, v51
    ds_write_addtid_b32 v61 offset:27456
    v_cvt_pk_bf16_f32 v62, v52, v53
    ds_write_addtid_b32 v62 offset:31680
    v_pk_mul_f32 v[64:65], v[46:47], v[44:45] op_sel:[0,0] op_sel_hi:[0,1]
    v_pk_mul_f32 v[66:67], v[48:49], v[44:45] op_sel:[0,0] op_sel_hi:[0,1]
    v_pk_mul_f32 v[68:69], v[50:51], v[44:45] op_sel:[0,0] op_sel_hi:[0,1]
    v_pk_mul_f32 v[70:71], v[52:53], v[44:45] op_sel:[0,0] op_sel_hi:[0,1]
    v_pk_fma_f32 v[64:65], v[46:47], v[44:45], v[64:65] op_sel:[1,1,0] op_sel_hi:[1,0,1] neg_lo:[0,1,0]
    v_pk_fma_f32 v[66:67], v[48:49], v[44:45], v[66:67] op_sel:[1,1,0] op_sel_hi:[1,0,1] neg_lo:[0,1,0]
    v_pk_fma_f32 v[68:69], v[50:51], v[44:45], v[68:69] op_sel:[1,1,0] op_sel_hi:[1,0,1] neg_lo:[0,1,0]
    v_pk_fma_f32 v[70:71], v[52:53], v[44:45], v[70:71] op_sel:[1,1,0] op_sel_hi:[1,0,1] neg_lo:[0,1,0]
    s_waitcnt vmcnt(0)
    ds_read_b64_tr_b16 v[152:153], v167 offset:0
    ds_read_b64_tr_b16 v[154:155], v167 offset:256
    ds_read_b64_tr_b16 v[156:157], v167 offset:8
    ds_read_b64_tr_b16 v[158:159], v167 offset:264
    ds_read_b64_tr_b16 v[160:161], v164 offset:2048
    ds_read_b64_tr_b16 v[162:163], v164 offset:2304
    v_cvt_pk_bf16_f32 v63, v64, v65
    ds_write_addtid_b32 v63 offset:20592
    v_cvt_pk_bf16_f32 v60, v66, v67
    ds_write_addtid_b32 v60 offset:23760
    v_cvt_pk_bf16_f32 v61, v68, v69
    ds_write_addtid_b32 v61 offset:27984
    v_cvt_pk_bf16_f32 v62, v70, v71
    ds_write_addtid_b32 v62 offset:32208
    v_pk_mul_f32 v[48:49], v[66:67], v[44:45] op_sel:[0,0] op_sel_hi:[0,1]
    v_pk_mul_f32 v[50:51], v[68:69], v[44:45] op_sel:[0,0] op_sel_hi:[0,1]
    v_pk_mul_f32 v[52:53], v[70:71], v[44:45] op_sel:[0,0] op_sel_hi:[0,1]
    v_pk_fma_f32 v[48:49], v[66:67], v[44:45], v[48:49] op_sel:[1,1,0] op_sel_hi:[1,0,1] neg_lo:[0,1,0]
    v_pk_fma_f32 v[50:51], v[68:69], v[44:45], v[50:51] op_sel:[1,1,0] op_sel_hi:[1,0,1] neg_lo:[0,1,0]
    v_pk_fma_f32 v[52:53], v[70:71], v[44:45], v[52:53] op_sel:[1,1,0] op_sel_hi:[1,0,1] neg_lo:[0,1,0]
    v_cvt_pk_bf16_f32 v63, v48, v49
    ds_write_addtid_b32 v63 offset:24288
    v_cvt_pk_bf16_f32 v60, v50, v51
    ds_write_addtid_b32 v60 offset:28512
    v_cvt_pk_bf16_f32 v61, v52, v53
    ds_write_addtid_b32 v61 offset:32736
    v_pk_mul_f32 v[66:67], v[48:49], v[44:45] op_sel:[0,0] op_sel_hi:[0,1]
    v_pk_mul_f32 v[68:69], v[50:51], v[44:45] op_sel:[0,0] op_sel_hi:[0,1]
    v_pk_mul_f32 v[70:71], v[52:53], v[44:45] op_sel:[0,0] op_sel_hi:[0,1]
    v_pk_fma_f32 v[66:67], v[48:49], v[44:45], v[66:67] op_sel:[1,1,0] op_sel_hi:[1,0,1] neg_lo:[0,1,0]
    v_pk_fma_f32 v[68:69], v[50:51], v[44:45], v[68:69] op_sel:[1,1,0] op_sel_hi:[1,0,1] neg_lo:[0,1,0]
    v_pk_fma_f32 v[70:71], v[52:53], v[44:45], v[70:71] op_sel:[1,1,0] op_sel_hi:[1,0,1] neg_lo:[0,1,0]
    v_cvt_pk_bf16_f32 v62, v66, v67
    ds_write_addtid_b32 v62 offset:24816
    v_cvt_pk_bf16_f32 v63, v68, v69
    ds_write_addtid_b32 v63 offset:29040
    v_cvt_pk_bf16_f32 v60, v70, v71
    ds_write_addtid_b32 v60 offset:33264
    s_branch A_mm
A_pa:
    s_cmp_eq_u32 s31, 1
    s_cbranch_scc1 A_a1
    v_mul_f32 v20, s71, v20
    v_mul_f32 v21, s71, v21
    v_mul_f32 v20, 0x3fb8aa3b, v20
    v_mul_f32 v21, 0.15915494, v21
    v_exp_f32 v56, v20
    v_fract_f32 v45, v21
    v_mul_f32 v57, 0x41000000, v20
    v_mul_f32 v47, 0x41000000, v21
    v_mul_f32 v58, 0x43800000, v20
    v_mul_f32 v49, 0x43800000, v21
    v_exp_f32 v57, v57
    v_fract_f32 v47, v47
    v_exp_f32 v58, v58
    v_fract_f32 v49, v49
    v_cos_f32 v44, v45
    v_sin_f32 v45, v45
    v_cos_f32 v46, v47
    v_sin_f32 v47, v47
    v_cos_f32 v48, v49
    v_sin_f32 v49, v49
    v_mul_f32 v44, v44, v56
    v_mul_f32 v45, v45, v56
    v_mul_f32 v46, v46, v57
    v_mul_f32 v47, v47, v57
    v_mul_f32 v48, v48, v58
    v_mul_f32 v49, v49, v58
    v_mul_f32 v22, s71, v22
    v_mul_f32 v23, s71, v23
    v_pk_mul_f32 v[64:65], v[24:25], v[22:23] op_sel:[0,0] op_sel_hi:[0,1]
    v_pk_mul_f32 v[50:51], v[44:45], v[44:45] op_sel:[0,0] op_sel_hi:[0,1]
    v_pk_fma_f32 v[64:65], v[24:25], v[22:23], v[64:65] op_sel:[1,1,0] op_sel_hi:[1,0,1] neg_lo:[0,1,0]
    v_pk_fma_f32 v[50:51], v[44:45], v[44:45], v[50:51] op_sel:[1,1,0] op_sel_hi:[1,0,1] neg_lo:[0,1,0]
    v_cvt_pk_bf16_f32 v61, v64, -v65
    ds_write_addtid_b32 v61 offset:0
    v_pk_mul_f32 v[66:67], v[64:65], v[44:45] op_sel:[0,0] op_sel_hi:[0,1]
    v_pk_mul_f32 v[68:69], v[64:65], v[50:51] op_sel:[0,0] op_sel_hi:[0,1]
    v_pk_mul_f32 v[52:53], v[50:51], v[50:51] op_sel:[0,0] op_sel_hi:[0,1]
    v_pk_mul_f32 v[80:81], v[64:65], v[48:49] op_sel:[0,0] op_sel_hi:[0,1]
    v_pk_fma_f32 v[66:67], v[64:65], v[44:45], v[66:67] op_sel:[1,1,0] op_sel_hi:[1,0,1] neg_lo:[0,1,0]
    v_pk_fma_f32 v[68:69], v[64:65], v[50:51], v[68:69] op_sel:[1,1,0] op_sel_hi:[1,0,1] neg_lo:[0,1,0]
    v_pk_fma_f32 v[52:53], v[50:51], v[50:51], v[52:53] op_sel:[1,1,0] op_sel_hi:[1,0,1] neg_lo:[0,1,0]
    v_pk_fma_f32 v[80:81], v[64:65], v[48:49], v[80:81] op_sel:[1,1,0] op_sel_hi:[1,0,1] neg_lo:[0,1,0]
    v_cvt_pk_bf16_f32 v62, v66, -v67
    ds_write_addtid_b32 v62 offset:528
    v_cvt_pk_bf16_f32 v63, v68, -v69
    ds_write_addtid_b32 v63 offset:1056
    v_cvt_pk_bf16_f32 v60, v80, -v81
    ds_write_addtid_b32 v60 offset:2112
    ds_write_addtid_b32 v60 offset:2640
    v_pk_mul_f32 v[70:71], v[66:67], v[50:51] op_sel:[0,0] op_sel_hi:[0,1]
    v_pk_mul_f32 v[72:73], v[64:65], v[52:53] op_sel:[0,0] op_sel_hi:[0,1]
    v_pk_mul_f32 v[74:75], v[66:67], v[52:53] op_sel:[0,0] op_sel_hi:[0,1]
    v_pk_mul_f32 v[76:77], v[68:69], v[52:53] op_sel:[0,0] op_sel_hi:[0,1]
    v_pk_mul_f32 v[82:83], v[68:69], v[48:49] op_sel:[0,0] op_sel_hi:[0,1]
    v_pk_mul_f32 v[84:85], v[80:81], v[46:47] op_sel:[0,0] op_sel_hi:[0,1]
    v_pk_fma_f32 v[70:71], v[66:67], v[50:51], v[70:71] op_sel:[1,1,0] op_sel_hi:[1,0,1] neg_lo:[0,1,0]
    v_pk_fma_f32 v[72:73], v[64:65], v[52:53], v[72:73] op_sel:[1,1,0] op_sel_hi:[1,0,1] neg_lo:[0,1,0]
    v_pk_fma_f32 v[74:75], v[66:67], v[52:53], v[74:75] op_sel:[1,1,0] op_sel_hi:[1,0,1] neg_lo:[0,1,0]
    v_pk_fma_f32 v[76:77], v[68:69], v[52:53], v[76:77] op_sel:[1,1,0] op_sel_hi:[1,0,1] neg_lo:[0,1,0]
    v_pk_fma_f32 v[82:83], v[68:69], v[48:49], v[82:83] op_sel:[1,1,0] op_sel_hi:[1,0,1] neg_lo:[0,1,0]
    v_pk_fma_f32 v[84:85], v[80:81], v[46:47], v[84:85] op_sel:[1,1,0] op_sel_hi:[1,0,1] neg_lo:[0,1,0]
    v_cvt_pk_bf16_f32 v61, v70, -v71
    ds_write_addtid_b32 v61 offset:1584
    v_cvt_pk_bf16_f32 v62, v72, -v73
    ds_write_addtid_b32 v62 offset:4224
    v_cvt_pk_bf16_f32 v63, v74, -v75
    ds_write_addtid_b32 v63 offset:4752
    v_cvt_pk_bf16_f32 v60, v76, -v77
    ds_write_addtid_b32 v60 offset:5280
    v_cvt_pk_bf16_f32 v61, v82, -v83
    ds_write_addtid_b32 v61 offset:3168
    v_cvt_pk_bf16_f32 v62, v84, -v85
    ds_write_addtid_b32 v62 offset:7920
    v_pk_mul_f32 v[78:79], v[70:71], v[52:53] op_sel:[0,0] op_sel_hi:[0,1]
    v_pk_mul_f32 v[64:65], v[72:73], v[48:49] op_sel:[0,0] op_sel_hi:[0,1]
    v_pk_mul_f32 v[66:67], v[76:77], v[48:49] op_sel:[0,0] op_sel_hi:[0,1]
    v_pk_mul_f32 v[68:69], v[80:81], v[48:49] op_sel:[0,0] op_sel_hi:[0,1]
    v_pk_mul_f32 v[74:75], v[84:85], v[48:49] op_sel:[0,0] op_sel_hi:[0,1]
    v_pk_fma_f32 v[78:79], v[70:71], v[52:53], v[78:79] op_sel:[1,1,0] op_sel_hi:[1,0,1] neg_lo:[0,1,0]
    v_pk_fma_f32 v[64:65], v[72:73], v[48:49], v[64:65] op_sel:[1,1,0] op_sel_hi:[1,0,1] neg_lo:[0,1,0]
    v_pk_fma_f32 v[66:67], v[76:77], v[48:49], v[66:67] op_sel:[1,1,0] op_sel_hi:[1,0,1] neg_lo:[0,1,0]
    v_pk_fma_f32 v[68:69], v[80:81], v[48:49], v[68:69] op_sel:[1,1,0] op_sel_hi:[1,0,1] neg_lo:[0,1,0]
    v_pk_fma_f32 v[74:75], v[84:85], v[48:49], v[74:75] op_sel:[1,1,0] op_sel_hi:[1,0,1] neg_lo:[0,1,0]
    v_cvt_pk_bf16_f32 v63, v78, -v79
    ds_write_addtid_b32 v63 offset:5808
    v_cvt_pk_bf16_f32 v60, v64, -v65
    ds_write_addtid_b32 v60 offset:3696
    ds_write_addtid_b32 v60 offset:6336
    ds_write_addtid_b32 v60 offset:6864
    v_cvt_pk_bf16_f32 v61, v66, -v67
    ds_write_addtid_b32 v61 offset:7392
    v_cvt_pk_bf16_f32 v62, v68, -v69
    ds_write_addtid_b32 v62 offset:8448
    v_cvt_pk_bf16_f32 v63, v74, -v75
    ds_write_addtid_b32 v63 offset:9504
    v_pk_mul_f32 v[70:71], v[64:65], v[48:49] op_sel:[0,0] op_sel_hi:[0,1]
    v_pk_mul_f32 v[80:81], v[68:69], v[48:49] op_sel:[0,0] op_sel_hi:[0,1]
    v_pk_mul_f32 v[84:85], v[74:75], v[48:49] op_sel:[0,0] op_sel_hi:[0,1]
    v_pk_fma_f32 v[70:71], v[64:65], v[48:49], v[70:71] op_sel:[1,1,0] op_sel_hi:[1,0,1] neg_lo:[0,1,0]
    v_pk_fma_f32 v[80:81], v[68:69], v[48:49], v[80:81] op_sel:[1,1,0] op_sel_hi:[1,0,1] neg_lo:[0,1,0]
    v_pk_fma_f32 v[84:85], v[74:75], v[48:49], v[84:85] op_sel:[1,1,0] op_sel_hi:[1,0,1] neg_lo:[0,1,0]
    v_cvt_pk_bf16_f32 v60, v70, -v71
    ds_write_addtid_b32 v60 offset:8976
    v_cvt_pk_bf16_f32 v61, v80, -v81
    ds_write_addtid_b32 v61 offset:10560
    v_cvt_pk_bf16_f32 v62, v84, -v85
    ds_write_addtid_b32 v62 offset:11616
    v_pk_mul_f32 v[64:65], v[70:71], v[48:49] op_sel:[0,0] op_sel_hi:[0,1]
    v_pk_mul_f32 v[68:69], v[80:81], v[48:49] op_sel:[0,0] op_sel_hi:[0,1]
    v_pk_mul_f32 v[74:75], v[84:85], v[48:49] op_sel:[0,0] op_sel_hi:[0,1]
    v_pk_fma_f32 v[64:65], v[70:71], v[48:49], v[64:65] op_sel:[1,1,0] op_sel_hi:[1,0,1] neg_lo:[0,1,0]
    v_pk_fma_f32 v[68:69], v[80:81], v[48:49], v[68:69] op_sel:[1,1,0] op_sel_hi:[1,0,1] neg_lo:[0,1,0]
    v_pk_fma_f32 v[74:75], v[84:85], v[48:49], v[74:75] op_sel:[1,1,0] op_sel_hi:[1,0,1] neg_lo:[0,1,0]
    v_cvt_pk_bf16_f32 v63, v64, -v65
    ds_write_addtid_b32 v63 offset:11088
    v_cvt_pk_bf16_f32 v60, v68, -v69
    ds_write_addtid_b32 v60 offset:10032
    v_cvt_pk_bf16_f32 v61, v74, -v75
    ds_write_addtid_b32 v61 offset:12672
    v_pk_mul_f32 v[80:81], v[68:69], v[48:49] op_sel:[0,0] op_sel_hi:[0,1]
    v_pk_mul_f32 v[84:85], v[74:75], v[48:49] op_sel:[0,0] op_sel_hi:[0,1]
    v_pk_fma_f32 v[80:81], v[68:69], v[48:49], v[80:81] op_sel:[1,1,0] op_sel_hi:[1,0,1] neg_lo:[0,1,0]
    v_pk_fma_f32 v[84:85], v[74:75], v[48:49], v[84:85] op_sel:[1,1,0] op_sel_hi:[1,0,1] neg_lo:[0,1,0]
    v_cvt_pk_bf16_f32 v62, v80, -v81
    ds_write_addtid_b32 v62 offset:12144
    v_cvt_pk_bf16_f32 v63, v84, -v85
    ds_write_addtid_b32 v63 offset:14784
    v_pk_mul_f32 v[68:69], v[80:81], v[48:49] op_sel:[0,0] op_sel_hi:[0,1]
    v_pk_mul_f32 v[74:75], v[84:85], v[48:49] op_sel:[0,0] op_sel_hi:[0,1]
    v_pk_fma_f32 v[68:69], v[80:81], v[48:49], v[68:69] op_sel:[1,1,0] op_sel_hi:[1,0,1] neg_lo:[0,1,0]
    v_pk_fma_f32 v[74:75], v[84:85], v[48:49], v[74:75] op_sel:[1,1,0] op_sel_hi:[1,0,1] neg_lo:[0,1,0]
    v_cvt_pk_bf16_f32 v60, v68, -v69
    ds_write_addtid_b32 v60 offset:13200
    v_cvt_pk_bf16_f32 v61, v74, -v75
    ds_write_addtid_b32 v61 offset:13728
    v_pk_mul_f32 v[80:81], v[68:69], v[48:49] op_sel:[0,0] op_sel_hi:[0,1]
    v_pk_mul_f32 v[84:85], v[74:75], v[48:49] op_sel:[0,0] op_sel_hi:[0,1]
    v_pk_fma_f32 v[80:81], v[68:69], v[48:49], v[80:81] op_sel:[1,1,0] op_sel_hi:[1,0,1] neg_lo:[0,1,0]
    v_pk_fma_f32 v[84:85], v[74:75], v[48:49], v[84:85] op_sel:[1,1,0] op_sel_hi:[1,0,1] neg_lo:[0,1,0]
    v_cvt_pk_bf16_f32 v62, v80, -v81
    ds_write_addtid_b32 v62 offset:15312
    v_cvt_pk_bf16_f32 v63, v84, -v85
    ds_write_addtid_b32 v63 offset:15840
A_a1:
    s_add_u32 m0, m0, 33792
    v_mul_f32 v28, s72, v28
    v_mul_f32 v29, s72, v29
    v_mul_f32 v28, 0x3fb8aa3b, v28
    v_mul_f32 v29, 0.15915494, v29
    v_exp_f32 v56, v28
    v_fract_f32 v45, v29
    v_mul_f32 v57, 0x41000000, v28
    v_mul_f32 v47, 0x41000000, v29
    v_mul_f32 v58, 0x43800000, v28
    v_mul_f32 v49, 0x43800000, v29
    v_exp_f32 v57, v57
    v_fract_f32 v47, v47
    v_exp_f32 v58, v58
    v_fract_f32 v49, v49
    v_cos_f32 v44, v45
    v_sin_f32 v45, v45
    v_cos_f32 v46, v47
    v_sin_f32 v47, v47
    v_cos_f32 v48, v49
    v_sin_f32 v49, v49
    v_mul_f32 v44, v44, v56
    v_mul_f32 v45, v45, v56
    v_mul_f32 v46, v46, v57
    v_mul_f32 v47, v47, v57
    v_mul_f32 v48, v48, v58
    v_mul_f32 v49, v49, v58
    v_mul_f32 v30, s72, v30
    v_mul_f32 v31, s72, v31
    v_pk_mul_f32 v[64:65], v[32:33], v[30:31] op_sel:[0,0] op_sel_hi:[0,1]
    v_pk_mul_f32 v[50:51], v[44:45], v[44:45] op_sel:[0,0] op_sel_hi:[0,1]
    v_pk_fma_f32 v[64:65], v[32:33], v[30:31], v[64:65] op_sel:[1,1,0] op_sel_hi:[1,0,1] neg_lo:[0,1,0]
    v_pk_fma_f32 v[50:51], v[44:45], v[44:45], v[50:51] op_sel:[1,1,0] op_sel_hi:[1,0,1] neg_lo:[0,1,0]
    v_cvt_pk_bf16_f32 v60, v64, -v65
    ds_write_addtid_b32 v60 offset:0
    v_pk_mul_f32 v[66:67], v[64:65], v[44:45] op_sel:[0,0] op_sel_hi:[0,1]
    v_pk_mul_f32 v[68:69], v[64:65], v[50:51] op_sel:[0,0] op_sel_hi:[0,1]
    v_pk_mul_f32 v[52:53], v[50:51], v[50:51] op_sel:[0,0] op_sel_hi:[0,1]
    v_pk_mul_f32 v[80:81], v[64:65], v[48:49] op_sel:[0,0] op_sel_hi:[0,1]
    v_pk_fma_f32 v[66:67], v[64:65], v[44:45], v[66:67] op_sel:[1,1,0] op_sel_hi:[1,0,1] neg_lo:[0,1,0]
    v_pk_fma_f32 v[68:69], v[64:65], v[50:51], v[68:69] op_sel:[1,1,0] op_sel_hi:[1,0,1] neg_lo:[0,1,0]
    v_pk_fma_f32 v[52:53], v[50:51], v[50:51], v[52:53] op_sel:[1,1,0] op_sel_hi:[1,0,1] neg_lo:[0,1,0]
    v_pk_fma_f32 v[80:81], v[64:65], v[48:49], v[80:81] op_sel:[1,1,0] op_sel_hi:[1,0,1] neg_lo:[0,1,0]
    v_cvt_pk_bf16_f32 v61, v66, -v67
    ds_write_addtid_b32 v61 offset:528
    v_cvt_pk_bf16_f32 v62, v68, -v69
    ds_write_addtid_b32 v62 offset:1056
    v_cvt_pk_bf16_f32 v63, v80, -v81
    ds_write_addtid_b32 v63 offset:2112
    ds_write_addtid_b32 v63 offset:2640
    v_pk_mul_f32 v[70:71], v[66:67], v[50:51] op_sel:[0,0] op_sel_hi:[0,1]
    v_pk_mul_f32 v[72:73], v[64:65], v[52:53] op_sel:[0,0] op_sel_hi:[0,1]
    v_pk_mul_f32 v[74:75], v[66:67], v[52:53] op_sel:[0,0] op_sel_hi:[0,1]
    v_pk_mul_f32 v[76:77], v[68:69], v[52:53] op_sel:[0,0] op_sel_hi:[0,1]
    v_pk_mul_f32 v[82:83], v[68:69], v[48:49] op_sel:[0,0] op_sel_hi:[0,1]
    v_pk_mul_f32 v[84:85], v[80:81], v[46:47] op_sel:[0,0] op_sel_hi:[0,1]
    v_pk_fma_f32 v[70:71], v[66:67], v[50:51], v[70:71] op_sel:[1,1,0] op_sel_hi:[1,0,1] neg_lo:[0,1,0]
    v_pk_fma_f32 v[72:73], v[64:65], v[52:53], v[72:73] op_sel:[1,1,0] op_sel_hi:[1,0,1] neg_lo:[0,1,0]
    v_pk_fma_f32 v[74:75], v[66:67], v[52:53], v[74:75] op_sel:[1,1,0] op_sel_hi:[1,0,1] neg_lo:[0,1,0]
    v_pk_fma_f32 v[76:77], v[68:69], v[52:53], v[76:77] op_sel:[1,1,0] op_sel_hi:[1,0,1] neg_lo:[0,1,0]
    v_pk_fma_f32 v[82:83], v[68:69], v[48:49], v[82:83] op_sel:[1,1,0] op_sel_hi:[1,0,1] neg_lo:[0,1,0]
    v_pk_fma_f32 v[84:85], v[80:81], v[46:47], v[84:85] op_sel:[1,1,0] op_sel_hi:[1,0,1] neg_lo:[0,1,0]
    v_cvt_pk_bf16_f32 v60, v70, -v71
    ds_write_addtid_b32 v60 offset:1584
    v_cvt_pk_bf16_f32 v61, v72, -v73
    ds_write_addtid_b32 v61 offset:4224
    v_cvt_pk_bf16_f32 v62, v74, -v75
    ds_write_addtid_b32 v62 offset:4752
    v_cvt_pk_bf16_f32 v63, v76, -v77
    ds_write_addtid_b32 v63 offset:5280
    v_cvt_pk_bf16_f32 v60, v82, -v83
    ds_write_addtid_b32 v60 offset:3168
    v_cvt_pk_bf16_f32 v61, v84, -v85
    ds_write_addtid_b32 v61 offset:7920
    v_pk_mul_f32 v[78:79], v[70:71], v[52:53] op_sel:[0,0] op_sel_hi:[0,1]
    v_pk_mul_f32 v[64:65], v[72:73], v[48:49] op_sel:[0,0] op_sel_hi:[0,1]
    v_pk_mul_f32 v[66:67], v[76:77], v[48:49] op_sel:[0,0] op_sel_hi:[0,1]
    v_pk_mul_f32 v[68:69], v[80:81], v[48:49] op_sel:[0,0] op_sel_hi:[0,1]
    v_pk_mul_f32 v[74:75], v[84:85], v[48:49] op_sel:[0,0] op_sel_hi:[0,1]
    v_pk_fma_f32 v[78:79], v[70:71], v[52:53], v[78:79] op_sel:[1,1,0] op_sel_hi:[1,0,1] neg_lo:[0,1,0]
    v_pk_fma_f32 v[64:65], v[72:73], v[48:49], v[64:65] op_sel:[1,1,0] op_sel_hi:[1,0,1] neg_lo:[0,1,0]
    v_pk_fma_f32 v[66:67], v[76:77], v[48:49], v[66:67] op_sel:[1,1,0] op_sel_hi:[1,0,1] neg_lo:[0,1,0]
    v_pk_fma_f32 v[68:69], v[80:81], v[48:49], v[68:69] op_sel:[1,1,0] op_sel_hi:[1,0,1] neg_lo:[0,1,0]
    v_pk_fma_f32 v[74:75], v[84:85], v[48:49], v[74:75] op_sel:[1,1,0] op_sel_hi:[1,0,1] neg_lo:[0,1,0]
    v_cvt_pk_bf16_f32 v62, v78, -v79
    ds_write_addtid_b32 v62 offset:5808
    v_cvt_pk_bf16_f32 v63, v64, -v65
    ds_write_addtid_b32 v63 offset:3696
    ds_write_addtid_b32 v63 offset:6336
    ds_write_addtid_b32 v63 offset:6864
    v_cvt_pk_bf16_f32 v60, v66, -v67
    ds_write_addtid_b32 v60 offset:7392
    v_cvt_pk_bf16_f32 v61, v68, -v69
    ds_write_addtid_b32 v61 offset:8448
    v_cvt_pk_bf16_f32 v62, v74, -v75
    ds_write_addtid_b32 v62 offset:9504
    v_pk_mul_f32 v[70:71], v[64:65], v[48:49] op_sel:[0,0] op_sel_hi:[0,1]
    v_pk_mul_f32 v[80:81], v[68:69], v[48:49] op_sel:[0,0] op_sel_hi:[0,1]
    v_pk_mul_f32 v[84:85], v[74:75], v[48:49] op_sel:[0,0] op_sel_hi:[0,1]
    v_pk_fma_f32 v[70:71], v[64:65], v[48:49], v[70:71] op_sel:[1,1,0] op_sel_hi:[1,0,1] neg_lo:[0,1,0]
    v_pk_fma_f32 v[80:81], v[68:69], v[48:49], v[80:81] op_sel:[1,1,0] op_sel_hi:[1,0,1] neg_lo:[0,1,0]
    v_pk_fma_f32 v[84:85], v[74:75], v[48:49], v[84:85] op_sel:[1,1,0] op_sel_hi:[1,0,1] neg_lo:[0,1,0]
    v_cvt_pk_bf16_f32 v63, v70, -v71
    ds_write_addtid_b32 v63 offset:8976
    v_cvt_pk_bf16_f32 v60, v80, -v81
    ds_write_addtid_b32 v60 offset:10560
    v_cvt_pk_bf16_f32 v61, v84, -v85
    ds_write_addtid_b32 v61 offset:11616
    v_pk_mul_f32 v[64:65], v[70:71], v[48:49] op_sel:[0,0] op_sel_hi:[0,1]
    v_pk_mul_f32 v[68:69], v[80:81], v[48:49] op_sel:[0,0] op_sel_hi:[0,1]
    v_pk_mul_f32 v[74:75], v[84:85], v[48:49] op_sel:[0,0] op_sel_hi:[0,1]
    v_pk_fma_f32 v[64:65], v[70:71], v[48:49], v[64:65] op_sel:[1,1,0] op_sel_hi:[1,0,1] neg_lo:[0,1,0]
    v_pk_fma_f32 v[68:69], v[80:81], v[48:49], v[68:69] op_sel:[1,1,0] op_sel_hi:[1,0,1] neg_lo:[0,1,0]
    v_pk_fma_f32 v[74:75], v[84:85], v[48:49], v[74:75] op_sel:[1,1,0] op_sel_hi:[1,0,1] neg_lo:[0,1,0]
    v_cvt_pk_bf16_f32 v62, v64, -v65
    ds_write_addtid_b32 v62 offset:11088
    v_cvt_pk_bf16_f32 v63, v68, -v69
    ds_write_addtid_b32 v63 offset:10032
    v_cvt_pk_bf16_f32 v60, v74, -v75
    ds_write_addtid_b32 v60 offset:12672
    v_pk_mul_f32 v[80:81], v[68:69], v[48:49] op_sel:[0,0] op_sel_hi:[0,1]
    v_pk_mul_f32 v[84:85], v[74:75], v[48:49] op_sel:[0,0] op_sel_hi:[0,1]
    v_pk_fma_f32 v[80:81], v[68:69], v[48:49], v[80:81] op_sel:[1,1,0] op_sel_hi:[1,0,1] neg_lo:[0,1,0]
    v_pk_fma_f32 v[84:85], v[74:75], v[48:49], v[84:85] op_sel:[1,1,0] op_sel_hi:[1,0,1] neg_lo:[0,1,0]
    v_cvt_pk_bf16_f32 v61, v80, -v81
    ds_write_addtid_b32 v61 offset:12144
    v_cvt_pk_bf16_f32 v62, v84, -v85
    ds_write_addtid_b32 v62 offset:14784
    v_pk_mul_f32 v[68:69], v[80:81], v[48:49] op_sel:[0,0] op_sel_hi:[0,1]
    v_pk_mul_f32 v[74:75], v[84:85], v[48:49] op_sel:[0,0] op_sel_hi:[0,1]
    v_pk_fma_f32 v[68:69], v[80:81], v[48:49], v[68:69] op_sel:[1,1,0] op_sel_hi:[1,0,1] neg_lo:[0,1,0]
    v_pk_fma_f32 v[74:75], v[84:85], v[48:49], v[74:75] op_sel:[1,1,0] op_sel_hi:[1,0,1] neg_lo:[0,1,0]
    v_cvt_pk_bf16_f32 v63, v68, -v69
    ds_write_addtid_b32 v63 offset:13200
    v_cvt_pk_bf16_f32 v60, v74, -v75
    ds_write_addtid_b32 v60 offset:13728
    v_pk_mul_f32 v[80:81], v[68:69], v[48:49] op_sel:[0,0] op_sel_hi:[0,1]
    v_pk_mul_f32 v[84:85], v[74:75], v[48:49] op_sel:[0,0] op_sel_hi:[0,1]
    v_pk_fma_f32 v[80:81], v[68:69], v[48:49], v[80:81] op_sel:[1,1,0] op_sel_hi:[1,0,1] neg_lo:[0,1,0]
    v_pk_fma_f32 v[84:85], v[74:75], v[48:49], v[84:85] op_sel:[1,1,0] op_sel_hi:[1,0,1] neg_lo:[0,1,0]
    v_cvt_pk_bf16_f32 v61, v80, -v81
    ds_write_addtid_b32 v61 offset:15312
    v_cvt_pk_bf16_f32 v62, v84, -v85
    ds_write_addtid_b32 v62 offset:15840
    s_add_u32 m0, m0, 33792
    v_mul_f32 v36, s73, v36
    v_mul_f32 v37, s73, v37
    v_mul_f32 v36, 0x3fb8aa3b, v36
    v_mul_f32 v37, 0.15915494, v37
    v_exp_f32 v56, v36
    v_fract_f32 v45, v37
    v_mul_f32 v57, 0x41000000, v36
    v_mul_f32 v47, 0x41000000, v37
    v_mul_f32 v58, 0x43800000, v36
    v_mul_f32 v49, 0x43800000, v37
    v_exp_f32 v57, v57
    v_fract_f32 v47, v47
    v_exp_f32 v58, v58
    v_fract_f32 v49, v49
    v_cos_f32 v44, v45
    v_sin_f32 v45, v45
    v_cos_f32 v46, v47
    v_sin_f32 v47, v47
    v_cos_f32 v48, v49
    v_sin_f32 v49, v49
    v_mul_f32 v44, v44, v56
    v_mul_f32 v45, v45, v56
    v_mul_f32 v46, v46, v57
    v_mul_f32 v47, v47, v57
    v_mul_f32 v48, v48, v58
    v_mul_f32 v49, v49, v58
    v_mul_f32 v38, s73, v38
    v_mul_f32 v39, s73, v39
    v_pk_mul_f32 v[64:65], v[40:41], v[38:39] op_sel:[0,0] op_sel_hi:[0,1]
    v_pk_mul_f32 v[50:51], v[44:45], v[44:45] op_sel:[0,0] op_sel_hi:[0,1]
    v_pk_fma_f32 v[64:65], v[40:41], v[38:39], v[64:65] op_sel:[1,1,0] op_sel_hi:[1,0,1] neg_lo:[0,1,0]
    v_pk_fma_f32 v[50:51], v[44:45], v[44:45], v[50:51] op_sel:[1,1,0] op_sel_hi:[1,0,1] neg_lo:[0,1,0]
    v_cvt_pk_bf16_f32 v63, v64, -v65
    ds_write_addtid_b32 v63 offset:0
    v_pk_mul_f32 v[66:67], v[64:65], v[44:45] op_sel:[0,0] op_sel_hi:[0,1]
    v_pk_mul_f32 v[68:69], v[64:65], v[50:51] op_sel:[0,0] op_sel_hi:[0,1]
    v_pk_mul_f32 v[52:53], v[50:51], v[50:51] op_sel:[0,0] op_sel_hi:[0,1]
    v_pk_mul_f32 v[80:81], v[64:65], v[48:49] op_sel:[0,0] op_sel_hi:[0,1]
    v_pk_fma_f32 v[66:67], v[64:65], v[44:45], v[66:67] op_sel:[1,1,0] op_sel_hi:[1,0,1] neg_lo:[0,1,0]
    v_pk_fma_f32 v[68:69], v[64:65], v[50:51], v[68:69] op_sel:[1,1,0] op_sel_hi:[1,0,1] neg_lo:[0,1,0]
    v_pk_fma_f32 v[52:53], v[50:51], v[50:51], v[52:53] op_sel:[1,1,0] op_sel_hi:[1,0,1] neg_lo:[0,1,0]
    v_pk_fma_f32 v[80:81], v[64:65], v[48:49], v[80:81] op_sel:[1,1,0] op_sel_hi:[1,0,1] neg_lo:[0,1,0]
    v_cvt_pk_bf16_f32 v60, v66, -v67
    ds_write_addtid_b32 v60 offset:528
    v_cvt_pk_bf16_f32 v61, v68, -v69
    ds_write_addtid_b32 v61 offset:1056
    v_cvt_pk_bf16_f32 v62, v80, -v81
    ds_write_addtid_b32 v62 offset:2112
    ds_write_addtid_b32 v62 offset:2640
    v_pk_mul_f32 v[70:71], v[66:67], v[50:51] op_sel:[0,0] op_sel_hi:[0,1]
    v_pk_mul_f32 v[72:73], v[64:65], v[52:53] op_sel:[0,0] op_sel_hi:[0,1]
    v_pk_mul_f32 v[74:75], v[66:67], v[52:53] op_sel:[0,0] op_sel_hi:[0,1]
    v_pk_mul_f32 v[76:77], v[68:69], v[52:53] op_sel:[0,0] op_sel_hi:[0,1]
    v_pk_mul_f32 v[82:83], v[68:69], v[48:49] op_sel:[0,0] op_sel_hi:[0,1]
    v_pk_mul_f32 v[84:85], v[80:81], v[46:47] op_sel:[0,0] op_sel_hi:[0,1]
    v_pk_fma_f32 v[70:71], v[66:67], v[50:51], v[70:71] op_sel:[1,1,0] op_sel_hi:[1,0,1] neg_lo:[0,1,0]
    v_pk_fma_f32 v[72:73], v[64:65], v[52:53], v[72:73] op_sel:[1,1,0] op_sel_hi:[1,0,1] neg_lo:[0,1,0]
    v_pk_fma_f32 v[74:75], v[66:67], v[52:53], v[74:75] op_sel:[1,1,0] op_sel_hi:[1,0,1] neg_lo:[0,1,0]
    v_pk_fma_f32 v[76:77], v[68:69], v[52:53], v[76:77] op_sel:[1,1,0] op_sel_hi:[1,0,1] neg_lo:[0,1,0]
    v_pk_fma_f32 v[82:83], v[68:69], v[48:49], v[82:83] op_sel:[1,1,0] op_sel_hi:[1,0,1] neg_lo:[0,1,0]
    v_pk_fma_f32 v[84:85], v[80:81], v[46:47], v[84:85] op_sel:[1,1,0] op_sel_hi:[1,0,1] neg_lo:[0,1,0]
    v_cvt_pk_bf16_f32 v63, v70, -v71
    ds_write_addtid_b32 v63 offset:1584
    v_cvt_pk_bf16_f32 v60, v72, -v73
    ds_write_addtid_b32 v60 offset:4224
    v_cvt_pk_bf16_f32 v61, v74, -v75
    ds_write_addtid_b32 v61 offset:4752
    v_cvt_pk_bf16_f32 v62, v76, -v77
    ds_write_addtid_b32 v62 offset:5280
    v_cvt_pk_bf16_f32 v63, v82, -v83
    ds_write_addtid_b32 v63 offset:3168
    v_cvt_pk_bf16_f32 v60, v84, -v85
    ds_write_addtid_b32 v60 offset:7920
    v_pk_mul_f32 v[78:79], v[70:71], v[52:53] op_sel:[0,0] op_sel_hi:[0,1]
    v_pk_mul_f32 v[64:65], v[72:73], v[48:49] op_sel:[0,0] op_sel_hi:[0,1]
    v_pk_mul_f32 v[66:67], v[76:77], v[48:49] op_sel:[0,0] op_sel_hi:[0,1]
    v_pk_mul_f32 v[68:69], v[80:81], v[48:49] op_sel:[0,0] op_sel_hi:[0,1]
    v_pk_mul_f32 v[74:75], v[84:85], v[48:49] op_sel:[0,0] op_sel_hi:[0,1]
    v_pk_fma_f32 v[78:79], v[70:71], v[52:53], v[78:79] op_sel:[1,1,0] op_sel_hi:[1,0,1] neg_lo:[0,1,0]
    v_pk_fma_f32 v[64:65], v[72:73], v[48:49], v[64:65] op_sel:[1,1,0] op_sel_hi:[1,0,1] neg_lo:[0,1,0]
    v_pk_fma_f32 v[66:67], v[76:77], v[48:49], v[66:67] op_sel:[1,1,0] op_sel_hi:[1,0,1] neg_lo:[0,1,0]
    v_pk_fma_f32 v[68:69], v[80:81], v[48:49], v[68:69] op_sel:[1,1,0] op_sel_hi:[1,0,1] neg_lo:[0,1,0]
    v_pk_fma_f32 v[74:75], v[84:85], v[48:49], v[74:75] op_sel:[1,1,0] op_sel_hi:[1,0,1] neg_lo:[0,1,0]
    v_cvt_pk_bf16_f32 v61, v78, -v79
    ds_write_addtid_b32 v61 offset:5808
    v_cvt_pk_bf16_f32 v62, v64, -v65
    ds_write_addtid_b32 v62 offset:3696
    ds_write_addtid_b32 v62 offset:6336
    ds_write_addtid_b32 v62 offset:6864
    v_cvt_pk_bf16_f32 v63, v66, -v67
    ds_write_addtid_b32 v63 offset:7392
    v_cvt_pk_bf16_f32 v60, v68, -v69
    ds_write_addtid_b32 v60 offset:8448
    v_cvt_pk_bf16_f32 v61, v74, -v75
    ds_write_addtid_b32 v61 offset:9504
    v_pk_mul_f32 v[70:71], v[64:65], v[48:49] op_sel:[0,0] op_sel_hi:[0,1]
    v_pk_mul_f32 v[80:81], v[68:69], v[48:49] op_sel:[0,0] op_sel_hi:[0,1]
    v_pk_mul_f32 v[84:85], v[74:75], v[48:49] op_sel:[0,0] op_sel_hi:[0,1]
    v_pk_fma_f32 v[70:71], v[64:65], v[48:49], v[70:71] op_sel:[1,1,0] op_sel_hi:[1,0,1] neg_lo:[0,1,0]
    v_pk_fma_f32 v[80:81], v[68:69], v[48:49], v[80:81] op_sel:[1,1,0] op_sel_hi:[1,0,1] neg_lo:[0,1,0]
    v_pk_fma_f32 v[84:85], v[74:75], v[48:49], v[84:85] op_sel:[1,1,0] op_sel_hi:[1,0,1] neg_lo:[0,1,0]
    s_waitcnt vmcnt(0)
    ds_read_b64_tr_b16 v[152:153], v167 offset:0
    ds_read_b64_tr_b16 v[154:155], v167 offset:256
    ds_read_b64_tr_b16 v[156:157], v167 offset:8
    ds_read_b64_tr_b16 v[158:159], v167 offset:264
    ds_read_b64_tr_b16 v[160:161], v164 offset:2048
    ds_read_b64_tr_b16 v[162:163], v164 offset:2304
    v_cvt_pk_bf16_f32 v62, v70, -v71
    ds_write_addtid_b32 v62 offset:8976
    v_cvt_pk_bf16_f32 v63, v80, -v81
    ds_write_addtid_b32 v63 offset:10560
    v_cvt_pk_bf16_f32 v60, v84, -v85
    ds_write_addtid_b32 v60 offset:11616
    v_pk_mul_f32 v[64:65], v[70:71], v[48:49] op_sel:[0,0] op_sel_hi:[0,1]
    v_pk_mul_f32 v[68:69], v[80:81], v[48:49] op_sel:[0,0] op_sel_hi:[0,1]
    v_pk_mul_f32 v[74:75], v[84:85], v[48:49] op_sel:[0,0] op_sel_hi:[0,1]
    v_pk_fma_f32 v[64:65], v[70:71], v[48:49], v[64:65] op_sel:[1,1,0] op_sel_hi:[1,0,1] neg_lo:[0,1,0]
    v_pk_fma_f32 v[68:69], v[80:81], v[48:49], v[68:69] op_sel:[1,1,0] op_sel_hi:[1,0,1] neg_lo:[0,1,0]
    v_pk_fma_f32 v[74:75], v[84:85], v[48:49], v[74:75] op_sel:[1,1,0] op_sel_hi:[1,0,1] neg_lo:[0,1,0]
    v_cvt_pk_bf16_f32 v61, v64, -v65
    ds_write_addtid_b32 v61 offset:11088
    v_cvt_pk_bf16_f32 v62, v68, -v69
    ds_write_addtid_b32 v62 offset:10032
    v_cvt_pk_bf16_f32 v63, v74, -v75
    ds_write_addtid_b32 v63 offset:12672
    v_pk_mul_f32 v[80:81], v[68:69], v[48:49] op_sel:[0,0] op_sel_hi:[0,1]
    v_pk_mul_f32 v[84:85], v[74:75], v[48:49] op_sel:[0,0] op_sel_hi:[0,1]
    v_pk_fma_f32 v[80:81], v[68:69], v[48:49], v[80:81] op_sel:[1,1,0] op_sel_hi:[1,0,1] neg_lo:[0,1,0]
    v_pk_fma_f32 v[84:85], v[74:75], v[48:49], v[84:85] op_sel:[1,1,0] op_sel_hi:[1,0,1] neg_lo:[0,1,0]
    v_cvt_pk_bf16_f32 v60, v80, -v81
    ds_write_addtid_b32 v60 offset:12144
    v_cvt_pk_bf16_f32 v61, v84, -v85
    ds_write_addtid_b32 v61 offset:14784
    v_pk_mul_f32 v[68:69], v[80:81], v[48:49] op_sel:[0,0] op_sel_hi:[0,1]
    v_pk_mul_f32 v[74:75], v[84:85], v[48:49] op_sel:[0,0] op_sel_hi:[0,1]
    v_pk_fma_f32 v[68:69], v[80:81], v[48:49], v[68:69] op_sel:[1,1,0] op_sel_hi:[1,0,1] neg_lo:[0,1,0]
    v_pk_fma_f32 v[74:75], v[84:85], v[48:49], v[74:75] op_sel:[1,1,0] op_sel_hi:[1,0,1] neg_lo:[0,1,0]
    v_cvt_pk_bf16_f32 v62, v68, -v69
    ds_write_addtid_b32 v62 offset:13200
    v_cvt_pk_bf16_f32 v63, v74, -v75
    ds_write_addtid_b32 v63 offset:13728
    v_pk_mul_f32 v[80:81], v[68:69], v[48:49] op_sel:[0,0] op_sel_hi:[0,1]
    v_pk_mul_f32 v[84:85], v[74:75], v[48:49] op_sel:[0,0] op_sel_hi:[0,1]
    v_pk_fma_f32 v[80:81], v[68:69], v[48:49], v[80:81] op_sel:[1,1,0] op_sel_hi:[1,0,1] neg_lo:[0,1,0]
    v_pk_fma_f32 v[84:85], v[74:75], v[48:49], v[84:85] op_sel:[1,1,0] op_sel_hi:[1,0,1] neg_lo:[0,1,0]
    v_cvt_pk_bf16_f32 v60, v80, -v81
    ds_write_addtid_b32 v60 offset:15312
    v_cvt_pk_bf16_f32 v61, v84, -v85
    ds_write_addtid_b32 v61 offset:15840
A_mm:
    v_and_b32 v4, 31, v1
    v_lshrrev_b32 v5, 5, v1
    v_mul_u32_u24 v6, 528, v4
    v_lshl_add_u32 v6, v5, 4, v6
    s_mul_i32 s88, s28, 33792
    v_add_u32 v6, s88, v6
    s_mul_i32 s88, s28, 13216
    s_add_u32 s88, s88, 101376
    v_lshl_add_u32 v7, v1, 2, s88
    s_waitcnt lgkmcnt(14)
    buffer_store_dwordx4 v[152:155], v165, s[4:7], s62 offen sc1
    s_waitcnt lgkmcnt(12)
    buffer_store_dwordx4 v[156:159], v165, s[4:7], s63 offen sc1
    s_waitcnt lgkmcnt(10)
    buffer_store_dwordx4 v[160:163], v166, s[4:7], s35 offen sc1
    s_waitcnt lgkmcnt(0)
    s_barrier
    s_mov_b32 s93, 65536
    buffer_load_dwordx4 v[96:99], v197, s[4:7], s81 offen offset:0 sc1
    buffer_load_dwordx4 v[112:115], v197, s[4:7], s93 offen offset:0 sc1
    buffer_load_dwordx4 v[100:103], v197, s[4:7], s81 offen offset:1024 sc1
    buffer_load_dwordx4 v[116:119], v197, s[4:7], s93 offen offset:1024 sc1
    buffer_load_dwordx4 v[104:107], v197, s[4:7], s81 offen offset:2048 sc1
    buffer_load_dwordx4 v[120:123], v197, s[4:7], s93 offen offset:2048 sc1
    buffer_load_dwordx4 v[108:111], v197, s[4:7], s81 offen offset:3072 sc1
    buffer_load_dwordx4 v[124:127], v197, s[4:7], s93 offen offset:3072 sc1
    s_mul_i32 s88, s78, 864
    s_and_b32 s88, s88, -128
    s_mul_i32 s89, s65, 69120
    s_add_u32 s88, s88, s89
    s_mul_i32 s89, s28, 17280
    s_add_u32 s88, s88, s89
    s_bitcmp1_b32 s2, 0
    s_cselect_b32 s96, s16, s12
    s_cselect_b32 s97, s17, s13
    s_cselect_b32 s98, s18, s14
    s_cselect_b32 s89, 3712, 0
    s_mov_b32 s99, 0x00020000
    s_add_u32 s88, s88, s89
    v_lshrrev_b32 v198, 3, v1
    v_mul_u32_u24 v198, 27, v198
    v_and_b32 v199, 7, v1
    v_add_lshl_u32 v198, v198, v199, 7
    v_cmp_gt_u32 vcc, 40, v1
    s_mov_b64 exec, vcc
    buffer_load_dword v199, v198, s[96:99], s88 offen
    s_mov_b64 exec, -1
    v_mov_b32 v4, 0
    ds_write_b32 v178, v4 offset:0
    ds_write_b32 v178, v4 offset:13216
    ds_write_b32 v178, v4 offset:26432
    s_cmp_eq_u32 s28, 3
    s_cbranch_scc1 A_ks
    s_cmp_lt_u32 s28, s31
    s_cbranch_scc1 A_ks
    ds_read_b128 v[8:11], v6 offset:0
    ds_read_b128 v[24:27], v6 offset:16896
    ds_read_b128 v[12:15], v6 offset:32
    ds_read_b128 v[28:31], v6 offset:16928
    ds_read_b128 v[16:19], v6 offset:64
    ds_read_b128 v[32:35], v6 offset:16960
    s_cmp_eq_u32 s28, 1
    s_cselect_b32 s88, s75, s76
    s_cmp_eq_u32 s28, 0
    s_cselect_b32 s88, s74, s88
    v_mov_b32 v4, 0
    v_writelane_b32 v4, s88, 0
    s_lshr_b32 s88, s3, 1
    s_sub_u32 s88, s88, s3
    s_lshl_b32 s88, s88, 7
    v_add_u32 v40, s88, v250
    ds_read_b32 v236, v250 offset:0
    ds_read_b32 v237, v250 offset:128
    ds_read_b32 v238, v250 offset:256
    ds_read_b32 v239, v250 offset:384
    ds_read_b32 v240, v250 offset:512
    ds_read_b32 v241, v250 offset:640
    ds_read_b32 v242, v250 offset:768
    ds_read_b32 v243, v250 offset:896
    ds_read_b128 v[20:23], v6 offset:96
    ds_read_b128 v[36:39], v6 offset:16992
    s_waitcnt lgkmcnt(14)
    v_mfma_f32_32x32x16_bf16 v[64:79], v[8:11], v[24:27], 0
    ds_read_b32 v244, v40 offset:2048
    ds_read_b32 v245, v40 offset:2176
    ds_read_b32 v246, v40 offset:2304
    ds_read_b32 v247, v40 offset:2432
    s_mul_i32 s88, s77, 320
    ds_read_b128 v[8:11], v6 offset:128
    ds_read_b128 v[24:27], v6 offset:17024
    s_waitcnt lgkmcnt(15)
    v_mfma_f32_32x32x16_bf16 v[64:79], v[12:15], v[28:31], v[64:79]
    s_add_u32 s88, s88, 147168
    v_lshrrev_b32 v40, 2, v1
    v_lshl_add_u32 v40, v40, 2, s88
    s_bitcmp1_b32 s77, 0
    s_cselect_b32 s89, 64, 0
    s_cselect_b32 s90, 0, 256
    ds_read_b128 v[12:15], v6 offset:160
    ds_read_b128 v[28:31], v6 offset:17056
    v_mfma_f32_32x32x16_bf16 v[64:79], v[16:19], v[32:35], v[64:79]
    v_and_b32 v41, 48, v1
    v_add3_u32 v41, v41, v40, s89
    v_add_u32 v40, s90, v40
    ds_read_b32 v46, v41 offset:0
    ds_read_b32 v47, v41 offset:16
    ds_read_b32 v48, v41 offset:128
    ds_read_b128 v[16:19], v6 offset:192
    ds_read_b128 v[32:35], v6 offset:17088
    s_waitcnt lgkmcnt(13)
    v_mfma_f32_32x32x16_bf16 v[64:79], v[20:23], v[36:39], v[64:79]
    ds_read_b32 v49, v41 offset:144
    ds_read_b32 v50, v40
    s_lshr_b32 s88, s28, 1
    s_lshl_b32 s88, s88, 6
    v_and_b32 v40, 48, v252
    ds_read_b128 v[20:23], v6 offset:224
    ds_read_b128 v[36:39], v6 offset:17120
    s_waitcnt lgkmcnt(11)
    v_mfma_f32_32x32x16_bf16 v[64:79], v[8:11], v[24:27], v[64:79]
    v_or_b32 v40, s88, v40
    v_add_u32 v236, v236, v251
    v_add_u32 v237, v237, v251
    v_add_u32 v238, v238, v251
    v_add_u32 v239, v239, v251
    v_add_u32 v240, v240, v251
    ds_read_b128 v[8:11], v6 offset:256
    ds_read_b128 v[24:27], v6 offset:17152
    s_waitcnt lgkmcnt(11)
    v_mfma_f32_32x32x16_bf16 v[64:79], v[12:15], v[28:31], v[64:79]
    v_add_u32 v241, v241, v251
    v_add_u32 v242, v242, v251
    v_add_u32 v243, v243, v251
    v_add_u32 v244, v244, v251
    v_add_u32 v245, v245, v251
    v_add_u32 v246, v246, v251
    ds_read_b128 v[12:15], v6 offset:288
    ds_read_b128 v[28:31], v6 offset:17184
    s_waitcnt lgkmcnt(8)
    v_mfma_f32_32x32x16_bf16 v[64:79], v[16:19], v[32:35], v[64:79]
    v_add_u32 v247, v247, v251
    v_xor_b32 v46, v46, v40
    v_xor_b32 v47, v47, v40
    v_xor_b32 v48, v48, v40
    s_waitcnt lgkmcnt(7)
    v_xor_b32 v49, v49, v40
    ds_read_b128 v[16:19], v6 offset:320
    ds_read_b128 v[32:35], v6 offset:17216
    s_waitcnt lgkmcnt(6)
    v_mfma_f32_32x32x16_bf16 v[64:79], v[20:23], v[36:39], v[64:79]
    v_xor_b32 v50, v50, v40
    v_accvgpr_write_b32 a244, v46
    v_accvgpr_write_b32 a245, v47
    v_accvgpr_write_b32 a246, v48
    v_accvgpr_write_b32 a247, v49
    v_accvgpr_write_b32 a248, v50
    ds_read_b128 v[20:23], v6 offset:352
    ds_read_b128 v[36:39], v6 offset:17248
    s_waitcnt lgkmcnt(6)
    v_mfma_f32_32x32x16_bf16 v[64:79], v[8:11], v[24:27], v[64:79]
    v_and_b32 v40, 3, v1
    v_bfe_u32 v41, v1, 2, 2
    v_lshrrev_b32 v42, 4, v1
    v_mul_u32_u24 v43, 1088, v40
    v_lshl_add_u32 v43, v41, 3, v43
    v_lshl_add_u32 v43, v42, 4, v43
    ds_read_b128 v[8:11], v6 offset:384
    ds_read_b128 v[24:27], v6 offset:17280
    s_waitcnt lgkmcnt(6)
    v_mfma_f32_32x32x16_bf16 v[64:79], v[12:15], v[28:31], v[64:79]
    v_and_b32 v44, 1, v41
    v_mul_u32_u24 v44, 4376, v44
    s_mov_b32 s88, 101376
    v_add3_u32 v201, v43, v44, s88
    v_sub_u32 v43, v40, v41
    ds_read_b128 v[12:15], v6 offset:416
    ds_read_b128 v[28:31], v6 offset:17312
    s_waitcnt lgkmcnt(6)
    v_mfma_f32_32x32x16_bf16 v[64:79], v[16:19], v[32:35], v[64:79]
    v_lshlrev_b32 v43, 3, v43
    v_lshlrev_b32 v44, 6, v42
    v_sub_u32 v43, v43, v44
    s_lshl_b32 s89, s28, 7
    s_add_u32 s88, s89, 110304
    v_add_u32 v202, s88, v43
    ds_read_b128 v[16:19], v6 offset:448
    ds_read_b128 v[32:35], v6 offset:17344
    s_waitcnt lgkmcnt(6)
    v_mfma_f32_32x32x16_bf16 v[64:79], v[20:23], v[36:39], v[64:79]
    v_and_b32 v43, 1, v41
    v_mul_u32_u24 v43, 4160, v43
    v_lshrrev_b32 v44, 3, v1
    v_lshl_add_u32 v43, v44, 4, v43
    v_lshl_add_u32 v43, v40, 2, v43
    s_add_u32 s88, s89, 89088
    ds_read_b128 v[20:23], v6 offset:480
    ds_read_b128 v[36:39], v6 offset:17376
    s_waitcnt lgkmcnt(6)
    v_mfma_f32_32x32x16_bf16 v[64:79], v[8:11], v[24:27], v[64:79]
    v_add_u32 v203, s88, v43
    v_add_u32 v204, 51936, v203
    v_lshlrev_b32 v43, 4, v0
    v_add_u32 v205, 89088, v43
    v_add_u32 v206, 141024, v43
    s_waitcnt lgkmcnt(4)
    v_mfma_f32_32x32x16_bf16 v[64:79], v[12:15], v[28:31], v[64:79]
    v_and_b32 v43, 7, v0
    v_cmp_eq_u32 vcc, 0, v43
    v_lshlrev_b32 v43, 2, v0
    s_nop 0
    v_cndmask_b32 v43, 0, v43, vcc
    v_add_u32 v207, 162752, v43
    s_lshl_b32 s88, s28, 5
    s_waitcnt lgkmcnt(2)
    v_mfma_f32_32x32x16_bf16 v[64:79], v[16:19], v[32:35], v[64:79]
    s_add_u32 s88, s88, 163040
    v_lshlrev_b32 v43, 2, v1
    v_sub_u32 v44, s88, v43
    v_and_b32 v43, 127, v43
    v_add_u32 v43, 149280, v43
    v_cmp_gt_u32 vcc, 61, v1
    s_waitcnt lgkmcnt(0)
    v_mfma_f32_32x32x16_bf16 v[64:79], v[20:23], v[36:39], v[64:79]
    v_cndmask_b32 v208, v44, v43, vcc
    s_mov_b32 s96, -1
    s_mov_b32 s97, 0x00ffffff
    s_mul_i32 s33, s28, 896
    s_lshl_b32 s34, s28, 12
    s_add_u32 s34, s34, 88960
    v_add_u32 v250, 32768, v252
    v_add_u32 v251, 65536, v252
    s_mov_b32 s98, 0x00003f80
    s_mov_b32 s99, 0x3f800000
    v_and_b32 v42, 3, v0
    v_and_b32 v43, 60, v0
    v_lshl_add_u32 v42, v42, 6, v43
    s_lshl_b32 s88, s28, 10
    s_add_u32 s88, s88, 110496
    v_add_u32 v42, s88, v42
    v_and_b32 v5, 1, v1
    v_cmp_eq_u32 vcc, 0, v5
    v_add_f32 v64, v64, v4
    v_cvt_pk_bf16_f32 v8, v64, v68
    v_cvt_pk_bf16_f32 v9, v65, v69
    v_cvt_pk_bf16_f32 v10, v66, v70
    v_cvt_pk_bf16_f32 v11, v67, v71
    v_cvt_pk_bf16_f32 v12, v72, v73
    v_cvt_pk_bf16_f32 v13, v72, v74
    v_cvt_pk_bf16_f32 v14, v73, v74
    v_cndmask_b32 v20, v76, v75, vcc
    v_cndmask_b32 v21, v78, v77, vcc
    v_cvt_pk_bf16_f32 v15, v75, v20
    v_cvt_pk_bf16_f32 v16, v75, v76
    v_cvt_pk_bf16_f32 v17, v77, v21
    v_cvt_pk_bf16_f32 v18, v77, v78
    ds_write_b32 v7, v8 offset:24
    ds_write_b32 v7, v8 offset:4400
    ds_write_b32 v7, v9 offset:1112
    ds_write_b32 v7, v9 offset:5488
    ds_write_b32 v7, v10 offset:2200
    ds_write_b32 v7, v10 offset:6576
    ds_write_b32 v7, v11 offset:3288
    ds_write_b32 v7, v11 offset:7664
    ds_write_b32 v7, v12 offset:280
    ds_write_b32 v7, v12 offset:4656
    ds_write_b32 v7, v12 offset:1368
    ds_write_b32 v7, v12 offset:5744
    ds_write_b32 v7, v13 offset:2456
    ds_write_b32 v7, v13 offset:6832
    ds_write_b32 v7, v14 offset:3544
    ds_write_b32 v7, v14 offset:7920
    ds_write_b32 v7, v15 offset:536
    ds_write_b32 v7, v15 offset:4912
    ds_write_b32 v7, v16 offset:1624
    ds_write_b32 v7, v16 offset:6000
    ds_write_b32 v7, v16 offset:2712
    ds_write_b32 v7, v16 offset:7088
    ds_write_b32 v7, v16 offset:3800
    ds_write_b32 v7, v16 offset:8176
    ds_write_b32 v7, v17 offset:792
    ds_write_b32 v7, v17 offset:5168
    ds_write_b32 v7, v18 offset:1880
    ds_write_b32 v7, v18 offset:6256
    ds_write_b32 v7, v18 offset:2968
    ds_write_b32 v7, v18 offset:7344
    ds_write_b32 v7, v18 offset:4056
    ds_write_b32 v7, v18 offset:8432
A_kd:
    s_cmp_eq_u32 s31, 0
    s_cbranch_scc1 A_ncs
    v_and_b32 v2, 3, v1
    s_cmp_eq_u32 s61, 0
    s_cselect_b32 s24, s12, s16
    s_cselect_b32 s25, s13, s17
    s_cselect_b32 s88, 0, 3712
    s_cselect_b32 s26, s14, s18
    s_cmp_lt_u32 s61, 2
    s_cselect_b32 s26, s26, 0
    s_mov_b32 s27, 0x00020000
    s_add_u32 s88, s88, s60
    s_mul_i32 s89, s28, 55296
    s_add_u32 s88, s88, s89
    v_lshrrev_b32 v5, 2, v1
    v_mul_u32_u24 v5, 3456, v5
    v_lshl_add_u32 v5, v2, 4, v5
    v_add_u32 v209, s88, v5
    v_and_b32 v5, 1, v1
    v_lshlrev_b32 v5, 4, v5
    v_mov_b32 v6, 0x3f80
    v_lshlrev_b32 v5, v5, v6
    v_bfe_u32 v6, v1, 1, 2
    v_cmp_eq_u32 vcc, 0, v6
    s_nop 1
    v_cndmask_b32 v212, 0, v5, vcc
    v_cmp_eq_u32 vcc, 1, v6
    s_nop 1
    v_cndmask_b32 v213, 0, v5, vcc
    v_cmp_eq_u32 vcc, 2, v6
    s_nop 1
    v_cndmask_b32 v214, 0, v5, vcc
    v_cmp_eq_u32 vcc, 3, v6
    s_nop 1
    v_cndmask_b32 v215, 0, v5, vcc
A_ncs:
A_chk:
    s_waitcnt vmcnt(7)
    v_lshlrev_b32 v184, 16, v114
    v_and_b32 v185, 0xffff0000, v114
    v_dot2_f32_bf16 v152, v96, s98, v184
    v_dot2_f32_bf16 v153, v96, s99, v185
    v_dot2_f32_bf16 v160, v97, s98, v184
    v_dot2_f32_bf16 v161, v97, s99, v185
    v_dot2_f32_bf16 v168, v98, s98, v184
    v_dot2_f32_bf16 v169, v98, s99, v185
    v_min_u32 v2, v99, v115
    v_max_u32 v3, v99, v115
    v_pk_mul_f32 v[152:153], v[152:153], v[112:113]
    v_pk_mul_f32 v[160:161], v[160:161], v[112:113]
    v_pk_mul_f32 v[168:169], v[168:169], v[112:113]
    v_cvt_pk_bf16_f32 v152, v152, v153
    v_cvt_pk_bf16_f32 v160, v160, v161
    v_cvt_pk_bf16_f32 v168, v168, v169
    ds_write_b32 v42, v96 offset:39840
    ds_write_b32 v42, v97 offset:43936
    ds_write_b32 v42, v98 offset:48032
    ds_write_b32 v42, v152 offset:0
    ds_write_b32 v42, v160 offset:13216
    ds_write_b32 v42, v168 offset:26432
    s_waitcnt vmcnt(5)
    v_lshlrev_b32 v186, 16, v118
    v_and_b32 v187, 0xffff0000, v118
    v_dot2_f32_bf16 v154, v100, s98, v186
    v_dot2_f32_bf16 v155, v100, s99, v187
    v_dot2_f32_bf16 v162, v101, s98, v186
    v_dot2_f32_bf16 v163, v101, s99, v187
    v_dot2_f32_bf16 v170, v102, s98, v186
    v_dot2_f32_bf16 v171, v102, s99, v187
    v_min3_u32 v2, v2, v103, v119
    v_max3_u32 v3, v3, v103, v119
    v_pk_mul_f32 v[154:155], v[154:155], v[116:117]
    v_pk_mul_f32 v[162:163], v[162:163], v[116:117]
    v_pk_mul_f32 v[170:171], v[170:171], v[116:117]
    v_cvt_pk_bf16_f32 v154, v154, v155
    v_cvt_pk_bf16_f32 v162, v162, v163
    v_cvt_pk_bf16_f32 v170, v170, v171
    ds_write_b32 v42, v100 offset:40096
    ds_write_b32 v42, v101 offset:44192
    ds_write_b32 v42, v102 offset:48288
    ds_write_b32 v42, v154 offset:256
    ds_write_b32 v42, v162 offset:13472
    ds_write_b32 v42, v170 offset:26688
    s_waitcnt vmcnt(3)
    v_lshlrev_b32 v188, 16, v122
    v_and_b32 v189, 0xffff0000, v122
    v_dot2_f32_bf16 v156, v104, s98, v188
    v_dot2_f32_bf16 v157, v104, s99, v189
    v_dot2_f32_bf16 v164, v105, s98, v188
    v_dot2_f32_bf16 v165, v105, s99, v189
    v_dot2_f32_bf16 v172, v106, s98, v188
    v_dot2_f32_bf16 v173, v106, s99, v189
    v_min3_u32 v2, v2, v107, v123
    v_max3_u32 v3, v3, v107, v123
    v_pk_mul_f32 v[156:157], v[156:157], v[120:121]
    v_pk_mul_f32 v[164:165], v[164:165], v[120:121]
    v_pk_mul_f32 v[172:173], v[172:173], v[120:121]
    v_cvt_pk_bf16_f32 v156, v156, v157
    v_cvt_pk_bf16_f32 v164, v164, v165
    v_cvt_pk_bf16_f32 v172, v172, v173
    ds_write_b32 v42, v104 offset:40352
    ds_write_b32 v42, v105 offset:44448
    ds_write_b32 v42, v106 offset:48544
    ds_write_b32 v42, v156 offset:512
    ds_write_b32 v42, v164 offset:13728
    ds_write_b32 v42, v172 offset:26944
    s_waitcnt vmcnt(1)
    v_lshlrev_b32 v190, 16, v126
    v_and_b32 v191, 0xffff0000, v126
    v_dot2_f32_bf16 v158, v108, s98, v190
    v_dot2_f32_bf16 v159, v108, s99, v191
    v_dot2_f32_bf16 v166, v109, s98, v190
    v_dot2_f32_bf16 v167, v109, s99, v191
    v_dot2_f32_bf16 v174, v110, s98, v190
    v_dot2_f32_bf16 v175, v110, s99, v191
    v_min3_u32 v2, v2, v111, v127
    v_max3_u32 v3, v3, v111, v127
    v_pk_mul_f32 v[158:159], v[158:159], v[124:125]
    v_pk_mul_f32 v[166:167], v[166:167], v[124:125]
    v_pk_mul_f32 v[174:175], v[174:175], v[124:125]
    v_cmp_ne_u32 vcc, s29, v2
    v_cmp_ne_u32 s[88:89], s29, v3
    v_cvt_pk_bf16_f32 v158, v158, v159
    v_cvt_pk_bf16_f32 v166, v166, v167
    v_cvt_pk_bf16_f32 v174, v174, v175
    ds_write_b32 v42, v108 offset:40608
    ds_write_b32 v42, v109 offset:44704
    ds_write_b32 v42, v110 offset:48800
    ds_write_b32 v42, v158 offset:768
    ds_write_b32 v42, v166 offset:13984
    ds_write_b32 v42, v174 offset:27200
    s_or_b64 vcc, vcc, s[88:89]
    s_cbranch_vccnz A_retry
A_ok:
    s_waitcnt lgkmcnt(0)
    s_barrier
    s_cmp_eq_u32 s31, 1
    s_cbranch_scc1 B_D
    ds_read_b128 v[72:75], v201 offset:0
    ds_read_b64_tr_b16 a[4:5], v202 offset:288
    ds_read_b64_tr_b16 a[6:7], v202 offset:256
    ds_read_b64_tr_b16 a[12:13], v202 offset:800
    ds_read_b64_tr_b16 a[14:15], v202 offset:768
    ds_read_b64_tr_b16 a[20:21], v202 offset:1312
    ds_read_b64_tr_b16 a[22:23], v202 offset:1280
    ds_read_b64_tr_b16 a[28:29], v202 offset:1824
    ds_read_b64_tr_b16 a[30:31], v202 offset:1792
    ds_read_b128 v[76:79], v201 offset:64
    ds_read_b64_tr_b16 a[36:37], v202 offset:2336
    ds_read_b64_tr_b16 a[38:39], v202 offset:2304
    ds_read_b64_tr_b16 a[44:45], v202 offset:2848
    ds_read_b64_tr_b16 a[46:47], v202 offset:2816
    s_waitcnt lgkmcnt(11)
    v_mfma_f32_16x16x32_bf16 v[8:11], v[72:75], a[4:7], 0
    ds_read_b64_tr_b16 a[52:53], v202 offset:3360
    ds_read_b64_tr_b16 a[54:55], v202 offset:3328
    s_waitcnt lgkmcnt(11)
    v_mfma_f32_16x16x32_bf16 v[12:15], v[72:75], a[12:15], 0
    ds_read_b64_tr_b16 a[60:61], v202 offset:3872
    ds_read_b64_tr_b16 a[62:63], v202 offset:3840
    s_waitcnt lgkmcnt(11)
    v_mfma_f32_16x16x32_bf16 v[16:19], v[72:75], a[20:23], 0
    ds_read_b64_tr_b16 a[0:1], v202 offset:32
    ds_read_b64_tr_b16 a[2:3], v202 offset:0
    s_waitcnt lgkmcnt(11)
    v_mfma_f32_16x16x32_bf16 v[20:23], v[72:75], a[28:31], 0
    ds_read_b64_tr_b16 a[8:9], v202 offset:544
    ds_read_b64_tr_b16 a[10:11], v202 offset:512
    s_waitcnt lgkmcnt(10)
    v_mfma_f32_16x16x32_bf16 v[24:27], v[72:75], a[36:39], 0
    ds_read_b64_tr_b16 a[16:17], v202 offset:1056
    ds_read_b64_tr_b16 a[18:19], v202 offset:1024
    s_waitcnt lgkmcnt(10)
    v_mfma_f32_16x16x32_bf16 v[28:31], v[72:75], a[44:47], 0
    ds_read_b64_tr_b16 a[24:25], v202 offset:1568
    ds_read_b64_tr_b16 a[26:27], v202 offset:1536
    s_waitcnt lgkmcnt(10)
    v_mfma_f32_16x16x32_bf16 v[32:35], v[72:75], a[52:55], 0
    ds_read_b64_tr_b16 a[32:33], v202 offset:2080
    ds_read_b64_tr_b16 a[34:35], v202 offset:2048
    s_waitcnt lgkmcnt(10)
    v_mfma_f32_16x16x32_bf16 v[36:39], v[72:75], a[60:63], 0
    ds_read_b64_tr_b16 a[40:41], v202 offset:2592
    ds_read_b64_tr_b16 a[42:43], v202 offset:2560
    s_waitcnt lgkmcnt(10)
    v_mfma_f32_16x16x32_bf16 v[8:11], v[76:79], a[0:3], v[8:11]
    ds_read_b64_tr_b16 a[48:49], v202 offset:3104
    ds_read_b64_tr_b16 a[50:51], v202 offset:3072
    s_waitcnt lgkmcnt(10)
    v_mfma_f32_16x16x32_bf16 v[12:15], v[76:79], a[8:11], v[12:15]
    ds_read_b64_tr_b16 a[56:57], v202 offset:3616
    ds_read_b64_tr_b16 a[58:59], v202 offset:3584
    ds_read_b128 v[80:83], v201 offset:128
    s_waitcnt lgkmcnt(11)
    v_mfma_f32_16x16x32_bf16 v[16:19], v[76:79], a[16:19], v[16:19]
    s_add_u32 m0, s33, 0
    s_nop 0
    buffer_load_dwordx4 v236, s[12:15], 0 offen lds
    s_waitcnt lgkmcnt(9)
    v_mfma_f32_16x16x32_bf16 v[20:23], v[76:79], a[24:27], v[20:23]
    ds_read_b128 v[84:87], v201 offset:192
    v_add_f32_dpp v10, v11, v10 wave_shr:1 row_mask:0xf bank_mask:0xf bound_ctrl:0
    s_waitcnt lgkmcnt(8)
    v_mfma_f32_16x16x32_bf16 v[24:27], v[76:79], a[32:35], v[24:27]
    ds_read_b64_tr_b16 a[68:69], v202 offset:13504
    s_waitcnt lgkmcnt(7)
    v_mfma_f32_16x16x32_bf16 v[28:31], v[76:79], a[40:43], v[28:31]
    v_add_f32_dpp v9, v10, v9 wave_shr:1 row_mask:0xf bank_mask:0xf bound_ctrl:0
    ds_read_b64_tr_b16 a[70:71], v202 offset:13472
    s_waitcnt lgkmcnt(6)
    v_mfma_f32_16x16x32_bf16 v[32:35], v[76:79], a[48:51], v[32:35]
    ds_read_b128 v[88:91], v201 offset:256
    s_waitcnt lgkmcnt(5)
    v_mfma_f32_16x16x32_bf16 v[36:39], v[76:79], a[56:59], v[36:39]
    v_add_f32_dpp v8, v9, v8 wave_shr:1 row_mask:0xf bank_mask:0xf bound_ctrl:0
    v_mov_b32_dpp v9, v10 row_shl:1 row_mask:0xf bank_mask:0xf
    s_waitcnt lgkmcnt(4)
    v_mfma_f32_16x16x32_bf16 v[12:15], v[80:83], a[4:7], v[12:15]
    ds_write_b32 v203, v8 offset:0
    v_mfma_f32_16x16x32_bf16 v[16:19], v[80:83], a[12:15], v[16:19]
    buffer_load_dwordx4 v236, s[16:19], 0 offen offset:3712 lds
    v_mfma_f32_16x16x32_bf16 v[20:23], v[80:83], a[20:23], v[20:23]
    v_mov_b32_dpp v9, v11 row_shl:2 row_mask:0xf bank_mask:0xf
    ds_read_b64_tr_b16 a[76:77], v202 offset:14016
    v_mfma_f32_16x16x32_bf16 v[24:27], v[80:83], a[28:31], v[24:27]
    ds_write_b32 v208, v9 offset:0
    v_mfma_f32_16x16x32_bf16 v[28:31], v[80:83], a[36:39], v[28:31]
    ds_read_b128 v[128:131], v206 offset:9312
    v_mfma_f32_16x16x32_bf16 v[32:35], v[80:83], a[44:47], v[32:35]
    ds_read_b128 v[92:95], v201 offset:320
    v_mfma_f32_16x16x32_bf16 v[36:39], v[80:83], a[52:55], v[36:39]
    ds_read_b64_tr_b16 a[78:79], v202 offset:13984
    s_waitcnt lgkmcnt(9)
    v_mfma_f32_16x16x32_bf16 v[12:15], v[84:87], a[0:3], v[12:15]
    ds_read_b64_tr_b16 a[84:85], v202 offset:14528
    v_mfma_f32_16x16x32_bf16 v[16:19], v[84:87], a[8:11], v[16:19]
    ds_read_b128 v[132:135], v206 offset:13408
    v_mfma_f32_16x16x32_bf16 v[20:23], v[84:87], a[16:19], v[20:23]
    s_add_u32 m0, s33, 7424
    s_nop 0
    buffer_load_dwordx4 v237, s[12:15], 0 offen lds
    v_mfma_f32_16x16x32_bf16 v[24:27], v[84:87], a[24:27], v[24:27]
    ds_read_b128 v[96:99], v201 offset:384
    v_add_f32_dpp v14, v15, v14 wave_shr:1 row_mask:0xf bank_mask:0xf bound_ctrl:0
    v_mfma_f32_16x16x32_bf16 v[28:31], v[84:87], a[32:35], v[28:31]
    ds_read_b64_tr_b16 a[86:87], v202 offset:14496
    v_mfma_f32_16x16x32_bf16 v[32:35], v[84:87], a[40:43], v[32:35]
    ds_read_b128 v[136:139], v206 offset:17504
    v_add_f32_dpp v13, v14, v13 wave_shr:1 row_mask:0xf bank_mask:0xf bound_ctrl:0
    v_mfma_f32_16x16x32_bf16 v[36:39], v[84:87], a[48:51], v[36:39]
    ds_read_b64_tr_b16 a[92:93], v202 offset:15040
    s_waitcnt lgkmcnt(12)
    v_mfma_f32_16x16x32_bf16 v[16:19], v[88:91], a[4:7], v[16:19]
    v_add_f32_dpp v12, v13, v12 wave_shr:1 row_mask:0xf bank_mask:0xf bound_ctrl:0
    v_mov_b32_dpp v13, v14 row_shl:1 row_mask:0xf bank_mask:0xf
    v_mfma_f32_16x16x32_bf16 v[20:23], v[88:91], a[12:15], v[20:23]
    ds_read_b128 v[100:103], v201 offset:448
    v_mfma_f32_16x16x32_bf16 v[24:27], v[88:91], a[20:23], v[24:27]
    ds_write_b32 v203, v12 offset:512
    v_mov_b32_dpp v13, v15 row_shl:2 row_mask:0xf bank_mask:0xf
    v_mfma_f32_16x16x32_bf16 v[28:31], v[88:91], a[28:31], v[28:31]
    buffer_load_dwordx4 v237, s[16:19], 0 offen offset:3712 lds
    v_mfma_f32_16x16x32_bf16 v[32:35], v[88:91], a[36:39], v[32:35]
    ds_write_b32 v208, v13 offset:128
    v_mfma_f32_16x16x32_bf16 v[36:39], v[88:91], a[44:47], v[36:39]
    ds_read_b64_tr_b16 a[94:95], v202 offset:15008
    s_waitcnt lgkmcnt(11)
    v_mfma_f32_16x16x32_bf16 v[16:19], v[92:95], a[0:3], v[16:19]
    ds_read_b128 v[72:75], v201 offset:512
    v_mfma_f32_16x16x32_bf16 v[20:23], v[92:95], a[8:11], v[20:23]
    ds_read_b64_tr_b16 a[100:101], v202 offset:15552
    v_mfma_f32_16x16x32_bf16 v[24:27], v[92:95], a[16:19], v[24:27]
    ds_read_b64_tr_b16 a[102:103], v202 offset:15520
    v_mfma_f32_16x16x32_bf16 v[28:31], v[92:95], a[24:27], v[28:31]
    s_nop 1
    v_add_f32_dpp v18, v19, v18 wave_shr:1 row_mask:0xf bank_mask:0xf bound_ctrl:0
    ds_read_b64_tr_b16 a[108:109], v202 offset:16064
    v_mfma_f32_16x16x32_bf16 v[32:35], v[92:95], a[32:35], v[32:35]
    ds_read_b128 v[76:79], v201 offset:576
    v_mfma_f32_16x16x32_bf16 v[36:39], v[92:95], a[40:43], v[36:39]
    s_add_u32 m0, s33, 14848
    s_nop 0
    buffer_load_dwordx4 v238, s[12:15], 0 offen lds
    s_waitcnt lgkmcnt(12)
    v_mfma_f32_16x16x32_bf16 v[20:23], v[96:99], a[4:7], v[20:23]
    v_add_f32_dpp v17, v18, v17 wave_shr:1 row_mask:0xf bank_mask:0xf bound_ctrl:0
    ds_read_b64_tr_b16 a[110:111], v202 offset:16032
    v_mfma_f32_16x16x32_bf16 v[24:27], v[96:99], a[12:15], v[24:27]
    ds_read_b64_tr_b16 a[116:117], v202 offset:16576
    v_mfma_f32_16x16x32_bf16 v[28:31], v[96:99], a[20:23], v[28:31]
    ds_read_b128 v[80:83], v201 offset:640
    v_add_f32_dpp v16, v17, v16 wave_shr:1 row_mask:0xf bank_mask:0xf bound_ctrl:0
    v_mfma_f32_16x16x32_bf16 v[32:35], v[96:99], a[28:31], v[32:35]
    ds_write_b32 v203, v16 offset:1024
    v_mov_b32_dpp v17, v18 row_shl:1 row_mask:0xf bank_mask:0xf
    v_mfma_f32_16x16x32_bf16 v[36:39], v[96:99], a[36:39], v[36:39]
    ds_read_b64_tr_b16 a[118:119], v202 offset:16544
    ds_read_b64_tr_b16 a[80:81], v202 offset:14272
    s_waitcnt lgkmcnt(14)
    v_mfma_f32_16x16x32_bf16 v[20:23], v[100:103], a[0:3], v[20:23]
    ds_read_b128 v[84:87], v201 offset:704
    v_mov_b32_dpp v17, v19 row_shl:2 row_mask:0xf bank_mask:0xf
    v_mfma_f32_16x16x32_bf16 v[24:27], v[100:103], a[8:11], v[24:27]
    buffer_load_dwordx4 v238, s[16:19], 0 offen offset:3712 lds
    ds_read_b64_tr_b16 a[82:83], v202 offset:14240
    v_mfma_f32_16x16x32_bf16 v[28:31], v[100:103], a[16:19], v[28:31]
    ds_write_b32 v208, v17 offset:256
    ds_read_b64_tr_b16 a[88:89], v202 offset:14784
    v_mfma_f32_16x16x32_bf16 v[32:35], v[100:103], a[24:27], v[32:35]
    ds_read_b128 v[88:91], v201 offset:768
    v_add_f32_dpp v22, v23, v22 wave_shr:1 row_mask:0xf bank_mask:0xf bound_ctrl:0
    v_mfma_f32_16x16x32_bf16 v[36:39], v[100:103], a[32:35], v[36:39]
    ds_read_b64_tr_b16 a[124:125], v202 offset:17088
    ds_read_b64_tr_b16 a[90:91], v202 offset:14752
    s_waitcnt lgkmcnt(15)
    v_mfma_f32_16x16x32_bf16 v[24:27], v[72:75], a[4:7], v[24:27]
    ds_read_b128 v[92:95], v201 offset:832
    v_add_f32_dpp v21, v22, v21 wave_shr:1 row_mask:0xf bank_mask:0xf bound_ctrl:0
    v_mfma_f32_16x16x32_bf16 v[28:31], v[72:75], a[12:15], v[28:31]
    ds_read_b64_tr_b16 a[126:127], v202 offset:17056
    ds_read_b64_tr_b16 a[96:97], v202 offset:15296
    v_mfma_f32_16x16x32_bf16 v[32:35], v[72:75], a[20:23], v[32:35]
    ds_read_b128 v[96:99], v201 offset:896
    v_add_f32_dpp v20, v21, v20 wave_shr:1 row_mask:0xf bank_mask:0xf bound_ctrl:0
    v_mfma_f32_16x16x32_bf16 v[36:39], v[72:75], a[28:31], v[36:39]
    ds_read_b128 v[100:103], v201 offset:960
    v_mov_b32_dpp v21, v22 row_shl:1 row_mask:0xf bank_mask:0xf
    s_waitcnt lgkmcnt(15)
    v_mfma_f32_16x16x32_bf16 v[24:27], v[76:79], a[0:3], v[24:27]
    s_add_u32 m0, s33, 22272
    s_nop 0
    buffer_load_dwordx4 v239, s[12:15], 0 offen lds
    ds_read_b64_tr_b16 a[98:99], v202 offset:15264
    v_mfma_f32_16x16x32_bf16 v[28:31], v[76:79], a[8:11], v[28:31]
    ds_read_b128 v[72:75], v201 offset:13216
    v_mov_b32_dpp v21, v23 row_shl:2 row_mask:0xf bank_mask:0xf
    v_mfma_f32_16x16x32_bf16 v[32:35], v[76:79], a[16:19], v[32:35]
    ds_write_b32 v203, v20 offset:1536
    ds_read_b64_tr_b16 a[104:105], v202 offset:15808
    v_mfma_f32_16x16x32_bf16 v[36:39], v[76:79], a[24:27], v[36:39]
    ds_write_b32 v208, v21 offset:384
    v_add_f32_dpp v26, v27, v26 wave_shr:1 row_mask:0xf bank_mask:0xf bound_ctrl:0
    v_mfma_f32_16x16x32_bf16 v[28:31], v[80:83], a[4:7], v[28:31]
    ds_read_b64_tr_b16 a[64:65], v202 offset:13248
    ds_read_b64_tr_b16 a[106:107], v202 offset:15776
    ds_read_b64_tr_b16 a[120:121], v202 offset:16832
    v_mfma_f32_16x16x32_bf16 v[32:35], v[80:83], a[12:15], v[32:35]
    v_add_f32_dpp v25, v26, v25 wave_shr:1 row_mask:0xf bank_mask:0xf bound_ctrl:0
    ds_read_b64_tr_b16 a[66:67], v202 offset:13216
    v_mfma_f32_16x16x32_bf16 v[36:39], v[80:83], a[20:23], v[36:39]
    ds_read_b64_tr_b16 a[72:73], v202 offset:13760
    ds_read_b64_tr_b16 a[112:113], v202 offset:16320
    ds_read_b64_tr_b16 a[122:123], v202 offset:16800
    s_waitcnt lgkmcnt(15)
    v_mfma_f32_16x16x32_bf16 v[28:31], v[84:87], a[0:3], v[28:31]
    v_add_f32_dpp v24, v25, v24 wave_shr:1 row_mask:0xf bank_mask:0xf bound_ctrl:0
    v_mov_b32_dpp v25, v26 row_shl:1 row_mask:0xf bank_mask:0xf
    ds_read_b64_tr_b16 a[74:75], v202 offset:13728
    v_mfma_f32_16x16x32_bf16 v[32:35], v[84:87], a[8:11], v[32:35]
    buffer_load_dwordx4 v239, s[16:19], 0 offen offset:3712 lds
    ds_read_b64_tr_b16 a[114:115], v202 offset:16288
    v_mfma_f32_16x16x32_bf16 v[36:39], v[84:87], a[16:19], v[36:39]
    ds_read_b128 v[76:79], v201 offset:13280
    v_mov_b32_dpp v25, v27 row_shl:2 row_mask:0xf bank_mask:0xf
    v_mfma_f32_16x16x32_bf16 v[32:35], v[88:91], a[4:7], v[32:35]
    ds_write_b32 v203, v24 offset:2048
    v_add_f32_dpp v30, v31, v30 wave_shr:1 row_mask:0xf bank_mask:0xf bound_ctrl:0
    v_mfma_f32_16x16x32_bf16 v[36:39], v[88:91], a[12:15], v[36:39]
    ds_write_b32 v208, v25 offset:512
    v_mfma_f32_16x16x32_bf16 v[32:35], v[92:95], a[0:3], v[32:35]
    v_add_f32_dpp v29, v30, v29 wave_shr:1 row_mask:0xf bank_mask:0xf bound_ctrl:0
    v_mfma_f32_16x16x32_bf16 v[36:39], v[92:95], a[8:11], v[36:39]
    s_waitcnt lgkmcnt(15)
    v_mfma_f32_16x16x32_bf16 v[36:39], v[96:99], a[4:7], v[36:39]
    v_add_f32_dpp v28, v29, v28 wave_shr:1 row_mask:0xf bank_mask:0xf bound_ctrl:0
    v_mov_b32_dpp v29, v30 row_shl:1 row_mask:0xf bank_mask:0xf
    v_mfma_f32_16x16x32_bf16 v[36:39], v[100:103], a[0:3], v[36:39]
    ds_write_b32 v203, v28 offset:2560
    v_add_f32_dpp v34, v35, v34 wave_shr:1 row_mask:0xf bank_mask:0xf bound_ctrl:0
    v_mfma_f32_16x16x32_bf16 v[40:43], v[72:75], a[68:71], 0
    s_add_u32 m0, s33, 29696
    s_nop 0
    buffer_load_dwordx4 v240, s[12:15], 0 offen lds
    v_mfma_f32_16x16x32_bf16 v[44:47], v[72:75], a[76:79], 0
    ds_read_b128 v[80:83], v201 offset:13344
    v_mov_b32_dpp v29, v31 row_shl:2 row_mask:0xf bank_mask:0xf
    v_mfma_f32_16x16x32_bf16 v[48:51], v[72:75], a[84:87], 0
    ds_write_b32 v208, v29 offset:640
    v_add_f32_dpp v33, v34, v33 wave_shr:1 row_mask:0xf bank_mask:0xf bound_ctrl:0
    v_mfma_f32_16x16x32_bf16 v[52:55], v[72:75], a[92:95], 0
    v_add_f32_dpp v38, v39, v38 wave_shr:1 row_mask:0xf bank_mask:0xf bound_ctrl:0
    ds_read_b64_tr_b16 a[4:5], v202 offset:26720
    v_mfma_f32_16x16x32_bf16 v[56:59], v[72:75], a[100:103], 0
    v_add_f32_dpp v32, v33, v32 wave_shr:1 row_mask:0xf bank_mask:0xf bound_ctrl:0
    v_mov_b32_dpp v33, v34 row_shl:1 row_mask:0xf bank_mask:0xf
    v_mfma_f32_16x16x32_bf16 v[60:63], v[72:75], a[108:111], 0
    ds_write_b32 v203, v32 offset:3072
    v_add_f32_dpp v37, v38, v37 wave_shr:1 row_mask:0xf bank_mask:0xf bound_ctrl:0
    v_mfma_f32_16x16x32_bf16 v[64:67], v[72:75], a[116:119], 0
    v_mov_b32_dpp v33, v35 row_shl:2 row_mask:0xf bank_mask:0xf
    ds_read_b64_tr_b16 a[6:7], v202 offset:26688
    v_mfma_f32_16x16x32_bf16 v[68:71], v[72:75], a[124:127], 0
    buffer_load_dwordx4 v240, s[16:19], 0 offen offset:3712 lds
    s_waitcnt lgkmcnt(8)
    v_mfma_f32_16x16x32_bf16 v[40:43], v[76:79], a[64:67], v[40:43]
    ds_read_b128 v[84:87], v201 offset:13408
    v_add_f32_dpp v36, v37, v36 wave_shr:1 row_mask:0xf bank_mask:0xf bound_ctrl:0
    v_mfma_f32_16x16x32_bf16 v[44:47], v[76:79], a[72:75], v[44:47]
    ds_write_b32 v208, v33 offset:768
    v_mov_b32_dpp v37, v38 row_shl:1 row_mask:0xf bank_mask:0xf
    v_mfma_f32_16x16x32_bf16 v[48:51], v[76:79], a[80:83], v[48:51]
    ds_write_b32 v203, v36 offset:3584
    v_mfma_f32_16x16x32_bf16 v[52:55], v[76:79], a[88:91], v[52:55]
    v_mov_b32_dpp v37, v39 row_shl:2 row_mask:0xf bank_mask:0xf
    v_add_f32_dpp v42, v43, v42 wave_shr:1 row_mask:0xf bank_mask:0xf bound_ctrl:0
    v_mfma_f32_16x16x32_bf16 v[56:59], v[76:79], a[96:99], v[56:59]
    ds_write_b32 v208, v37 offset:896
    v_mfma_f32_16x16x32_bf16 v[60:63], v[76:79], a[104:107], v[60:63]
    v_add_f32_dpp v41, v42, v41 wave_shr:1 row_mask:0xf bank_mask:0xf bound_ctrl:0
    ds_read_b64_tr_b16 a[12:13], v202 offset:27232
    v_mfma_f32_16x16x32_bf16 v[64:67], v[76:79], a[112:115], v[64:67]
    ds_read_b128 v[88:91], v201 offset:13472
    v_mfma_f32_16x16x32_bf16 v[68:71], v[76:79], a[120:123], v[68:71]
    s_add_u32 m0, s33, 37120
    s_nop 0
    buffer_load_dwordx4 v241, s[12:15], 0 offen lds
    s_waitcnt lgkmcnt(10)
    v_mfma_f32_16x16x32_bf16 v[44:47], v[80:83], a[68:71], v[44:47]
    s_waitcnt lgkmcnt(2)
    s_barrier
    v_mfma_f32_16x16x32_bf16 v[48:51], v[80:83], a[76:79], v[48:51]
    ds_read_b128 v[104:107], v205 offset:0
    v_add_f32_dpp v40, v41, v40 wave_shr:1 row_mask:0xf bank_mask:0xf bound_ctrl:0
    v_mfma_f32_16x16x32_bf16 v[52:55], v[80:83], a[84:87], v[52:55]
    ds_read_b128 v[112:115], v207 offset:0
    v_mov_b32_dpp v41, v42 row_shl:1 row_mask:0xf bank_mask:0xf
    v_mfma_f32_16x16x32_bf16 v[56:59], v[80:83], a[92:95], v[56:59]
    ds_read_b128 v[108:111], v205 offset:4160
    v_mfma_f32_16x16x32_bf16 v[60:63], v[80:83], a[100:103], v[60:63]
    ds_read_b128 v[92:95], v201 offset:13536
    v_mov_b32_dpp v41, v43 row_shl:2 row_mask:0xf bank_mask:0xf
    v_mfma_f32_16x16x32_bf16 v[64:67], v[80:83], a[108:111], v[64:67]
    ds_write_b32 v204, v40 offset:0
    v_mfma_f32_16x16x32_bf16 v[68:71], v[80:83], a[116:119], v[68:71]
    ds_write_b32 v208, v41 offset:16
    v_mfma_f32_16x16x32_bf16 v[44:47], v[84:87], a[64:67], v[44:47]
    buffer_load_dwordx4 v241, s[16:19], 0 offen offset:3712 lds
    v_mfma_f32_16x16x32_bf16 v[48:51], v[84:87], a[72:75], v[48:51]
    ds_read_b64_tr_b16 a[14:15], v202 offset:27200
    v_mfma_f32_16x16x32_bf16 v[52:55], v[84:87], a[80:83], v[52:55]
    s_waitcnt lgkmcnt(6)
    v_dot2_f32_bf16 v104, v128, s98, v104
    v_dot2_f32_bf16 v105, v128, s99, v105
    ds_read_b64_tr_b16 a[46:47], v202 offset:29248
    v_mfma_f32_16x16x32_bf16 v[56:59], v[84:87], a[88:91], v[56:59]
    ds_read_b128 v[96:99], v201 offset:13600
    v_dot2_f32_bf16 v106, v129, s98, v106
    v_mfma_f32_16x16x32_bf16 v[60:63], v[84:87], a[96:99], v[60:63]
    v_dot2_f32_bf16 v107, v129, s99, v107
    s_waitcnt lgkmcnt(6)
    v_dot2_f32_bf16 v108, v130, s98, v108
    ds_read_b64_tr_b16 a[52:53], v202 offset:29792
    v_mfma_f32_16x16x32_bf16 v[64:67], v[84:87], a[104:107], v[64:67]
    v_dot2_f32_bf16 v109, v130, s99, v109
    v_dot2_f32_bf16 v110, v131, s98, v110
    ds_read_b64_tr_b16 a[54:55], v202 offset:29760
    v_mfma_f32_16x16x32_bf16 v[68:71], v[84:87], a[112:115], v[68:71]
    v_dot2_f32_bf16 v111, v131, s99, v111
    v_add_f32 v104, v104, v113
    ds_read_b64_tr_b16 a[60:61], v202 offset:30304
    v_mfma_f32_16x16x32_bf16 v[48:51], v[88:91], a[68:71], v[48:51]
    v_add_f32 v105, v105, v114
    v_add_f32 v106, v106, v115
    ds_read_b64_tr_b16 a[62:63], v202 offset:30272
    v_mfma_f32_16x16x32_bf16 v[52:55], v[88:91], a[76:79], v[52:55]
    s_add_u32 m0, s33, 44544
    s_nop 0
    buffer_load_dwordx4 v242, s[12:15], 0 offen lds
    v_mfma_f32_16x16x32_bf16 v[56:59], v[88:91], a[84:87], v[56:59]
    ds_read_b128 v[100:103], v201 offset:13664
    v_cvt_pk_bf16_f32 v116, v104, v105
    v_mfma_f32_16x16x32_bf16 v[60:63], v[88:91], a[92:95], v[60:63]
    v_cvt_pk_bf16_f32 v117, v106, v107
    v_cvt_pk_bf16_f32 v118, v108, v109
    ds_read_b64_tr_b16 a[0:1], v202 offset:26464
    v_mfma_f32_16x16x32_bf16 v[64:67], v[88:91], a[100:103], v[64:67]
    v_cvt_pk_bf16_f32 v119, v110, v111
    v_add_f32_dpp v46, v47, v46 wave_shr:1 row_mask:0xf bank_mask:0xf bound_ctrl:0
    ds_read_b64_tr_b16 a[2:3], v202 offset:26432
    v_mfma_f32_16x16x32_bf16 v[68:71], v[88:91], a[108:111], v[68:71]
    buffer_store_dwordx4 v[116:119], v254, s[4:7], s68 offen sc1
    s_waitcnt lgkmcnt(12)
    v_mfma_f32_16x16x32_bf16 v[48:51], v[92:95], a[64:67], v[48:51]
    ds_read_b128 v[72:75], v201 offset:13728
    v_add_f32_dpp v45, v46, v45 wave_shr:1 row_mask:0xf bank_mask:0xf bound_ctrl:0
    v_mfma_f32_16x16x32_bf16 v[52:55], v[92:95], a[72:75], v[52:55]
    ds_read_b64_tr_b16 a[20:21], v202 offset:27744
    v_mfma_f32_16x16x32_bf16 v[56:59], v[92:95], a[80:83], v[56:59]
    buffer_load_dwordx4 v242, s[16:19], 0 offen offset:3712 lds
    v_mfma_f32_16x16x32_bf16 v[60:63], v[92:95], a[88:91], v[60:63]
    v_add_f32_dpp v44, v45, v44 wave_shr:1 row_mask:0xf bank_mask:0xf bound_ctrl:0
    v_mov_b32_dpp v45, v46 row_shl:1 row_mask:0xf bank_mask:0xf
    ds_read_b64_tr_b16 a[8:9], v202 offset:26976
    v_mfma_f32_16x16x32_bf16 v[64:67], v[92:95], a[96:99], v[64:67]
    ds_read_b128 v[76:79], v201 offset:13792
    v_add_f32_dpp v50, v51, v50 wave_shr:1 row_mask:0xf bank_mask:0xf bound_ctrl:0
    v_mfma_f32_16x16x32_bf16 v[68:71], v[92:95], a[104:107], v[68:71]
    ds_write_b32 v204, v44 offset:512
    v_mov_b32_dpp v45, v47 row_shl:2 row_mask:0xf bank_mask:0xf
    s_waitcnt lgkmcnt(12)
    v_mfma_f32_16x16x32_bf16 v[52:55], v[96:99], a[68:71], v[52:55]
    ds_write_b32 v208, v45 offset:144
    v_add_f32_dpp v49, v50, v49 wave_shr:1 row_mask:0xf bank_mask:0xf bound_ctrl:0
    v_mfma_f32_16x16x32_bf16 v[56:59], v[96:99], a[76:79], v[56:59]
    ds_read_b64_tr_b16 a[22:23], v202 offset:27712
    ds_read_b64_tr_b16 a[16:17], v202 offset:27488
    v_mfma_f32_16x16x32_bf16 v[60:63], v[96:99], a[84:87], v[60:63]
    ds_read_b128 v[80:83], v201 offset:13856
    v_add_f32_dpp v48, v49, v48 wave_shr:1 row_mask:0xf bank_mask:0xf bound_ctrl:0
    v_mfma_f32_16x16x32_bf16 v[64:67], v[96:99], a[92:95], v[64:67]
    ds_write_b32 v204, v48 offset:1024
    v_mov_b32_dpp v49, v50 row_shl:1 row_mask:0xf bank_mask:0xf
    v_mfma_f32_16x16x32_bf16 v[68:71], v[96:99], a[100:103], v[68:71]
    s_add_u32 m0, s33, 51968
    s_nop 0
    buffer_load_dwordx4 v243, s[12:15], 0 offen lds
    ds_read_b64_tr_b16 a[18:19], v202 offset:27456
    s_waitcnt lgkmcnt(13)
    v_mfma_f32_16x16x32_bf16 v[52:55], v[100:103], a[64:67], v[52:55]
    ds_read_b128 v[84:87], v201 offset:13920
    v_mov_b32_dpp v49, v51 row_shl:2 row_mask:0xf bank_mask:0xf
    v_mfma_f32_16x16x32_bf16 v[56:59], v[100:103], a[72:75], v[56:59]
    ds_write_b32 v208, v49 offset:272
    ds_read_b64_tr_b16 a[24:25], v202 offset:28000
    v_mfma_f32_16x16x32_bf16 v[60:63], v[100:103], a[80:83], v[60:63]
    ds_read_b64_tr_b16 a[28:29], v202 offset:28256
    ds_read_b64_tr_b16 a[26:27], v202 offset:27968
    v_mfma_f32_16x16x32_bf16 v[64:67], v[100:103], a[88:91], v[64:67]
    ds_read_b128 v[88:91], v201 offset:13984
    v_add_f32_dpp v54, v55, v54 wave_shr:1 row_mask:0xf bank_mask:0xf bound_ctrl:0
    v_mfma_f32_16x16x32_bf16 v[68:71], v[100:103], a[96:99], v[68:71]
    ds_read_b64_tr_b16 a[30:31], v202 offset:28224
    ds_read_b64_tr_b16 a[32:33], v202 offset:28512
    s_waitcnt lgkmcnt(15)
    v_mfma_f32_16x16x32_bf16 v[56:59], v[72:75], a[68:71], v[56:59]
    ds_read_b128 v[92:95], v201 offset:14048
    v_add_f32_dpp v53, v54, v53 wave_shr:1 row_mask:0xf bank_mask:0xf bound_ctrl:0
    v_mfma_f32_16x16x32_bf16 v[60:63], v[72:75], a[76:79], v[60:63]
    ds_read_b64_tr_b16 a[36:37], v202 offset:28768
    ds_read_b64_tr_b16 a[34:35], v202 offset:28480
    v_mfma_f32_16x16x32_bf16 v[64:67], v[72:75], a[84:87], v[64:67]
    buffer_load_dwordx4 v243, s[16:19], 0 offen offset:3712 lds
    ds_read_b64_tr_b16 a[40:41], v202 offset:29024
    v_mfma_f32_16x16x32_bf16 v[68:71], v[72:75], a[92:95], v[68:71]
    ds_read_b128 v[96:99], v201 offset:14112
    v_add_f32_dpp v52, v53, v52 wave_shr:1 row_mask:0xf bank_mask:0xf bound_ctrl:0
    v_mfma_f32_16x16x32_bf16 v[56:59], v[76:79], a[64:67], v[56:59]
    ds_read_b128 v[100:103], v201 offset:14176
    v_mov_b32_dpp v53, v54 row_shl:1 row_mask:0xf bank_mask:0xf
    v_mfma_f32_16x16x32_bf16 v[60:63], v[76:79], a[72:75], v[60:63]
    ds_read_b128 v[72:75], v201 offset:26432
    ds_read_b64_tr_b16 a[42:43], v202 offset:28992
    v_mfma_f32_16x16x32_bf16 v[64:67], v[76:79], a[80:83], v[64:67]
    ds_write_b32 v204, v52 offset:1536
    v_mov_b32_dpp v53, v55 row_shl:2 row_mask:0xf bank_mask:0xf
    v_mfma_f32_16x16x32_bf16 v[68:71], v[76:79], a[88:91], v[68:71]
    ds_write_b32 v208, v53 offset:400
    v_add_f32_dpp v58, v59, v58 wave_shr:1 row_mask:0xf bank_mask:0xf bound_ctrl:0
    s_waitcnt lgkmcnt(15)
    v_mfma_f32_16x16x32_bf16 v[60:63], v[80:83], a[68:71], v[60:63]
    ds_read_b64_tr_b16 a[38:39], v202 offset:28736
    ds_read_b64_tr_b16 a[48:49], v202 offset:29536
    v_mfma_f32_16x16x32_bf16 v[64:67], v[80:83], a[76:79], v[64:67]
    v_add_f32_dpp v57, v58, v57 wave_shr:1 row_mask:0xf bank_mask:0xf bound_ctrl:0
    ds_read_b64_tr_b16 a[44:45], v202 offset:29280
    v_mfma_f32_16x16x32_bf16 v[68:71], v[80:83], a[84:87], v[68:71]
    s_add_u32 m0, s33, 59392
    s_nop 0
    buffer_load_dwordx4 v236, s[12:15], s32 offen lds
    ds_read_b64_tr_b16 a[50:51], v202 offset:29504
    v_mfma_f32_16x16x32_bf16 v[60:63], v[84:87], a[64:67], v[60:63]
    v_add_f32_dpp v56, v57, v56 wave_shr:1 row_mask:0xf bank_mask:0xf bound_ctrl:0
    v_mov_b32_dpp v57, v58 row_shl:1 row_mask:0xf bank_mask:0xf
    ds_read_b64_tr_b16 a[10:11], v202 offset:26944
    v_mfma_f32_16x16x32_bf16 v[64:67], v[84:87], a[72:75], v[64:67]
    ds_read_b128 v[76:79], v201 offset:26496
    ds_read_b64_tr_b16 a[56:57], v202 offset:30048
    ds_read_b64_tr_b16 a[58:59], v202 offset:30016
    v_mfma_f32_16x16x32_bf16 v[68:71], v[84:87], a[80:83], v[68:71]
    ds_write_b32 v204, v56 offset:2048
    v_mov_b32_dpp v57, v59 row_shl:2 row_mask:0xf bank_mask:0xf
    s_waitcnt lgkmcnt(15)
    v_mfma_f32_16x16x32_bf16 v[64:67], v[88:91], a[68:71], v[64:67]
    ds_write_b32 v208, v57 offset:528
    v_add_f32_dpp v62, v63, v62 wave_shr:1 row_mask:0xf bank_mask:0xf bound_ctrl:0
    v_mfma_f32_16x16x32_bf16 v[68:71], v[88:91], a[76:79], v[68:71]
    v_mfma_f32_16x16x32_bf16 v[64:67], v[92:95], a[64:67], v[64:67]
    v_add_f32_dpp v61, v62, v61 wave_shr:1 row_mask:0xf bank_mask:0xf bound_ctrl:0
    v_mfma_f32_16x16x32_bf16 v[68:71], v[92:95], a[72:75], v[68:71]
    buffer_load_dwordx4 v236, s[16:19], s32 offen offset:3712 lds
    s_waitcnt lgkmcnt(15)
    v_mfma_f32_16x16x32_bf16 v[68:71], v[96:99], a[68:71], v[68:71]
    v_add_f32_dpp v60, v61, v60 wave_shr:1 row_mask:0xf bank_mask:0xf bound_ctrl:0
    v_mov_b32_dpp v61, v62 row_shl:1 row_mask:0xf bank_mask:0xf
    s_waitcnt lgkmcnt(14)
    v_mfma_f32_16x16x32_bf16 v[68:71], v[100:103], a[64:67], v[68:71]
    ds_write_b32 v204, v60 offset:2560
    v_add_f32_dpp v66, v67, v66 wave_shr:1 row_mask:0xf bank_mask:0xf bound_ctrl:0
    s_waitcnt lgkmcnt(14)
    v_mfma_f32_16x16x32_bf16 v[8:11], v[72:75], a[4:7], 0
    ds_read_b128 v[80:83], v201 offset:26560
    v_mov_b32_dpp v61, v63 row_shl:2 row_mask:0xf bank_mask:0xf
    v_mfma_f32_16x16x32_bf16 v[12:15], v[72:75], a[12:15], 0
    ds_write_b32 v208, v61 offset:656
    v_add_f32_dpp v65, v66, v65 wave_shr:1 row_mask:0xf bank_mask:0xf bound_ctrl:0
    v_mfma_f32_16x16x32_bf16 v[16:19], v[72:75], a[20:23], 0
    v_add_f32_dpp v70, v71, v70 wave_shr:1 row_mask:0xf bank_mask:0xf bound_ctrl:0
    v_mfma_f32_16x16x32_bf16 v[20:23], v[72:75], a[28:31], 0
    v_add_f32_dpp v64, v65, v64 wave_shr:1 row_mask:0xf bank_mask:0xf bound_ctrl:0
    v_mov_b32_dpp v65, v66 row_shl:1 row_mask:0xf bank_mask:0xf
    s_waitcnt lgkmcnt(12)
    v_mfma_f32_16x16x32_bf16 v[24:27], v[72:75], a[36:39], 0
    ds_write_b32 v204, v64 offset:3072
    v_add_f32_dpp v69, v70, v69 wave_shr:1 row_mask:0xf bank_mask:0xf bound_ctrl:0
    s_waitcnt lgkmcnt(11)
    v_mfma_f32_16x16x32_bf16 v[28:31], v[72:75], a[44:47], 0
    s_add_u32 m0, s33, 66816
    s_nop 0
    buffer_load_dwordx4 v244, s[12:15], 0 offen lds
    v_mfma_f32_16x16x32_bf16 v[32:35], v[72:75], a[52:55], 0
    v_mov_b32_dpp v65, v67 row_shl:2 row_mask:0xf bank_mask:0xf
    v_add_f32_dpp v68, v69, v68 wave_shr:1 row_mask:0xf bank_mask:0xf bound_ctrl:0
    v_mfma_f32_16x16x32_bf16 v[36:39], v[72:75], a[60:63], 0
    ds_read_b128 v[84:87], v201 offset:26624
    v_mov_b32_dpp v69, v70 row_shl:1 row_mask:0xf bank_mask:0xf
    s_waitcnt lgkmcnt(9)
    v_mfma_f32_16x16x32_bf16 v[8:11], v[76:79], a[0:3], v[8:11]
    ds_write_b32 v208, v65 offset:784
    v_mfma_f32_16x16x32_bf16 v[12:15], v[76:79], a[8:11], v[12:15]
    ds_write_b32 v204, v68 offset:3584
    v_mov_b32_dpp v69, v71 row_shl:2 row_mask:0xf bank_mask:0xf
    v_mfma_f32_16x16x32_bf16 v[16:19], v[76:79], a[16:19], v[16:19]
    ds_write_b32 v208, v69 offset:912
    v_mfma_f32_16x16x32_bf16 v[20:23], v[76:79], a[24:27], v[20:23]
    s_nop 0
    v_add_f32_dpp v10, v11, v10 wave_shr:1 row_mask:0xf bank_mask:0xf bound_ctrl:0
    v_mfma_f32_16x16x32_bf16 v[24:27], v[76:79], a[32:35], v[24:27]
    v_mfma_f32_16x16x32_bf16 v[28:31], v[76:79], a[40:43], v[28:31]
    buffer_load_dwordx4 v244, s[16:19], 0 offen offset:3712 lds
    v_mfma_f32_16x16x32_bf16 v[32:35], v[76:79], a[48:51], v[32:35]
    ds_read_b128 v[88:91], v201 offset:26688
    v_add_f32_dpp v9, v10, v9 wave_shr:1 row_mask:0xf bank_mask:0xf bound_ctrl:0
    s_waitcnt lgkmcnt(11)
    v_mfma_f32_16x16x32_bf16 v[36:39], v[76:79], a[56:59], v[36:39]
    s_waitcnt lgkmcnt(1)
    s_barrier
    v_mfma_f32_16x16x32_bf16 v[12:15], v[80:83], a[4:7], v[12:15]
    ds_read_b128 v[104:107], v206 offset:0
    v_add_f32_dpp v8, v9, v8 wave_shr:1 row_mask:0xf bank_mask:0xf bound_ctrl:0
    v_mfma_f32_16x16x32_bf16 v[16:19], v[80:83], a[12:15], v[16:19]
    ds_read_b128 v[112:115], v207 offset:16
    v_mov_b32_dpp v9, v10 row_shl:1 row_mask:0xf bank_mask:0xf
    v_mfma_f32_16x16x32_bf16 v[20:23], v[80:83], a[20:23], v[20:23]
    ds_read_b128 v[108:111], v206 offset:4160
    v_mfma_f32_16x16x32_bf16 v[24:27], v[80:83], a[28:31], v[24:27]
    ds_write_b32 v204, v8 offset:13472
    v_mov_b32_dpp v9, v11 row_shl:2 row_mask:0xf bank_mask:0xf
    v_mfma_f32_16x16x32_bf16 v[28:31], v[80:83], a[36:39], v[28:31]
    ds_read_b128 v[92:95], v201 offset:26752
    v_mfma_f32_16x16x32_bf16 v[32:35], v[80:83], a[44:47], v[32:35]
    s_add_u32 m0, s33, 74240
    s_nop 0
    buffer_load_dwordx4 v237, s[12:15], s32 offen lds
    v_mfma_f32_16x16x32_bf16 v[36:39], v[80:83], a[52:55], v[36:39]
    ds_write_b32 v208, v9 offset:0
    v_mfma_f32_16x16x32_bf16 v[12:15], v[84:87], a[0:3], v[12:15]
    v_mfma_f32_16x16x32_bf16 v[16:19], v[84:87], a[8:11], v[16:19]
    s_waitcnt lgkmcnt(5)
    v_dot2_f32_bf16 v104, v132, s98, v104
    v_dot2_f32_bf16 v105, v132, s99, v105
    v_mfma_f32_16x16x32_bf16 v[20:23], v[84:87], a[16:19], v[20:23]
    v_dot2_f32_bf16 v106, v133, s98, v106
    v_dot2_f32_bf16 v107, v133, s99, v107
    v_mfma_f32_16x16x32_bf16 v[24:27], v[84:87], a[24:27], v[24:27]
    ds_read_b128 v[96:99], v201 offset:26816
    s_waitcnt lgkmcnt(4)
    v_dot2_f32_bf16 v108, v134, s98, v108
    v_mfma_f32_16x16x32_bf16 v[28:31], v[84:87], a[32:35], v[28:31]
    v_dot2_f32_bf16 v109, v134, s99, v109
    v_dot2_f32_bf16 v110, v135, s98, v110
    v_mfma_f32_16x16x32_bf16 v[32:35], v[84:87], a[40:43], v[32:35]
    buffer_load_dwordx4 v237, s[16:19], s32 offen offset:3712 lds
    v_mfma_f32_16x16x32_bf16 v[36:39], v[84:87], a[48:51], v[36:39]
    v_dot2_f32_bf16 v111, v135, s99, v111
    v_add_f32 v104, v104, v113
    v_mfma_f32_16x16x32_bf16 v[16:19], v[88:91], a[4:7], v[16:19]
    v_add_f32 v105, v105, v114
    v_add_f32 v106, v106, v115
    v_mfma_f32_16x16x32_bf16 v[20:23], v[88:91], a[12:15], v[20:23]
    ds_read_b128 v[100:103], v201 offset:26880
    v_cvt_pk_bf16_f32 v116, v104, v105
    v_mfma_f32_16x16x32_bf16 v[24:27], v[88:91], a[20:23], v[24:27]
    v_cvt_pk_bf16_f32 v117, v106, v107
    v_cvt_pk_bf16_f32 v118, v108, v109
    v_mfma_f32_16x16x32_bf16 v[28:31], v[88:91], a[28:31], v[28:31]
    v_cvt_pk_bf16_f32 v119, v110, v111
    v_add_f32_dpp v14, v15, v14 wave_shr:1 row_mask:0xf bank_mask:0xf bound_ctrl:0
    v_mfma_f32_16x16x32_bf16 v[32:35], v[88:91], a[36:39], v[32:35]
    buffer_store_dwordx4 v[116:119], v254, s[4:7], s69 offen sc1
    v_mfma_f32_16x16x32_bf16 v[36:39], v[88:91], a[44:47], v[36:39]
    v_add_f32_dpp v13, v14, v13 wave_shr:1 row_mask:0xf bank_mask:0xf bound_ctrl:0
    s_waitcnt lgkmcnt(3)
    v_mfma_f32_16x16x32_bf16 v[16:19], v[92:95], a[0:3], v[16:19]
    s_add_u32 m0, s33, 81664
    s_nop 0
    buffer_load_dwordx4 v238, s[12:15], s32 offen lds
    v_mfma_f32_16x16x32_bf16 v[20:23], v[92:95], a[8:11], v[20:23]
    ds_read_b128 v[72:75], v201 offset:26944
    v_add_f32_dpp v12, v13, v12 wave_shr:1 row_mask:0xf bank_mask:0xf bound_ctrl:0
    v_mfma_f32_16x16x32_bf16 v[24:27], v[92:95], a[16:19], v[24:27]
    ds_write_b32 v204, v12 offset:13984
    v_mov_b32_dpp v13, v14 row_shl:1 row_mask:0xf bank_mask:0xf
    v_mfma_f32_16x16x32_bf16 v[28:31], v[92:95], a[24:27], v[28:31]
    v_add_f32_dpp v18, v19, v18 wave_shr:1 row_mask:0xf bank_mask:0xf bound_ctrl:0
    v_mfma_f32_16x16x32_bf16 v[32:35], v[92:95], a[32:35], v[32:35]
    ds_read_b128 v[76:79], v201 offset:27008
    v_mov_b32_dpp v13, v15 row_shl:2 row_mask:0xf bank_mask:0xf
    v_mfma_f32_16x16x32_bf16 v[36:39], v[92:95], a[40:43], v[36:39]
    ds_write_b32 v208, v13 offset:128
    v_add_f32_dpp v17, v18, v17 wave_shr:1 row_mask:0xf bank_mask:0xf bound_ctrl:0
    s_waitcnt lgkmcnt(5)
    v_mfma_f32_16x16x32_bf16 v[20:23], v[96:99], a[4:7], v[20:23]
    v_mfma_f32_16x16x32_bf16 v[24:27], v[96:99], a[12:15], v[24:27]
    v_add_f32_dpp v16, v17, v16 wave_shr:1 row_mask:0xf bank_mask:0xf bound_ctrl:0
    v_mov_b32_dpp v17, v18 row_shl:1 row_mask:0xf bank_mask:0xf
    v_mfma_f32_16x16x32_bf16 v[28:31], v[96:99], a[20:23], v[28:31]
    s_mov_b64 exec, s[96:97]
    buffer_load_dwordx4 v238, s[16:19], s32 offen offset:3712 lds
    s_mov_b64 exec, -1
    v_mfma_f32_16x16x32_bf16 v[32:35], v[96:99], a[28:31], v[32:35]
    ds_read_b128 v[80:83], v201 offset:27072
    v_mov_b32_dpp v17, v19 row_shl:2 row_mask:0xf bank_mask:0xf
    v_mfma_f32_16x16x32_bf16 v[36:39], v[96:99], a[36:39], v[36:39]
    ds_write_b32 v204, v16 offset:14496
    s_waitcnt lgkmcnt(6)
    v_mfma_f32_16x16x32_bf16 v[20:23], v[100:103], a[0:3], v[20:23]
    ds_read_b128 v[84:87], v201 offset:27136
    v_mfma_f32_16x16x32_bf16 v[24:27], v[100:103], a[8:11], v[24:27]
    ds_write_b32 v208, v17 offset:256
    v_mfma_f32_16x16x32_bf16 v[28:31], v[100:103], a[16:19], v[28:31]
    v_mfma_f32_16x16x32_bf16 v[32:35], v[100:103], a[24:27], v[32:35]
    ds_read_b128 v[88:91], v201 offset:27200
    s_nop 1
    v_add_f32_dpp v22, v23, v22 wave_shr:1 row_mask:0xf bank_mask:0xf bound_ctrl:0
    v_mfma_f32_16x16x32_bf16 v[36:39], v[100:103], a[32:35], v[36:39]
    s_waitcnt lgkmcnt(8)
    v_mfma_f32_16x16x32_bf16 v[24:27], v[72:75], a[4:7], v[24:27]
    ds_read_b128 v[92:95], v201 offset:27264
    v_add_f32_dpp v21, v22, v21 wave_shr:1 row_mask:0xf bank_mask:0xf bound_ctrl:0
    v_mfma_f32_16x16x32_bf16 v[28:31], v[72:75], a[12:15], v[28:31]
    v_mfma_f32_16x16x32_bf16 v[32:35], v[72:75], a[20:23], v[32:35]
    ds_read_b128 v[96:99], v201 offset:27328
    v_add_f32_dpp v20, v21, v20 wave_shr:1 row_mask:0xf bank_mask:0xf bound_ctrl:0
    v_mfma_f32_16x16x32_bf16 v[36:39], v[72:75], a[28:31], v[36:39]
    ds_read_b128 v[100:103], v201 offset:27392
    v_mov_b32_dpp v21, v22 row_shl:1 row_mask:0xf bank_mask:0xf
    s_waitcnt lgkmcnt(9)
    v_mfma_f32_16x16x32_bf16 v[24:27], v[76:79], a[0:3], v[24:27]
    ds_write_b32 v204, v20 offset:15008
    v_mfma_f32_16x16x32_bf16 v[28:31], v[76:79], a[8:11], v[28:31]
    v_mov_b32_dpp v21, v23 row_shl:2 row_mask:0xf bank_mask:0xf
    v_mfma_f32_16x16x32_bf16 v[32:35], v[76:79], a[16:19], v[32:35]
    ds_write_b32 v208, v21 offset:384
    v_mfma_f32_16x16x32_bf16 v[36:39], v[76:79], a[24:27], v[36:39]
    s_nop 1
    v_add_f32_dpp v26, v27, v26 wave_shr:1 row_mask:0xf bank_mask:0xf bound_ctrl:0
    s_waitcnt lgkmcnt(9)
    v_mfma_f32_16x16x32_bf16 v[28:31], v[80:83], a[4:7], v[28:31]
    s_add_u32 m0, s34, 0
    s_nop 0
    buffer_load_dwordx4 v252, s[4:7], s44 offen offset:0 sc1 lds
    v_mfma_f32_16x16x32_bf16 v[32:35], v[80:83], a[12:15], v[32:35]
    v_add_f32_dpp v25, v26, v25 wave_shr:1 row_mask:0xf bank_mask:0xf bound_ctrl:0
    v_mfma_f32_16x16x32_bf16 v[36:39], v[80:83], a[20:23], v[36:39]
    s_waitcnt lgkmcnt(7)
    v_mfma_f32_16x16x32_bf16 v[28:31], v[84:87], a[0:3], v[28:31]
    buffer_load_dwordx4 v252, s[4:7], s44 offen offset:1024 sc1 lds
    v_mfma_f32_16x16x32_bf16 v[32:35], v[84:87], a[8:11], v[32:35]
    v_add_f32_dpp v24, v25, v24 wave_shr:1 row_mask:0xf bank_mask:0xf bound_ctrl:0
    v_mov_b32_dpp v25, v26 row_shl:1 row_mask:0xf bank_mask:0xf
    v_mfma_f32_16x16x32_bf16 v[36:39], v[84:87], a[16:19], v[36:39]
    ds_write_b32 v204, v24 offset:15520
    s_waitcnt lgkmcnt(6)
    v_mfma_f32_16x16x32_bf16 v[32:35], v[88:91], a[4:7], v[32:35]
    buffer_load_dwordx4 v252, s[4:7], s44 offen offset:2048 sc1 lds
    v_mfma_f32_16x16x32_bf16 v[36:39], v[88:91], a[12:15], v[36:39]
    v_mov_b32_dpp v25, v27 row_shl:2 row_mask:0xf bank_mask:0xf
    v_add_f32_dpp v30, v31, v30 wave_shr:1 row_mask:0xf bank_mask:0xf bound_ctrl:0
    s_waitcnt lgkmcnt(5)
    v_mfma_f32_16x16x32_bf16 v[32:35], v[92:95], a[0:3], v[32:35]
    ds_write_b32 v208, v25 offset:512
    v_mfma_f32_16x16x32_bf16 v[36:39], v[92:95], a[8:11], v[36:39]
    buffer_load_dwordx4 v252, s[4:7], s44 offen offset:3072 sc1 lds
    s_waitcnt lgkmcnt(5)
    v_mfma_f32_16x16x32_bf16 v[36:39], v[96:99], a[4:7], v[36:39]
    v_add_f32_dpp v29, v30, v29 wave_shr:1 row_mask:0xf bank_mask:0xf bound_ctrl:0
    s_waitcnt lgkmcnt(4)
    v_mfma_f32_16x16x32_bf16 v[36:39], v[100:103], a[0:3], v[36:39]
    s_add_u32 m0, s34, 16384
    s_nop 0
    buffer_load_dwordx4 v252, s[4:7], s45 offen offset:0 sc1 lds
    buffer_load_dwordx4 v252, s[4:7], s45 offen offset:1024 sc1 lds
    buffer_load_dwordx4 v252, s[4:7], s45 offen offset:2048 sc1 lds
    buffer_load_dwordx4 v252, s[4:7], s45 offen offset:3072 sc1 lds
    v_add_f32_dpp v28, v29, v28 wave_shr:1 row_mask:0xf bank_mask:0xf bound_ctrl:0
    ds_write_b32 v204, v28 offset:16032
    v_mov_b32_dpp v29, v30 row_shl:1 row_mask:0xf bank_mask:0xf
    s_nop 1
    v_mov_b32_dpp v29, v31 row_shl:2 row_mask:0xf bank_mask:0xf
    ds_write_b32 v208, v29 offset:640
    v_add_f32_dpp v34, v35, v34 wave_shr:1 row_mask:0xf bank_mask:0xf bound_ctrl:0
    s_nop 1
    v_add_f32_dpp v33, v34, v33 wave_shr:1 row_mask:0xf bank_mask:0xf bound_ctrl:0
    s_nop 1
    v_add_f32_dpp v32, v33, v32 wave_shr:1 row_mask:0xf bank_mask:0xf bound_ctrl:0
    v_add_f32_dpp v38, v39, v38 wave_shr:1 row_mask:0xf bank_mask:0xf bound_ctrl:0
    v_mov_b32_dpp v33, v34 row_shl:1 row_mask:0xf bank_mask:0xf
    ds_write_b32 v204, v32 offset:16544
    v_add_f32_dpp v37, v38, v37 wave_shr:1 row_mask:0xf bank_mask:0xf bound_ctrl:0
    v_mov_b32_dpp v33, v35 row_shl:2 row_mask:0xf bank_mask:0xf
    s_nop 0
    v_add_f32_dpp v36, v37, v36 wave_shr:1 row_mask:0xf bank_mask:0xf bound_ctrl:0
    ds_write_b32 v208, v33 offset:768
    v_mov_b32_dpp v37, v38 row_shl:1 row_mask:0xf bank_mask:0xf
    ds_write_b32 v204, v36 offset:17056
    s_nop 0
    v_mov_b32_dpp v37, v39 row_shl:2 row_mask:0xf bank_mask:0xf
    ds_write_b32 v208, v37 offset:896
    s_waitcnt lgkmcnt(0)
    s_barrier
    ds_read_b128 v[104:107], v206 offset:13472
    ds_read_b128 v[112:115], v207 offset:0
    ds_read_b128 v[108:111], v206 offset:17632
    s_add_u32 m0, s34, 32768
    s_nop 0
    buffer_load_dwordx4 v252, s[4:7], s46 offen offset:0 sc1 lds
    buffer_load_dwordx4 v252, s[4:7], s46 offen offset:1024 sc1 lds
    buffer_load_dwordx4 v252, s[4:7], s46 offen offset:2048 sc1 lds
    buffer_load_dwordx4 v252, s[4:7], s46 offen offset:3072 sc1 lds
    s_waitcnt lgkmcnt(2)
    v_dot2_f32_bf16 v104, v136, s98, v104
    v_dot2_f32_bf16 v105, v136, s99, v105
    v_dot2_f32_bf16 v106, v137, s98, v106
    v_dot2_f32_bf16 v107, v137, s99, v107
    s_waitcnt lgkmcnt(0)
    v_dot2_f32_bf16 v108, v138, s98, v108
    v_dot2_f32_bf16 v109, v138, s99, v109
    v_dot2_f32_bf16 v110, v139, s98, v110
    v_dot2_f32_bf16 v111, v139, s99, v111
    v_add_f32 v104, v104, v113
    v_add_f32 v105, v105, v114
    v_add_f32 v106, v106, v115
    v_cvt_pk_bf16_f32 v116, v104, v105
    v_cvt_pk_bf16_f32 v117, v106, v107
    v_cvt_pk_bf16_f32 v118, v108, v109
    v_cvt_pk_bf16_f32 v119, v110, v111
    buffer_store_dwordx4 v[116:119], v253, s[4:7], s70 offen sc1
    s_add_u32 m0, s34, 49152
    s_nop 0
    buffer_load_dwordx4 v252, s[4:7], s47 offen offset:0 sc1 lds
    buffer_load_dwordx4 v252, s[4:7], s47 offen offset:1024 sc1 lds
    buffer_load_dwordx4 v252, s[4:7], s47 offen offset:2048 sc1 lds
    buffer_load_dwordx4 v252, s[4:7], s47 offen offset:3072 sc1 lds
    s_branch B_end
B_D:
    ds_read_b128 v[72:75], v201 offset:13216
    ds_read_b64_tr_b16 a[4:5], v202 offset:13504
    ds_read_b64_tr_b16 a[6:7], v202 offset:13472
    ds_read_b64_tr_b16 a[12:13], v202 offset:14016
    ds_read_b64_tr_b16 a[14:15], v202 offset:13984
    ds_read_b64_tr_b16 a[20:21], v202 offset:14528
    ds_read_b64_tr_b16 a[22:23], v202 offset:14496
    ds_read_b64_tr_b16 a[28:29], v202 offset:15040
    ds_read_b64_tr_b16 a[30:31], v202 offset:15008
    ds_read_b128 v[76:79], v201 offset:13280
    ds_read_b64_tr_b16 a[36:37], v202 offset:15552
    ds_read_b64_tr_b16 a[38:39], v202 offset:15520
    ds_read_b64_tr_b16 a[44:45], v202 offset:16064
    ds_read_b64_tr_b16 a[46:47], v202 offset:16032
    s_waitcnt lgkmcnt(11)
    v_mfma_f32_16x16x32_bf16 v[8:11], v[72:75], a[4:7], 0
    ds_read_b64_tr_b16 a[52:53], v202 offset:16576
    ds_read_b64_tr_b16 a[54:55], v202 offset:16544
    s_waitcnt lgkmcnt(11)
    v_mfma_f32_16x16x32_bf16 v[12:15], v[72:75], a[12:15], 0
    ds_read_b64_tr_b16 a[60:61], v202 offset:17088
    ds_read_b64_tr_b16 a[62:63], v202 offset:17056
    s_waitcnt lgkmcnt(11)
    v_mfma_f32_16x16x32_bf16 v[16:19], v[72:75], a[20:23], 0
    ds_read_b64_tr_b16 a[0:1], v202 offset:13248
    ds_read_b64_tr_b16 a[2:3], v202 offset:13216
    s_waitcnt lgkmcnt(11)
    v_mfma_f32_16x16x32_bf16 v[20:23], v[72:75], a[28:31], 0
    ds_read_b64_tr_b16 a[8:9], v202 offset:13760
    ds_read_b64_tr_b16 a[10:11], v202 offset:13728
    s_waitcnt lgkmcnt(10)
    v_mfma_f32_16x16x32_bf16 v[24:27], v[72:75], a[36:39], 0
    ds_read_b64_tr_b16 a[16:17], v202 offset:14272
    ds_read_b64_tr_b16 a[18:19], v202 offset:14240
    s_waitcnt lgkmcnt(10)
    v_mfma_f32_16x16x32_bf16 v[28:31], v[72:75], a[44:47], 0
    ds_read_b64_tr_b16 a[24:25], v202 offset:14784
    ds_read_b64_tr_b16 a[26:27], v202 offset:14752
    s_waitcnt lgkmcnt(10)
    v_mfma_f32_16x16x32_bf16 v[32:35], v[72:75], a[52:55], 0
    ds_read_b64_tr_b16 a[32:33], v202 offset:15296
    ds_read_b64_tr_b16 a[34:35], v202 offset:15264
    s_waitcnt lgkmcnt(10)
    v_mfma_f32_16x16x32_bf16 v[36:39], v[72:75], a[60:63], 0
    ds_read_b64_tr_b16 a[40:41], v202 offset:15808
    ds_read_b64_tr_b16 a[42:43], v202 offset:15776
    s_waitcnt lgkmcnt(10)
    v_mfma_f32_16x16x32_bf16 v[8:11], v[76:79], a[0:3], v[8:11]
    ds_read_b64_tr_b16 a[48:49], v202 offset:16320
    ds_read_b64_tr_b16 a[50:51], v202 offset:16288
    s_waitcnt lgkmcnt(10)
    v_mfma_f32_16x16x32_bf16 v[12:15], v[76:79], a[8:11], v[12:15]
    ds_read_b64_tr_b16 a[56:57], v202 offset:16832
    ds_read_b64_tr_b16 a[58:59], v202 offset:16800
    ds_read_b128 v[80:83], v201 offset:13344
    s_waitcnt lgkmcnt(11)
    v_mfma_f32_16x16x32_bf16 v[16:19], v[76:79], a[16:19], v[16:19]
    s_mov_b32 s89, 0
    buffer_load_dwordx4 a[128:131], v209, s[24:27], s89 offen
    s_waitcnt lgkmcnt(9)
    v_mfma_f32_16x16x32_bf16 v[20:23], v[76:79], a[24:27], v[20:23]
    ds_read_b128 v[84:87], v201 offset:13408
    v_add_f32_dpp v10, v11, v10 wave_shr:1 row_mask:0xf bank_mask:0xf bound_ctrl:0
    s_waitcnt lgkmcnt(8)
    v_mfma_f32_16x16x32_bf16 v[24:27], v[76:79], a[32:35], v[24:27]
    ds_read_b64_tr_b16 a[68:69], v202 offset:26720
    s_waitcnt lgkmcnt(7)
    v_mfma_f32_16x16x32_bf16 v[28:31], v[76:79], a[40:43], v[28:31]
    s_mov_b32 s89, 221184
    buffer_load_dwordx4 a[132:135], v209, s[24:27], s89 offen
    s_waitcnt lgkmcnt(5)
    v_mfma_f32_16x16x32_bf16 v[32:35], v[76:79], a[48:51], v[32:35]
    ds_read_b128 v[88:91], v201 offset:13472
    v_add_f32_dpp v9, v10, v9 wave_shr:1 row_mask:0xf bank_mask:0xf bound_ctrl:0
    s_waitcnt lgkmcnt(4)
    v_mfma_f32_16x16x32_bf16 v[36:39], v[76:79], a[56:59], v[36:39]
    ds_read_b64_tr_b16 a[70:71], v202 offset:26688
    s_waitcnt lgkmcnt(4)
    v_mfma_f32_16x16x32_bf16 v[12:15], v[80:83], a[4:7], v[12:15]
    v_add_f32_dpp v8, v9, v8 wave_shr:1 row_mask:0xf bank_mask:0xf bound_ctrl:0
    v_mov_b32_dpp v9, v10 row_shl:1 row_mask:0xf bank_mask:0xf
    v_mfma_f32_16x16x32_bf16 v[16:19], v[80:83], a[12:15], v[16:19]
    s_mov_b32 s89, 442368
    buffer_load_dwordx4 a[136:139], v209, s[24:27], s89 offen
    v_mfma_f32_16x16x32_bf16 v[20:23], v[80:83], a[20:23], v[20:23]
    ds_write_b32 v204, v8 offset:0
    v_mov_b32_dpp v9, v11 row_shl:2 row_mask:0xf bank_mask:0xf
    v_mfma_f32_16x16x32_bf16 v[24:27], v[80:83], a[28:31], v[24:27]
    ds_write_b32 v208, v9 offset:16
    v_mfma_f32_16x16x32_bf16 v[28:31], v[80:83], a[36:39], v[28:31]
    ds_read_b128 v[132:135], v206 offset:13408
    s_mov_b32 s89, 663552
    buffer_load_dwordx4 a[140:143], v209, s[24:27], s89 offen
    v_mfma_f32_16x16x32_bf16 v[32:35], v[80:83], a[44:47], v[32:35]
    ds_read_b128 v[92:95], v201 offset:13536
    v_mfma_f32_16x16x32_bf16 v[36:39], v[80:83], a[52:55], v[36:39]
    ds_read_b64_tr_b16 a[76:77], v202 offset:27232
    s_waitcnt lgkmcnt(8)
    v_mfma_f32_16x16x32_bf16 v[12:15], v[84:87], a[0:3], v[12:15]
    ds_read_b64_tr_b16 a[78:79], v202 offset:27200
    v_mfma_f32_16x16x32_bf16 v[16:19], v[84:87], a[8:11], v[16:19]
    ds_read_b128 v[136:139], v206 offset:17504
    s_mov_b32 s89, 884736
    buffer_load_dwordx4 a[144:147], v209, s[24:27], s89 offen
    v_mfma_f32_16x16x32_bf16 v[20:23], v[84:87], a[16:19], v[20:23]
    ds_read_b64_tr_b16 a[84:85], v202 offset:27744
    v_mfma_f32_16x16x32_bf16 v[24:27], v[84:87], a[24:27], v[24:27]
    ds_read_b128 v[96:99], v201 offset:13600
    v_add_f32_dpp v14, v15, v14 wave_shr:1 row_mask:0xf bank_mask:0xf bound_ctrl:0
    v_mfma_f32_16x16x32_bf16 v[28:31], v[84:87], a[32:35], v[28:31]
    s_mov_b32 s89, 1105920
    buffer_load_dwordx4 a[148:151], v209, s[24:27], s89 offen
    v_mfma_f32_16x16x32_bf16 v[32:35], v[84:87], a[40:43], v[32:35]
    v_add_f32_dpp v13, v14, v13 wave_shr:1 row_mask:0xf bank_mask:0xf bound_ctrl:0
    ds_read_b64_tr_b16 a[86:87], v202 offset:27712
    v_mfma_f32_16x16x32_bf16 v[36:39], v[84:87], a[48:51], v[36:39]
    ds_read_b64_tr_b16 a[92:93], v202 offset:28256
    s_waitcnt lgkmcnt(12)
    v_mfma_f32_16x16x32_bf16 v[16:19], v[88:91], a[4:7], v[16:19]
    v_add_f32_dpp v12, v13, v12 wave_shr:1 row_mask:0xf bank_mask:0xf bound_ctrl:0
    v_mov_b32_dpp v13, v14 row_shl:1 row_mask:0xf bank_mask:0xf
    v_mfma_f32_16x16x32_bf16 v[20:23], v[88:91], a[12:15], v[20:23]
    s_mov_b32 s89, 1327104
    buffer_load_dwordx4 a[152:155], v209, s[24:27], s89 offen
    v_mfma_f32_16x16x32_bf16 v[24:27], v[88:91], a[20:23], v[24:27]
    ds_read_b128 v[100:103], v201 offset:13664
    v_mov_b32_dpp v13, v15 row_shl:2 row_mask:0xf bank_mask:0xf
    v_mfma_f32_16x16x32_bf16 v[28:31], v[88:91], a[28:31], v[28:31]
    ds_write_b32 v204, v12 offset:512
    v_mfma_f32_16x16x32_bf16 v[32:35], v[88:91], a[36:39], v[32:35]
    ds_write_b32 v208, v13 offset:144
    ds_read_b64_tr_b16 a[124:125], v202 offset:30304
    v_mfma_f32_16x16x32_bf16 v[36:39], v[88:91], a[44:47], v[36:39]
    s_mov_b32 s89, 1548288
    buffer_load_dwordx4 a[156:159], v209, s[24:27], s89 offen
    s_waitcnt lgkmcnt(11)
    v_mfma_f32_16x16x32_bf16 v[16:19], v[92:95], a[0:3], v[16:19]
    ds_read_b128 v[72:75], v201 offset:13728
    ds_read_b64_tr_b16 a[126:127], v202 offset:30272
    v_mfma_f32_16x16x32_bf16 v[20:23], v[92:95], a[8:11], v[20:23]
    ds_read_b64_tr_b16 a[94:95], v202 offset:28224
    v_mfma_f32_16x16x32_bf16 v[24:27], v[92:95], a[16:19], v[24:27]
    s_mov_b32 s89, 1769472
    buffer_load_dwordx4 a[160:163], v209, s[24:27], s89 offen
    ds_read_b64_tr_b16 a[64:65], v202 offset:26464
    v_mfma_f32_16x16x32_bf16 v[28:31], v[92:95], a[24:27], v[28:31]
    v_add_f32_dpp v18, v19, v18 wave_shr:1 row_mask:0xf bank_mask:0xf bound_ctrl:0
    ds_read_b64_tr_b16 a[100:101], v202 offset:28768
    v_mfma_f32_16x16x32_bf16 v[32:35], v[92:95], a[32:35], v[32:35]
    ds_read_b128 v[76:79], v201 offset:13792
    ds_read_b64_tr_b16 a[66:67], v202 offset:26432
    v_mfma_f32_16x16x32_bf16 v[36:39], v[92:95], a[40:43], v[36:39]
    v_add_f32_dpp v17, v18, v17 wave_shr:1 row_mask:0xf bank_mask:0xf bound_ctrl:0
    ds_read_b64_tr_b16 a[102:103], v202 offset:28736
    s_waitcnt lgkmcnt(14)
    v_mfma_f32_16x16x32_bf16 v[20:23], v[96:99], a[4:7], v[20:23]
    s_mov_b32 s89, 1990656
    buffer_load_dwordx4 a[164:167], v209, s[24:27], s89 offen
    ds_read_b64_tr_b16 a[72:73], v202 offset:26976
    v_mfma_f32_16x16x32_bf16 v[24:27], v[96:99], a[12:15], v[24:27]
    v_add_f32_dpp v16, v17, v16 wave_shr:1 row_mask:0xf bank_mask:0xf bound_ctrl:0
    v_mov_b32_dpp v17, v18 row_shl:1 row_mask:0xf bank_mask:0xf
    ds_read_b64_tr_b16 a[118:119], v202 offset:29760
    v_mfma_f32_16x16x32_bf16 v[28:31], v[96:99], a[20:23], v[28:31]
    ds_read_b128 v[80:83], v201 offset:13856
    ds_read_b64_tr_b16 a[74:75], v202 offset:26944
    v_mfma_f32_16x16x32_bf16 v[32:35], v[96:99], a[28:31], v[32:35]
    s_add_u32 m0, s33, 0
    s_nop 0
    buffer_load_dwordx4 v236, s[12:15], 0 offen lds
    ds_read_b64_tr_b16 a[80:81], v202 offset:27488
    v_mfma_f32_16x16x32_bf16 v[36:39], v[96:99], a[36:39], v[36:39]
    ds_write_b32 v204, v16 offset:1024
    v_mov_b32_dpp v17, v19 row_shl:2 row_mask:0xf bank_mask:0xf
    s_waitcnt lgkmcnt(15)
    v_mfma_f32_16x16x32_bf16 v[20:23], v[100:103], a[0:3], v[20:23]
    ds_read_b128 v[84:87], v201 offset:13920
    ds_read_b64_tr_b16 a[82:83], v202 offset:27456
    v_mfma_f32_16x16x32_bf16 v[24:27], v[100:103], a[8:11], v[24:27]
    ds_write_b32 v208, v17 offset:272
    ds_read_b64_tr_b16 a[88:89], v202 offset:28000
    v_mfma_f32_16x16x32_bf16 v[28:31], v[100:103], a[16:19], v[28:31]
    buffer_load_dwordx4 v236, s[16:19], 0 offen offset:3712 lds
    ds_read_b64_tr_b16 a[90:91], v202 offset:27968
    v_mfma_f32_16x16x32_bf16 v[32:35], v[100:103], a[24:27], v[32:35]
    ds_read_b128 v[88:91], v201 offset:13984
    v_add_f32_dpp v22, v23, v22 wave_shr:1 row_mask:0xf bank_mask:0xf bound_ctrl:0
    v_mfma_f32_16x16x32_bf16 v[36:39], v[100:103], a[32:35], v[36:39]
    ds_read_b64_tr_b16 a[108:109], v202 offset:29280
    ds_read_b64_tr_b16 a[96:97], v202 offset:28512
    s_waitcnt lgkmcnt(15)
    v_mfma_f32_16x16x32_bf16 v[24:27], v[72:75], a[4:7], v[24:27]
    ds_read_b128 v[92:95], v201 offset:14048
    v_add_f32_dpp v21, v22, v21 wave_shr:1 row_mask:0xf bank_mask:0xf bound_ctrl:0
    v_mfma_f32_16x16x32_bf16 v[28:31], v[72:75], a[12:15], v[28:31]
    s_add_u32 m0, s33, 7424
    s_nop 0
    buffer_load_dwordx4 v237, s[12:15], 0 offen lds
    ds_read_b64_tr_b16 a[98:99], v202 offset:28480
    v_mfma_f32_16x16x32_bf16 v[32:35], v[72:75], a[20:23], v[32:35]
    ds_read_b128 v[96:99], v201 offset:14112
    v_add_f32_dpp v20, v21, v20 wave_shr:1 row_mask:0xf bank_mask:0xf bound_ctrl:0
    v_mfma_f32_16x16x32_bf16 v[36:39], v[72:75], a[28:31], v[36:39]
    ds_read_b128 v[100:103], v201 offset:14176
    v_mov_b32_dpp v21, v22 row_shl:1 row_mask:0xf bank_mask:0xf
    v_mfma_f32_16x16x32_bf16 v[24:27], v[76:79], a[0:3], v[24:27]
    buffer_load_dwordx4 v237, s[16:19], 0 offen offset:3712 lds
    ds_read_b64_tr_b16 a[104:105], v202 offset:29024
    v_mfma_f32_16x16x32_bf16 v[28:31], v[76:79], a[8:11], v[28:31]
    ds_read_b128 v[72:75], v201 offset:26432
    v_mov_b32_dpp v21, v23 row_shl:2 row_mask:0xf bank_mask:0xf
    v_mfma_f32_16x16x32_bf16 v[32:35], v[76:79], a[16:19], v[32:35]
    ds_write_b32 v204, v20 offset:1536
    ds_read_b64_tr_b16 a[106:107], v202 offset:28992
    v_mfma_f32_16x16x32_bf16 v[36:39], v[76:79], a[24:27], v[36:39]
    ds_write_b32 v208, v21 offset:400
    v_add_f32_dpp v26, v27, v26 wave_shr:1 row_mask:0xf bank_mask:0xf bound_ctrl:0
    s_waitcnt lgkmcnt(15)
    v_mfma_f32_16x16x32_bf16 v[28:31], v[80:83], a[4:7], v[28:31]
    s_add_u32 m0, s33, 14848
    s_nop 0
    buffer_load_dwordx4 v238, s[12:15], 0 offen lds
    ds_read_b64_tr_b16 a[112:113], v202 offset:29536
    v_mfma_f32_16x16x32_bf16 v[32:35], v[80:83], a[12:15], v[32:35]
    v_add_f32_dpp v25, v26, v25 wave_shr:1 row_mask:0xf bank_mask:0xf bound_ctrl:0
    ds_read_b64_tr_b16 a[110:111], v202 offset:29248
    v_mfma_f32_16x16x32_bf16 v[36:39], v[80:83], a[20:23], v[36:39]
    ds_read_b64_tr_b16 a[116:117], v202 offset:29792
    ds_read_b64_tr_b16 a[114:115], v202 offset:29504
    ds_read_b64_tr_b16 a[122:123], v202 offset:30016
    v_mfma_f32_16x16x32_bf16 v[28:31], v[84:87], a[0:3], v[28:31]
    buffer_load_dwordx4 v238, s[16:19], 0 offen offset:3712 lds
    ds_read_b64_tr_b16 a[120:121], v202 offset:30048
    v_mfma_f32_16x16x32_bf16 v[32:35], v[84:87], a[8:11], v[32:35]
    ds_read_b128 v[76:79], v201 offset:26496
    v_add_f32_dpp v24, v25, v24 wave_shr:1 row_mask:0xf bank_mask:0xf bound_ctrl:0
    v_mfma_f32_16x16x32_bf16 v[36:39], v[84:87], a[16:19], v[36:39]
    ds_write_b32 v204, v24 offset:2048
    v_mov_b32_dpp v25, v26 row_shl:1 row_mask:0xf bank_mask:0xf
    s_waitcnt lgkmcnt(15)
    v_mfma_f32_16x16x32_bf16 v[32:35], v[88:91], a[4:7], v[32:35]
    v_add_f32_dpp v30, v31, v30 wave_shr:1 row_mask:0xf bank_mask:0xf bound_ctrl:0
    v_mfma_f32_16x16x32_bf16 v[36:39], v[88:91], a[12:15], v[36:39]
    s_add_u32 m0, s33, 22272
    s_nop 0
    buffer_load_dwordx4 v239, s[12:15], 0 offen lds
    v_mfma_f32_16x16x32_bf16 v[32:35], v[92:95], a[0:3], v[32:35]
    v_mov_b32_dpp v25, v27 row_shl:2 row_mask:0xf bank_mask:0xf
    v_add_f32_dpp v29, v30, v29 wave_shr:1 row_mask:0xf bank_mask:0xf bound_ctrl:0
    v_mfma_f32_16x16x32_bf16 v[36:39], v[92:95], a[8:11], v[36:39]
    ds_write_b32 v208, v25 offset:528
    s_waitcnt lgkmcnt(15)
    v_mfma_f32_16x16x32_bf16 v[36:39], v[96:99], a[4:7], v[36:39]
    v_add_f32_dpp v28, v29, v28 wave_shr:1 row_mask:0xf bank_mask:0xf bound_ctrl:0
    v_mov_b32_dpp v29, v30 row_shl:1 row_mask:0xf bank_mask:0xf
    s_waitcnt lgkmcnt(14)
    v_mfma_f32_16x16x32_bf16 v[36:39], v[100:103], a[0:3], v[36:39]
    buffer_load_dwordx4 v239, s[16:19], 0 offen offset:3712 lds
    s_waitcnt lgkmcnt(12)
    v_mfma_f32_16x16x32_bf16 v[40:43], v[72:75], a[68:71], 0
    ds_read_b128 v[80:83], v201 offset:26560
    v_mov_b32_dpp v29, v31 row_shl:2 row_mask:0xf bank_mask:0xf
    v_mfma_f32_16x16x32_bf16 v[44:47], v[72:75], a[76:79], 0
    ds_write_b32 v204, v28 offset:2560
    v_add_f32_dpp v34, v35, v34 wave_shr:1 row_mask:0xf bank_mask:0xf bound_ctrl:0
    v_mfma_f32_16x16x32_bf16 v[48:51], v[72:75], a[84:87], 0
    s_add_u32 m0, s33, 29696
    s_nop 0
    buffer_load_dwordx4 v240, s[12:15], 0 offen lds
    v_mfma_f32_16x16x32_bf16 v[52:55], v[72:75], a[92:95], 0
    ds_write_b32 v208, v29 offset:656
    v_add_f32_dpp v33, v34, v33 wave_shr:1 row_mask:0xf bank_mask:0xf bound_ctrl:0
    v_mfma_f32_16x16x32_bf16 v[56:59], v[72:75], a[100:103], 0
    v_add_f32_dpp v38, v39, v38 wave_shr:1 row_mask:0xf bank_mask:0xf bound_ctrl:0
    s_waitcnt lgkmcnt(10)
    v_mfma_f32_16x16x32_bf16 v[60:63], v[72:75], a[108:111], 0
    v_add_f32_dpp v32, v33, v32 wave_shr:1 row_mask:0xf bank_mask:0xf bound_ctrl:0
    v_mov_b32_dpp v33, v34 row_shl:1 row_mask:0xf bank_mask:0xf
    s_waitcnt lgkmcnt(9)
    v_mfma_f32_16x16x32_bf16 v[64:67], v[72:75], a[116:119], 0
    buffer_load_dwordx4 v240, s[16:19], 0 offen offset:3712 lds
    v_mfma_f32_16x16x32_bf16 v[68:71], v[72:75], a[124:127], 0
    ds_read_b128 v[84:87], v201 offset:26624
    v_mov_b32_dpp v33, v35 row_shl:2 row_mask:0xf bank_mask:0xf
    s_waitcnt lgkmcnt(6)
    v_mfma_f32_16x16x32_bf16 v[40:43], v[76:79], a[64:67], v[40:43]
    ds_write_b32 v204, v32 offset:3072
    v_add_f32_dpp v37, v38, v37 wave_shr:1 row_mask:0xf bank_mask:0xf bound_ctrl:0
    v_mfma_f32_16x16x32_bf16 v[44:47], v[76:79], a[72:75], v[44:47]
    s_add_u32 m0, s33, 37120
    s_nop 0
    buffer_load_dwordx4 v241, s[12:15], 0 offen lds
    v_mfma_f32_16x16x32_bf16 v[48:51], v[76:79], a[80:83], v[48:51]
    ds_write_b32 v208, v33 offset:784
    v_add_f32_dpp v36, v37, v36 wave_shr:1 row_mask:0xf bank_mask:0xf bound_ctrl:0
    v_mfma_f32_16x16x32_bf16 v[52:55], v[76:79], a[88:91], v[52:55]
    ds_write_b32 v204, v36 offset:3584
    v_mov_b32_dpp v37, v38 row_shl:1 row_mask:0xf bank_mask:0xf
    v_mfma_f32_16x16x32_bf16 v[56:59], v[76:79], a[96:99], v[56:59]
    v_add_f32_dpp v42, v43, v42 wave_shr:1 row_mask:0xf bank_mask:0xf bound_ctrl:0
    v_mfma_f32_16x16x32_bf16 v[60:63], v[76:79], a[104:107], v[60:63]
    buffer_load_dwordx4 v241, s[16:19], 0 offen offset:3712 lds
    v_mfma_f32_16x16x32_bf16 v[64:67], v[76:79], a[112:115], v[64:67]
    ds_read_b128 v[88:91], v201 offset:26688
    v_mov_b32_dpp v37, v39 row_shl:2 row_mask:0xf bank_mask:0xf
    v_mfma_f32_16x16x32_bf16 v[68:71], v[76:79], a[120:123], v[68:71]
    ds_write_b32 v208, v37 offset:912
    v_add_f32_dpp v41, v42, v41 wave_shr:1 row_mask:0xf bank_mask:0xf bound_ctrl:0
    s_waitcnt lgkmcnt(8)
    v_mfma_f32_16x16x32_bf16 v[44:47], v[80:83], a[68:71], v[44:47]
    s_add_u32 m0, s33, 44544
    s_nop 0
    buffer_load_dwordx4 v242, s[12:15], 0 offen lds
    v_mfma_f32_16x16x32_bf16 v[48:51], v[80:83], a[76:79], v[48:51]
    v_add_f32_dpp v40, v41, v40 wave_shr:1 row_mask:0xf bank_mask:0xf bound_ctrl:0
    v_mov_b32_dpp v41, v42 row_shl:1 row_mask:0xf bank_mask:0xf
    v_mfma_f32_16x16x32_bf16 v[52:55], v[80:83], a[84:87], v[52:55]
    s_waitcnt lgkmcnt(0)
    s_barrier
    v_mfma_f32_16x16x32_bf16 v[56:59], v[80:83], a[92:95], v[56:59]
    ds_read_b128 v[104:107], v206 offset:0
    v_mov_b32_dpp v41, v43 row_shl:2 row_mask:0xf bank_mask:0xf
    v_mfma_f32_16x16x32_bf16 v[60:63], v[80:83], a[100:103], v[60:63]
    buffer_load_dwordx4 v242, s[16:19], 0 offen offset:3712 lds
    v_mfma_f32_16x16x32_bf16 v[64:67], v[80:83], a[108:111], v[64:67]
    ds_read_b128 v[92:95], v201 offset:26752
    v_mfma_f32_16x16x32_bf16 v[68:71], v[80:83], a[116:119], v[68:71]
    ds_read_b128 v[112:115], v207 offset:16
    v_mfma_f32_16x16x32_bf16 v[44:47], v[84:87], a[64:67], v[44:47]
    ds_read_b128 v[108:111], v206 offset:4160
    v_mfma_f32_16x16x32_bf16 v[48:51], v[84:87], a[72:75], v[48:51]
    s_add_u32 m0, s33, 51968
    s_nop 0
    buffer_load_dwordx4 v243, s[12:15], 0 offen lds
    v_mfma_f32_16x16x32_bf16 v[52:55], v[84:87], a[80:83], v[52:55]
    ds_write_b32 v204, v40 offset:13472
    v_mfma_f32_16x16x32_bf16 v[56:59], v[84:87], a[88:91], v[56:59]
    ds_read_b128 v[96:99], v201 offset:26816
    v_add_f32_dpp v46, v47, v46 wave_shr:1 row_mask:0xf bank_mask:0xf bound_ctrl:0
    v_mfma_f32_16x16x32_bf16 v[60:63], v[84:87], a[96:99], v[60:63]
    buffer_load_dwordx4 v243, s[16:19], 0 offen offset:3712 lds
    v_mfma_f32_16x16x32_bf16 v[64:67], v[84:87], a[104:107], v[64:67]
    ds_write_b32 v208, v41 offset:0
    v_add_f32_dpp v45, v46, v45 wave_shr:1 row_mask:0xf bank_mask:0xf bound_ctrl:0
    v_mfma_f32_16x16x32_bf16 v[68:71], v[84:87], a[112:115], v[68:71]
    s_waitcnt lgkmcnt(6)
    v_dot2_f32_bf16 v104, v132, s98, v104
    v_dot2_f32_bf16 v105, v132, s99, v105
    v_mfma_f32_16x16x32_bf16 v[48:51], v[88:91], a[68:71], v[48:51]
    v_dot2_f32_bf16 v106, v133, s98, v106
    v_dot2_f32_bf16 v107, v133, s99, v107
    v_mfma_f32_16x16x32_bf16 v[52:55], v[88:91], a[76:79], v[52:55]
    s_add_u32 m0, s33, 59392
    s_nop 0
    buffer_load_dwordx4 v236, s[12:15], s32 offen lds
    v_mfma_f32_16x16x32_bf16 v[56:59], v[88:91], a[84:87], v[56:59]
    ds_read_b128 v[100:103], v201 offset:26880
    s_waitcnt lgkmcnt(4)
    v_dot2_f32_bf16 v108, v134, s98, v108
    v_mfma_f32_16x16x32_bf16 v[60:63], v[88:91], a[92:95], v[60:63]
    v_dot2_f32_bf16 v109, v134, s99, v109
    v_dot2_f32_bf16 v110, v135, s98, v110
    v_mfma_f32_16x16x32_bf16 v[64:67], v[88:91], a[100:103], v[64:67]
    buffer_load_dwordx4 v236, s[16:19], s32 offen offset:3712 lds
    v_mfma_f32_16x16x32_bf16 v[68:71], v[88:91], a[108:111], v[68:71]
    v_dot2_f32_bf16 v111, v135, s99, v111
    v_add_f32 v104, v104, v113
    v_mfma_f32_16x16x32_bf16 v[48:51], v[92:95], a[64:67], v[48:51]
    ds_read_b128 v[72:75], v201 offset:26944
    v_add_f32 v105, v105, v114
    v_mfma_f32_16x16x32_bf16 v[52:55], v[92:95], a[72:75], v[52:55]
    v_add_f32 v106, v106, v115
    v_cvt_pk_bf16_f32 v116, v104, v105
    v_mfma_f32_16x16x32_bf16 v[56:59], v[92:95], a[80:83], v[56:59]
    s_add_u32 m0, s33, 66816
    s_nop 0
    buffer_load_dwordx4 v244, s[12:15], 0 offen lds
    v_mfma_f32_16x16x32_bf16 v[60:63], v[92:95], a[88:91], v[60:63]
    v_cvt_pk_bf16_f32 v117, v106, v107
    v_cvt_pk_bf16_f32 v118, v108, v109
    v_mfma_f32_16x16x32_bf16 v[64:67], v[92:95], a[96:99], v[64:67]
    ds_read_b128 v[76:79], v201 offset:27008
    v_cvt_pk_bf16_f32 v119, v110, v111
    v_mfma_f32_16x16x32_bf16 v[68:71], v[92:95], a[104:107], v[68:71]
    buffer_store_dwordx4 v[116:119], v254, s[4:7], s69 offen sc1
    s_waitcnt lgkmcnt(4)
    v_mfma_f32_16x16x32_bf16 v[52:55], v[96:99], a[68:71], v[52:55]
    buffer_load_dwordx4 v244, s[16:19], 0 offen offset:3712 lds
    v_mfma_f32_16x16x32_bf16 v[56:59], v[96:99], a[76:79], v[56:59]
    v_add_f32_dpp v44, v45, v44 wave_shr:1 row_mask:0xf bank_mask:0xf bound_ctrl:0
    v_mov_b32_dpp v45, v46 row_shl:1 row_mask:0xf bank_mask:0xf
    v_mfma_f32_16x16x32_bf16 v[60:63], v[96:99], a[84:87], v[60:63]
    ds_read_b128 v[80:83], v201 offset:27072
    v_add_f32_dpp v50, v51, v50 wave_shr:1 row_mask:0xf bank_mask:0xf bound_ctrl:0
    v_mfma_f32_16x16x32_bf16 v[64:67], v[96:99], a[92:95], v[64:67]
    s_add_u32 m0, s33, 74240
    s_nop 0
    buffer_load_dwordx4 v237, s[12:15], s32 offen lds
    v_mfma_f32_16x16x32_bf16 v[68:71], v[96:99], a[100:103], v[68:71]
    ds_write_b32 v204, v44 offset:13984
    v_mov_b32_dpp v45, v47 row_shl:2 row_mask:0xf bank_mask:0xf
    s_waitcnt lgkmcnt(4)
    v_mfma_f32_16x16x32_bf16 v[52:55], v[100:103], a[64:67], v[52:55]
    ds_read_b128 v[84:87], v201 offset:27136
    v_add_f32_dpp v49, v50, v49 wave_shr:1 row_mask:0xf bank_mask:0xf bound_ctrl:0
    v_mfma_f32_16x16x32_bf16 v[56:59], v[100:103], a[72:75], v[56:59]
    ds_write_b32 v208, v45 offset:128
    v_mfma_f32_16x16x32_bf16 v[60:63], v[100:103], a[80:83], v[60:63]
    buffer_load_dwordx4 v237, s[16:19], s32 offen offset:3712 lds
    v_mfma_f32_16x16x32_bf16 v[64:67], v[100:103], a[88:91], v[64:67]
    ds_read_b128 v[88:91], v201 offset:27200
    v_add_f32_dpp v48, v49, v48 wave_shr:1 row_mask:0xf bank_mask:0xf bound_ctrl:0
    v_mfma_f32_16x16x32_bf16 v[68:71], v[100:103], a[96:99], v[68:71]
    ds_write_b32 v204, v48 offset:14496
    v_mov_b32_dpp v49, v50 row_shl:1 row_mask:0xf bank_mask:0xf
    s_waitcnt lgkmcnt(7)
    v_mfma_f32_16x16x32_bf16 v[56:59], v[72:75], a[68:71], v[56:59]
    s_add_u32 m0, s33, 81664
    s_nop 0
    buffer_load_dwordx4 v238, s[12:15], s32 offen lds
    v_mfma_f32_16x16x32_bf16 v[60:63], v[72:75], a[76:79], v[60:63]
    ds_read_b128 v[92:95], v201 offset:27264
    v_mov_b32_dpp v49, v51 row_shl:2 row_mask:0xf bank_mask:0xf
    v_mfma_f32_16x16x32_bf16 v[64:67], v[72:75], a[84:87], v[64:67]
    ds_read_b128 v[96:99], v201 offset:27328
    v_add_f32_dpp v54, v55, v54 wave_shr:1 row_mask:0xf bank_mask:0xf bound_ctrl:0
    v_mfma_f32_16x16x32_bf16 v[68:71], v[72:75], a[92:95], v[68:71]
    ds_read_b128 v[100:103], v201 offset:27392
    s_waitcnt lgkmcnt(9)
    v_mfma_f32_16x16x32_bf16 v[56:59], v[76:79], a[64:67], v[56:59]
    s_mov_b64 exec, s[96:97]
    buffer_load_dwordx4 v238, s[16:19], s32 offen offset:3712 lds
    s_mov_b64 exec, -1
    v_mfma_f32_16x16x32_bf16 v[60:63], v[76:79], a[72:75], v[60:63]
    ds_write_b32 v208, v49 offset:256
    v_add_f32_dpp v53, v54, v53 wave_shr:1 row_mask:0xf bank_mask:0xf bound_ctrl:0
    v_mfma_f32_16x16x32_bf16 v[64:67], v[76:79], a[80:83], v[64:67]
    v_mfma_f32_16x16x32_bf16 v[68:71], v[76:79], a[88:91], v[68:71]
    v_add_f32_dpp v52, v53, v52 wave_shr:1 row_mask:0xf bank_mask:0xf bound_ctrl:0
    v_mov_b32_dpp v53, v54 row_shl:1 row_mask:0xf bank_mask:0xf
    s_waitcnt lgkmcnt(9)
    v_mfma_f32_16x16x32_bf16 v[60:63], v[80:83], a[68:71], v[60:63]
    ds_write_b32 v204, v52 offset:15008
    v_add_f32_dpp v58, v59, v58 wave_shr:1 row_mask:0xf bank_mask:0xf bound_ctrl:0
    v_mfma_f32_16x16x32_bf16 v[64:67], v[80:83], a[76:79], v[64:67]
    v_mov_b32_dpp v53, v55 row_shl:2 row_mask:0xf bank_mask:0xf
    v_mfma_f32_16x16x32_bf16 v[68:71], v[80:83], a[84:87], v[68:71]
    ds_write_b32 v208, v53 offset:384
    v_add_f32_dpp v57, v58, v57 wave_shr:1 row_mask:0xf bank_mask:0xf bound_ctrl:0
    s_waitcnt lgkmcnt(9)
    v_mfma_f32_16x16x32_bf16 v[60:63], v[84:87], a[64:67], v[60:63]
    v_mfma_f32_16x16x32_bf16 v[64:67], v[84:87], a[72:75], v[64:67]
    v_add_f32_dpp v56, v57, v56 wave_shr:1 row_mask:0xf bank_mask:0xf bound_ctrl:0
    v_mov_b32_dpp v57, v58 row_shl:1 row_mask:0xf bank_mask:0xf
    v_mfma_f32_16x16x32_bf16 v[68:71], v[84:87], a[80:83], v[68:71]
    ds_write_b32 v204, v56 offset:15520
    s_waitcnt lgkmcnt(8)
    v_mfma_f32_16x16x32_bf16 v[64:67], v[88:91], a[68:71], v[64:67]
    v_mov_b32_dpp v57, v59 row_shl:2 row_mask:0xf bank_mask:0xf
    v_add_f32_dpp v62, v63, v62 wave_shr:1 row_mask:0xf bank_mask:0xf bound_ctrl:0
    v_mfma_f32_16x16x32_bf16 v[68:71], v[88:91], a[76:79], v[68:71]
    ds_write_b32 v208, v57 offset:512
    s_waitcnt lgkmcnt(7)
    v_mfma_f32_16x16x32_bf16 v[64:67], v[92:95], a[64:67], v[64:67]
    v_add_f32_dpp v61, v62, v61 wave_shr:1 row_mask:0xf bank_mask:0xf bound_ctrl:0
    v_mfma_f32_16x16x32_bf16 v[68:71], v[92:95], a[72:75], v[68:71]
    s_waitcnt lgkmcnt(6)
    v_mfma_f32_16x16x32_bf16 v[68:71], v[96:99], a[68:71], v[68:71]
    v_add_f32_dpp v60, v61, v60 wave_shr:1 row_mask:0xf bank_mask:0xf bound_ctrl:0
    v_mov_b32_dpp v61, v62 row_shl:1 row_mask:0xf bank_mask:0xf
    s_waitcnt lgkmcnt(5)
    v_mfma_f32_16x16x32_bf16 v[68:71], v[100:103], a[64:67], v[68:71]
    ds_write_b32 v204, v60 offset:16032
    v_mov_b32_dpp v61, v63 row_shl:2 row_mask:0xf bank_mask:0xf
    ds_write_b32 v208, v61 offset:640
    v_add_f32_dpp v66, v67, v66 wave_shr:1 row_mask:0xf bank_mask:0xf bound_ctrl:0
    s_nop 1
    v_add_f32_dpp v65, v66, v65 wave_shr:1 row_mask:0xf bank_mask:0xf bound_ctrl:0
    s_nop 1
    v_add_f32_dpp v64, v65, v64 wave_shr:1 row_mask:0xf bank_mask:0xf bound_ctrl:0
    v_add_f32_dpp v70, v71, v70 wave_shr:1 row_mask:0xf bank_mask:0xf bound_ctrl:0
    v_mov_b32_dpp v65, v66 row_shl:1 row_mask:0xf bank_mask:0xf
    ds_write_b32 v204, v64 offset:16544
    v_add_f32_dpp v69, v70, v69 wave_shr:1 row_mask:0xf bank_mask:0xf bound_ctrl:0
    v_mov_b32_dpp v65, v67 row_shl:2 row_mask:0xf bank_mask:0xf
    s_nop 0
    v_add_f32_dpp v68, v69, v68 wave_shr:1 row_mask:0xf bank_mask:0xf bound_ctrl:0
    ds_write_b32 v208, v65 offset:768
    v_mov_b32_dpp v69, v70 row_shl:1 row_mask:0xf bank_mask:0xf
    ds_write_b32 v204, v68 offset:17056
    s_nop 0
    v_mov_b32_dpp v69, v71 row_shl:2 row_mask:0xf bank_mask:0xf
    ds_write_b32 v208, v69 offset:896
    s_waitcnt lgkmcnt(0)
    s_barrier
    ds_read_b128 v[104:107], v206 offset:13472
    ds_read_b128 v[112:115], v207 offset:0
    ds_read_b128 v[108:111], v206 offset:17632
    s_waitcnt lgkmcnt(2)
    v_dot2_f32_bf16 v104, v136, s98, v104
    v_dot2_f32_bf16 v105, v136, s99, v105
    v_dot2_f32_bf16 v106, v137, s98, v106
    v_dot2_f32_bf16 v107, v137, s99, v107
    s_waitcnt lgkmcnt(0)
    v_dot2_f32_bf16 v108, v138, s98, v108
    v_dot2_f32_bf16 v109, v138, s99, v109
    v_dot2_f32_bf16 v110, v139, s98, v110
    v_dot2_f32_bf16 v111, v139, s99, v111
    v_add_f32 v104, v104, v113
    v_add_f32 v105, v105, v114
    v_add_f32 v106, v106, v115
    v_cvt_pk_bf16_f32 v116, v104, v105
    v_cvt_pk_bf16_f32 v117, v106, v107
    v_cvt_pk_bf16_f32 v118, v108, v109
    v_cvt_pk_bf16_f32 v119, v110, v111
    buffer_store_dwordx4 v[116:119], v253, s[4:7], s70 offen sc1
    s_waitcnt vmcnt(35)
    v_mfma_f32_16x16x32_bf16 v[216:219], v[212:215], a[128:131], 0
    s_waitcnt vmcnt(34)
    v_mfma_f32_16x16x32_bf16 v[216:219], v[212:215], a[132:135], v[216:219]
    s_waitcnt vmcnt(33)
    v_mfma_f32_16x16x32_bf16 v[216:219], v[212:215], a[136:139], v[216:219]
    s_waitcnt vmcnt(32)
    v_mfma_f32_16x16x32_bf16 v[216:219], v[212:215], a[140:143], v[216:219]
    s_waitcnt vmcnt(31)
    v_mfma_f32_16x16x32_bf16 v[216:219], v[212:215], a[144:147], v[216:219]
    s_waitcnt vmcnt(30)
    v_mfma_f32_16x16x32_bf16 v[216:219], v[212:215], a[148:151], v[216:219]
    s_waitcnt vmcnt(29)
    v_mfma_f32_16x16x32_bf16 v[216:219], v[212:215], a[152:155], v[216:219]
    s_waitcnt vmcnt(28)
    v_mfma_f32_16x16x32_bf16 v[216:219], v[212:215], a[156:159], v[216:219]
    s_waitcnt vmcnt(27)
    v_mfma_f32_16x16x32_bf16 v[216:219], v[212:215], a[160:163], v[216:219]
    s_waitcnt vmcnt(26)
    v_mfma_f32_16x16x32_bf16 v[216:219], v[212:215], a[164:167], v[216:219]
    v_and_b32 v2, 3, v1
    v_lshlrev_b32 v2, 5, v2
    v_and_b32 v3, 16, v1
    s_lshl_b32 s88, s28, 7
    s_add_u32 s88, s88, 141024
    v_add3_u32 v2, v2, v3, s88
    v_add_u32 v3, 141024, v252
    s_nop 0
    v_add_f32_dpp v216, v216, v216 row_ror:4 row_mask:0xf bank_mask:0xf
    v_add_f32_dpp v217, v217, v217 row_ror:4 row_mask:0xf bank_mask:0xf
    v_add_f32_dpp v218, v218, v218 row_ror:4 row_mask:0xf bank_mask:0xf
    v_add_f32_dpp v219, v219, v219 row_ror:4 row_mask:0xf bank_mask:0xf
    v_add_f32_dpp v216, v216, v216 row_ror:8 row_mask:0xf bank_mask:0xf
    v_add_f32_dpp v217, v217, v217 row_ror:8 row_mask:0xf bank_mask:0xf
    v_add_f32_dpp v218, v218, v218 row_ror:8 row_mask:0xf bank_mask:0xf
    v_add_f32_dpp v219, v219, v219 row_ror:8 row_mask:0xf bank_mask:0xf
    ds_write_b128 v2, v[216:219]
    s_waitcnt lgkmcnt(0)
    s_barrier
    s_cmp_ge_u32 s61, 2
    s_cselect_b32 s88, 1, s28
    s_cmp_lg_u32 s88, 0
    s_cbranch_scc1 B_ncs
    s_mov_b64 exec, 0xff
    ds_read_b128 v[8:11], v3 offset:0
    ds_read_b128 v[12:15], v3 offset:128
    ds_read_b128 v[16:19], v3 offset:256
    ds_read_b128 v[20:23], v3 offset:384
    s_mul_i32 s88, s61, 3456
    s_add_u32 s88, s88, s60
    s_lshl_b32 s88, s88, 1
    s_add_u32 s88, s88, 262144
    s_waitcnt lgkmcnt(2)
    v_add_f32 v8, v8, v12
    s_waitcnt lgkmcnt(0)
    v_add_f32 v16, v16, v20
    v_add_f32 v9, v9, v13
    v_add_f32 v17, v17, v21
    v_add_f32 v10, v10, v14
    v_add_f32 v18, v18, v22
    v_add_f32 v11, v11, v15
    v_add_f32 v19, v19, v23
    v_add_f32 v8, v8, v16
    v_add_f32 v9, v9, v17
    v_add_f32 v10, v10, v18
    v_add_f32 v11, v11, v19
    buffer_store_dwordx4 v[8:11], v252, s[4:7], s88 offen sc1
    s_mov_b64 exec, -1
B_ncs:
    s_add_u32 m0, s34, 0
    s_nop 0
    buffer_load_dwordx4 v252, s[4:7], s44 offen offset:0 sc1 lds
    buffer_load_dwordx4 v252, s[4:7], s44 offen offset:1024 sc1 lds
    buffer_load_dwordx4 v252, s[4:7], s44 offen offset:2048 sc1 lds
    buffer_load_dwordx4 v252, s[4:7], s44 offen offset:3072 sc1 lds
    s_add_u32 m0, s34, 16384
    s_nop 0
    buffer_load_dwordx4 v252, s[4:7], s45 offen offset:0 sc1 lds
    buffer_load_dwordx4 v252, s[4:7], s45 offen offset:1024 sc1 lds
    buffer_load_dwordx4 v252, s[4:7], s45 offen offset:2048 sc1 lds
    buffer_load_dwordx4 v252, s[4:7], s45 offen offset:3072 sc1 lds
    s_add_u32 m0, s34, 32768
    s_nop 0
    buffer_load_dwordx4 v252, s[4:7], s46 offen offset:0 sc1 lds
    buffer_load_dwordx4 v252, s[4:7], s46 offen offset:1024 sc1 lds
    buffer_load_dwordx4 v252, s[4:7], s46 offen offset:2048 sc1 lds
    buffer_load_dwordx4 v252, s[4:7], s46 offen offset:3072 sc1 lds
    s_add_u32 m0, s34, 49152
    s_nop 0
    buffer_load_dwordx4 v252, s[4:7], s47 offen offset:0 sc1 lds
    buffer_load_dwordx4 v252, s[4:7], s47 offen offset:1024 sc1 lds
    buffer_load_dwordx4 v252, s[4:7], s47 offen offset:2048 sc1 lds
    buffer_load_dwordx4 v252, s[4:7], s47 offen offset:3072 sc1 lds
B_end:
    s_waitcnt vmcnt(34)
    s_barrier
    ds_read_b64_tr_b16 a[0:1], v228 offset:0
    ds_read_b64_tr_b16 a[2:3], v228 offset:1792
    ds_read_b64_tr_b16 a[8:9], v228 offset:32
    ds_read_b64_tr_b16 a[10:11], v228 offset:1824
    ds_read_b64_tr_b16 a[24:25], v230 offset:0
    ds_read_b64_tr_b16 a[26:27], v230 offset:1792
    ds_read_b64_tr_b16 a[16:17], v228 offset:64
    ds_read_b64_tr_b16 a[18:19], v228 offset:1856
    ds_read_b64_tr_b16 a[4:5], v228 offset:3712
    ds_read_b64_tr_b16 a[6:7], v228 offset:5504
    ds_read_b64_tr_b16 a[12:13], v228 offset:3744
    ds_read_b64_tr_b16 a[14:15], v228 offset:5536
    ds_read_b64_tr_b16 a[20:21], v228 offset:3776
    ds_read_b64_tr_b16 a[22:23], v228 offset:5568
    s_waitcnt vmcnt(12)
    ds_read2st64_b32 v[2:3], v232 offset0:0 offset1:4
    ds_read2st64_b32 v[4:5], v232 offset0:8 offset1:12
    ds_read_b64_tr_b16 a[44:45], v224 offset:0
    ds_read_b64_tr_b16 a[46:47], v224 offset:2048
    ds_read_b64_tr_b16 a[48:49], v225 offset:0
    ds_read_b64_tr_b16 a[50:51], v225 offset:2048
    ds_read_b64_tr_b16 a[52:53], v226 offset:0
    ds_read_b64_tr_b16 a[54:55], v226 offset:2048
    ds_read_b64_tr_b16 a[56:57], v227 offset:0
    ds_read_b64_tr_b16 a[58:59], v227 offset:2048
    s_waitcnt lgkmcnt(8)
    v_max3_u32 v2, v2, v3, v4
    v_max_u32 v2, v2, v5
    v_cmp_eq_u32 vcc, -1, v2
    s_cbranch_vccnz C_rt0
C_ok0:
    s_waitcnt lgkmcnt(6)
    v_mfma_f32_16x16x32_bf16 v[8:11], a[0:3], a[44:47], 0
    s_waitcnt vmcnt(8)
    ds_read2st64_b32 v[2:3], v232 offset0:64 offset1:68
    s_waitcnt lgkmcnt(5)
    v_mfma_f32_16x16x32_bf16 v[12:15], a[0:3], a[48:51], 0
    ds_read2st64_b32 v[4:5], v232 offset0:72 offset1:76
    s_waitcnt lgkmcnt(4)
    v_mfma_f32_16x16x32_bf16 v[24:27], a[0:3], a[52:55], 0
    s_add_u32 m0, s34, 0
    ds_read_b64_tr_b16 a[104:105], v224 offset:16384
    ds_read_b64_tr_b16 a[106:107], v224 offset:18432
    s_waitcnt lgkmcnt(4)
    v_mfma_f32_16x16x32_bf16 v[28:31], a[0:3], a[56:59], 0
    buffer_load_dwordx4 v252, s[4:7], s48 offen offset:0 sc1 lds
    v_mfma_f32_16x16x32_bf16 v[60:63], a[8:11], a[56:59], 0
    ds_read_b64_tr_b16 a[108:109], v225 offset:16384
    v_mfma_f32_16x16x32_bf16 v[56:59], a[8:11], a[52:55], 0
    s_waitcnt lgkmcnt(3)
    ds_read_b64_tr_b16 a[110:111], v225 offset:18432
    v_max3_u32 v2, v2, v3, v4
    v_mfma_f32_16x16x32_bf16 v[44:47], a[8:11], a[48:51], 0
    ds_read_b64_tr_b16 a[112:113], v226 offset:16384
    ds_read_b64_tr_b16 a[114:115], v226 offset:18432
    v_mfma_f32_16x16x32_bf16 v[40:43], a[8:11], a[44:47], 0
    buffer_load_dwordx4 v252, s[4:7], s48 offen offset:1024 sc1 lds
    v_mfma_f32_16x16x32_bf16 v[104:107], a[24:27], a[44:47], 0
    ds_read_b64_tr_b16 a[116:117], v227 offset:16384
    v_max_u32 v2, v2, v5
    v_mfma_f32_16x16x32_bf16 v[160:163], a[44:47], a[44:47], 0
    v_mfma_f32_16x16x32_bf16 v[164:167], a[252:255], a[44:47], 0
    v_mfma_f32_16x16x32_bf16 v[108:111], a[24:27], a[48:51], 0
    ds_read_b64_tr_b16 a[118:119], v227 offset:18432
    v_cmp_eq_u32 vcc, -1, v2
    v_mfma_f32_16x16x32_bf16 v[112:115], a[24:27], a[52:55], 0
    ds_read_b64_tr_b16 a[60:61], v228 offset:7424
    ds_read_b64_tr_b16 a[62:63], v228 offset:9216
    v_mfma_f32_16x16x32_bf16 v[116:119], a[24:27], a[56:59], 0
    buffer_load_dwordx4 v252, s[4:7], s48 offen offset:2048 sc1 lds
    v_mfma_f32_16x16x32_bf16 v[92:95], a[16:19], a[56:59], 0
    s_cbranch_vccnz C_rt1
C_ok1:
    v_mfma_f32_16x16x32_bf16 v[88:91], a[16:19], a[52:55], 0
    ds_read_b64_tr_b16 a[68:69], v228 offset:7456
    v_mfma_f32_16x16x32_bf16 v[76:79], a[16:19], a[48:51], 0
    ds_read_b64_tr_b16 a[70:71], v228 offset:9248
    ds_read_b64_tr_b16 a[84:85], v230 offset:7424
    v_mfma_f32_16x16x32_bf16 v[72:75], a[16:19], a[44:47], 0
    buffer_load_dwordx4 v252, s[4:7], s48 offen offset:3072 sc1 lds
    v_mfma_f32_16x16x32_bf16 v[16:19], a[4:7], a[44:47], 0
    ds_read_b64_tr_b16 a[86:87], v230 offset:9216
    v_mfma_f32_16x16x32_bf16 v[20:23], a[4:7], a[48:51], 0
    ds_read_b64_tr_b16 a[76:77], v228 offset:7488
    v_mfma_f32_16x16x32_bf16 v[32:35], a[4:7], a[52:55], 0
    s_add_u32 s90, s85, 4259840
    ds_read_b64_tr_b16 a[78:79], v228 offset:9280
    ds_read_b64_tr_b16 a[64:65], v228 offset:11136
    v_mfma_f32_16x16x32_bf16 v[36:39], a[4:7], a[56:59], 0
    buffer_store_dwordx4 v[192:195], v248, s[4:7], s90 offen sc1
    v_mfma_f32_16x16x32_bf16 v[68:71], a[12:15], a[56:59], 0
    ds_read_b64_tr_b16 a[66:67], v228 offset:12928
    v_mfma_f32_16x16x32_bf16 v[64:67], a[12:15], a[52:55], 0
    ds_read_b64_tr_b16 a[72:73], v228 offset:11168
    v_mfma_f32_16x16x32_bf16 v[52:55], a[12:15], a[48:51], 0
    ds_read_b64_tr_b16 a[74:75], v228 offset:12960
    ds_read_b64_tr_b16 a[80:81], v228 offset:11200
    v_mfma_f32_16x16x32_bf16 v[48:51], a[12:15], a[44:47], 0
    buffer_store_dwordx4 v[192:195], v248, s[4:7], s90 offen offset:2048 sc1
    v_mfma_f32_16x16x32_bf16 v[80:83], a[20:23], a[44:47], 0
    ds_read_b64_tr_b16 a[82:83], v228 offset:12992
    v_mfma_f32_16x16x32_bf16 v[84:87], a[20:23], a[48:51], 0
    s_waitcnt lgkmcnt(10)
    v_mfma_f32_16x16x32_bf16 v[96:99], a[20:23], a[52:55], 0
    s_add_u32 s90, s85, 6389760
    v_mfma_f32_16x16x32_bf16 v[100:103], a[20:23], a[56:59], 0
    buffer_store_dwordx4 v[192:195], v249, s[4:7], s90 offen sc1
    v_mfma_f32_16x16x32_bf16 v[8:11], a[60:63], a[104:107], v[8:11]
    s_lshl_b32 s91, s28, 10
    s_waitcnt vmcnt(11)
    ds_read2st64_b32 v[2:3], v232 offset0:128 offset1:132
    v_mfma_f32_16x16x32_bf16 v[12:15], a[60:63], a[108:111], v[12:15]
    s_add_u32 s91, s91, 154496
    ds_read2st64_b32 v[4:5], v232 offset0:136 offset1:140
    v_lshrrev_b32 v7, 5, v1
    v_mfma_f32_16x16x32_bf16 v[24:27], a[60:63], a[112:115], v[24:27]
    s_add_u32 m0, s34, 16384
    ds_read_b64_tr_b16 a[44:45], v224 offset:32768
    ds_read_b64_tr_b16 a[46:47], v224 offset:34816
    v_mfma_f32_16x16x32_bf16 v[28:31], a[60:63], a[116:119], v[28:31]
    buffer_load_dwordx4 v252, s[4:7], s49 offen offset:0 sc1 lds
    v_mfma_f32_16x16x32_bf16 v[60:63], a[68:71], a[116:119], v[60:63]
    s_mul_i32 s60, s77, 56
    ds_read_b64_tr_b16 a[48:49], v225 offset:32768
    v_lshlrev_b32 v7, 4, v7
    v_mfma_f32_16x16x32_bf16 v[56:59], a[68:71], a[112:115], v[56:59]
    s_waitcnt lgkmcnt(3)
    ds_read_b64_tr_b16 a[50:51], v225 offset:34816
    v_max3_u32 v2, v2, v3, v4
    v_mfma_f32_16x16x32_bf16 v[44:47], a[68:71], a[108:111], v[44:47]
    s_mul_i32 s92, s28, 14
    ds_read_b64_tr_b16 a[52:53], v226 offset:32768
    ds_read_b64_tr_b16 a[54:55], v226 offset:34816
    v_mfma_f32_16x16x32_bf16 v[40:43], a[68:71], a[104:107], v[40:43]
    buffer_load_dwordx4 v252, s[4:7], s49 offen offset:1024 sc1 lds
    v_mfma_f32_16x16x32_bf16 v[104:107], a[84:87], a[104:107], v[104:107]
    s_add_u32 s60, s60, s92
    ds_read_b64_tr_b16 a[56:57], v227 offset:32768
    v_max_u32 v2, v2, v5
    v_mfma_f32_16x16x32_bf16 v[108:111], a[84:87], a[108:111], v[108:111]
    s_mul_i32 s60, s60, 5120
    ds_read_b64_tr_b16 a[58:59], v227 offset:34816
    v_cmp_eq_u32 vcc, -1, v2
    v_mfma_f32_16x16x32_bf16 v[112:115], a[84:87], a[112:115], v[112:115]
    s_add_u32 s60, s60, 12582912
    ds_read_b64_tr_b16 a[0:1], v228 offset:14848
    ds_read_b64_tr_b16 a[2:3], v228 offset:16640
    v_mfma_f32_16x16x32_bf16 v[116:119], a[84:87], a[116:119], v[116:119]
    buffer_load_dwordx4 v252, s[4:7], s49 offen offset:2048 sc1 lds
    v_mfma_f32_16x16x32_bf16 v[92:95], a[76:79], a[116:119], v[92:95]
    s_cbranch_vccnz C_rt2
C_ok2:
    v_mfma_f32_16x16x32_bf16 v[88:91], a[76:79], a[112:115], v[88:91]
    s_lshl_b32 s62, s84, 2
    ds_read_b64_tr_b16 a[8:9], v228 offset:14880
    v_and_b32 v192, 16, v1
    v_mfma_f32_16x16x32_bf16 v[76:79], a[76:79], a[108:111], v[76:79]
    s_add_u32 s62, s62, s78
    ds_read_b64_tr_b16 a[10:11], v228 offset:16672
    ds_read_b64_tr_b16 a[24:25], v230 offset:14848
    v_mfma_f32_16x16x32_bf16 v[72:75], a[76:79], a[104:107], v[72:75]
    buffer_load_dwordx4 v252, s[4:7], s49 offen offset:3072 sc1 lds
    v_mfma_f32_16x16x32_bf16 v[16:19], a[64:67], a[104:107], v[16:19]
    s_lshl_b32 s61, s28, 3
    ds_read_b64_tr_b16 a[26:27], v230 offset:16640
    v_lshl_add_u32 v7, v192, 1, v7
    v_mfma_f32_16x16x32_bf16 v[20:23], a[64:67], a[108:111], v[20:23]
    s_add_u32 s61, s61, s84
    ds_read_b64_tr_b16 a[16:17], v228 offset:14912
    v_add_u32 v7, s91, v7
    v_mfma_f32_16x16x32_bf16 v[32:35], a[64:67], a[112:115], v[32:35]
    s_mul_i32 s61, s61, 16640
    ds_read_b64_tr_b16 a[18:19], v228 offset:16704
    s_lshl_b32 s92, s78, 12
    ds_read_b64_tr_b16 a[4:5], v228 offset:18560
    v_mfma_f32_16x16x32_bf16 v[36:39], a[64:67], a[116:119], v[36:39]
    s_add_u32 s61, s61, s92
    v_mul_u32_u24 v221, 416, v192
    v_add_u32 v192, s91, v192
    v_mfma_f32_16x16x32_bf16 v[68:71], a[72:75], a[116:119], v[68:71]
    s_add_u32 s61, s61, 16777216
    ds_read_b64_tr_b16 a[6:7], v228 offset:20352
    v_add_u32 v221, v221, v252
    v_mfma_f32_16x16x32_bf16 v[64:67], a[72:75], a[112:115], v[64:67]
    s_mul_i32 s62, s62, 81920
    ds_read_b64_tr_b16 a[12:13], v228 offset:18592
    v_and_b32 v222, 32, v1
    v_mfma_f32_16x16x32_bf16 v[52:55], a[72:75], a[108:111], v[52:55]
    s_add_u32 s62, s62, 1048576
    ds_read_b64_tr_b16 a[14:15], v228 offset:20384
    s_mul_i32 s92, s3, 0
    ds_read_b64_tr_b16 a[20:21], v228 offset:18624
    v_mfma_f32_16x16x32_bf16 v[48:51], a[72:75], a[104:107], v[48:51]
    s_mov_b32 s98, 0x76543210
    s_mov_b32 s99, 0x76543210
    v_lshl_add_u32 v221, v222, 26, v221
    v_mfma_f32_16x16x32_bf16 v[80:83], a[80:83], a[104:107], v[80:83]
    s_lshr_b64 s[98:99], s[98:99], s92
    s_mov_b32 s63, s98
    ds_read_b64_tr_b16 a[22:23], v228 offset:20416
    v_mfma_f32_16x16x32_bf16 v[84:87], a[80:83], a[108:111], v[84:87]
    s_mov_b32 s98, 0x98dcba98
    s_mov_b32 s99, 0xa98dcba
    s_waitcnt lgkmcnt(10)
    v_mfma_f32_16x16x32_bf16 v[96:99], a[80:83], a[112:115], v[96:99]
    s_lshr_b64 s[98:99], s[98:99], s92
    s_mov_b32 s35, s98
    v_mfma_f32_16x16x32_bf16 v[100:103], a[80:83], a[116:119], v[100:103]
    v_mfma_f32_16x16x32_bf16 v[8:11], a[0:3], a[44:47], v[8:11]
    s_waitcnt vmcnt(11)
    ds_read2st64_b32 v[2:3], v232 offset0:192 offset1:196
    v_mfma_f32_16x16x32_bf16 v[12:15], a[0:3], a[48:51], v[12:15]
    ds_read2st64_b32 v[4:5], v232 offset0:200 offset1:204
    v_mfma_f32_16x16x32_bf16 v[24:27], a[0:3], a[52:55], v[24:27]
    s_add_u32 m0, s34, 32768
    ds_read_b64_tr_b16 a[104:105], v224 offset:49152
    ds_read_b64_tr_b16 a[106:107], v224 offset:51200
    v_mfma_f32_16x16x32_bf16 v[28:31], a[0:3], a[56:59], v[28:31]
    buffer_load_dwordx4 v252, s[4:7], s50 offen offset:0 sc1 lds
    v_mfma_f32_16x16x32_bf16 v[60:63], a[8:11], a[56:59], v[60:63]
    ds_read_b64_tr_b16 a[108:109], v225 offset:49152
    v_mfma_f32_16x16x32_bf16 v[56:59], a[8:11], a[52:55], v[56:59]
    s_waitcnt lgkmcnt(3)
    ds_read_b64_tr_b16 a[110:111], v225 offset:51200
    v_max3_u32 v2, v2, v3, v4
    v_mfma_f32_16x16x32_bf16 v[44:47], a[8:11], a[48:51], v[44:47]
    ds_read_b64_tr_b16 a[112:113], v226 offset:49152
    ds_read_b64_tr_b16 a[114:115], v226 offset:51200
    v_mfma_f32_16x16x32_bf16 v[40:43], a[8:11], a[44:47], v[40:43]
    buffer_load_dwordx4 v252, s[4:7], s50 offen offset:1024 sc1 lds
    v_mfma_f32_16x16x32_bf16 v[104:107], a[24:27], a[44:47], v[104:107]
    ds_read_b64_tr_b16 a[116:117], v227 offset:49152
    v_max_u32 v2, v2, v5
    v_mfma_f32_16x16x32_bf16 v[108:111], a[24:27], a[48:51], v[108:111]
    ds_read_b64_tr_b16 a[118:119], v227 offset:51200
    v_cmp_eq_u32 vcc, -1, v2
    v_mfma_f32_16x16x32_bf16 v[112:115], a[24:27], a[52:55], v[112:115]
    ds_read_b64_tr_b16 a[60:61], v228 offset:22272
    ds_read_b64_tr_b16 a[62:63], v228 offset:24064
    v_mfma_f32_16x16x32_bf16 v[116:119], a[24:27], a[56:59], v[116:119]
    buffer_load_dwordx4 v252, s[4:7], s50 offen offset:2048 sc1 lds
    v_mfma_f32_16x16x32_bf16 v[92:95], a[16:19], a[56:59], v[92:95]
    s_cbranch_vccnz C_rt3
C_ok3:
    v_mfma_f32_16x16x32_bf16 v[88:91], a[16:19], a[52:55], v[88:91]
    ds_read_b64_tr_b16 a[68:69], v228 offset:22304
    v_mfma_f32_16x16x32_bf16 v[76:79], a[16:19], a[48:51], v[76:79]
    ds_read_b64_tr_b16 a[70:71], v228 offset:24096
    ds_read_b64_tr_b16 a[84:85], v230 offset:22272
    v_mfma_f32_16x16x32_bf16 v[72:75], a[16:19], a[44:47], v[72:75]
    buffer_load_dwordx4 v252, s[4:7], s50 offen offset:3072 sc1 lds
    v_mfma_f32_16x16x32_bf16 v[16:19], a[4:7], a[44:47], v[16:19]
    ds_read_b64_tr_b16 a[86:87], v230 offset:24064
    v_mfma_f32_16x16x32_bf16 v[20:23], a[4:7], a[48:51], v[20:23]
    ds_read_b64_tr_b16 a[76:77], v228 offset:22336
    v_mfma_f32_16x16x32_bf16 v[32:35], a[4:7], a[52:55], v[32:35]
    ds_read_b64_tr_b16 a[78:79], v228 offset:24128
    ds_read_b64_tr_b16 a[64:65], v228 offset:25984
    v_mfma_f32_16x16x32_bf16 v[36:39], a[4:7], a[56:59], v[36:39]
    v_mfma_f32_16x16x32_bf16 v[68:71], a[12:15], a[56:59], v[68:71]
    ds_read_b64_tr_b16 a[66:67], v228 offset:27776
    v_mfma_f32_16x16x32_bf16 v[64:67], a[12:15], a[52:55], v[64:67]
    ds_read_b64_tr_b16 a[72:73], v228 offset:26016
    v_mfma_f32_16x16x32_bf16 v[52:55], a[12:15], a[48:51], v[52:55]
    ds_read_b64_tr_b16 a[74:75], v228 offset:27808
    ds_read_b64_tr_b16 a[80:81], v228 offset:26048
    v_mfma_f32_16x16x32_bf16 v[48:51], a[12:15], a[44:47], v[48:51]
    v_mfma_f32_16x16x32_bf16 v[80:83], a[20:23], a[44:47], v[80:83]
    ds_read_b64_tr_b16 a[82:83], v228 offset:27840
    v_mfma_f32_16x16x32_bf16 v[84:87], a[20:23], a[48:51], v[84:87]
    s_waitcnt lgkmcnt(10)
    v_mfma_f32_16x16x32_bf16 v[96:99], a[20:23], a[52:55], v[96:99]
    v_mfma_f32_16x16x32_bf16 v[100:103], a[20:23], a[56:59], v[100:103]
    v_mfma_f32_16x16x32_bf16 v[8:11], a[60:63], a[104:107], v[8:11]
    s_waitcnt vmcnt(11)
    ds_read2st64_b32 v[2:3], v232 offset0:0 offset1:4
    v_mfma_f32_16x16x32_bf16 v[12:15], a[60:63], a[108:111], v[12:15]
    ds_read2st64_b32 v[4:5], v232 offset0:8 offset1:12
    v_mfma_f32_16x16x32_bf16 v[24:27], a[60:63], a[112:115], v[24:27]
    s_add_u32 m0, s34, 49152
    ds_read_b64_tr_b16 a[44:45], v224 offset:0
    ds_read_b64_tr_b16 a[46:47], v224 offset:2048
    v_mfma_f32_16x16x32_bf16 v[28:31], a[60:63], a[116:119], v[28:31]
    buffer_load_dwordx4 v252, s[4:7], s51 offen offset:0 sc1 lds
    v_mfma_f32_16x16x32_bf16 v[60:63], a[68:71], a[116:119], v[60:63]
    ds_read_b64_tr_b16 a[48:49], v225 offset:0
    v_mfma_f32_16x16x32_bf16 v[56:59], a[68:71], a[112:115], v[56:59]
    s_waitcnt lgkmcnt(3)
    ds_read_b64_tr_b16 a[50:51], v225 offset:2048
    v_max3_u32 v2, v2, v3, v4
    v_mfma_f32_16x16x32_bf16 v[44:47], a[68:71], a[108:111], v[44:47]
    ds_read_b64_tr_b16 a[52:53], v226 offset:0
    ds_read_b64_tr_b16 a[54:55], v226 offset:2048
    v_mfma_f32_16x16x32_bf16 v[40:43], a[68:71], a[104:107], v[40:43]
    buffer_load_dwordx4 v252, s[4:7], s51 offen offset:1024 sc1 lds
    v_mfma_f32_16x16x32_bf16 v[104:107], a[84:87], a[104:107], v[104:107]
    ds_read_b64_tr_b16 a[56:57], v227 offset:0
    v_max_u32 v2, v2, v5
    v_mfma_f32_16x16x32_bf16 v[108:111], a[84:87], a[108:111], v[108:111]
    s_barrier
    ds_read_b64_tr_b16 a[58:59], v227 offset:2048
    v_cmp_eq_u32 vcc, -1, v2
    v_mfma_f32_16x16x32_bf16 v[112:115], a[84:87], a[112:115], v[112:115]
    ds_read_b64_tr_b16 a[0:1], v228 offset:29696
    ds_read_b64_tr_b16 a[2:3], v228 offset:31488
    v_mfma_f32_16x16x32_bf16 v[116:119], a[84:87], a[116:119], v[116:119]
    buffer_load_dwordx4 v252, s[4:7], s51 offen offset:2048 sc1 lds
    v_mfma_f32_16x16x32_bf16 v[92:95], a[76:79], a[116:119], v[92:95]
    s_cbranch_vccnz C_rt4
C_ok4:
    v_mfma_f32_16x16x32_bf16 v[88:91], a[76:79], a[112:115], v[88:91]
    ds_read_b64_tr_b16 a[8:9], v228 offset:29728
    v_mfma_f32_16x16x32_bf16 v[76:79], a[76:79], a[108:111], v[76:79]
    ds_read_b64_tr_b16 a[10:11], v228 offset:31520
    ds_read_b64_tr_b16 a[24:25], v230 offset:29696
    v_mfma_f32_16x16x32_bf16 v[72:75], a[76:79], a[104:107], v[72:75]
    buffer_load_dwordx4 v252, s[4:7], s51 offen offset:3072 sc1 lds
    v_mfma_f32_16x16x32_bf16 v[16:19], a[64:67], a[104:107], v[16:19]
    ds_read_b64_tr_b16 a[26:27], v230 offset:31488
    v_mfma_f32_16x16x32_bf16 v[20:23], a[64:67], a[108:111], v[20:23]
    ds_read_b64_tr_b16 a[16:17], v228 offset:29760
    v_mfma_f32_16x16x32_bf16 v[32:35], a[64:67], a[112:115], v[32:35]
    s_add_u32 m0, s33, 0
    ds_read_b64_tr_b16 a[18:19], v228 offset:31552
    ds_read_b64_tr_b16 a[4:5], v228 offset:33408
    v_mfma_f32_16x16x32_bf16 v[36:39], a[64:67], a[116:119], v[36:39]
    buffer_load_dwordx4 v239, s[12:15], s32 offen lds
    v_mfma_f32_16x16x32_bf16 v[68:71], a[72:75], a[116:119], v[68:71]
    ds_read_b64_tr_b16 a[6:7], v228 offset:35200
    v_mfma_f32_16x16x32_bf16 v[64:67], a[72:75], a[112:115], v[64:67]
    ds_read_b64_tr_b16 a[12:13], v228 offset:33440
    v_mfma_f32_16x16x32_bf16 v[52:55], a[72:75], a[108:111], v[52:55]
    ds_read_b64_tr_b16 a[14:15], v228 offset:35232
    ds_read_b64_tr_b16 a[20:21], v228 offset:33472
    v_mfma_f32_16x16x32_bf16 v[48:51], a[72:75], a[104:107], v[48:51]
    buffer_load_dwordx4 v239, s[16:19], s32 offen offset:3712 lds
    v_mfma_f32_16x16x32_bf16 v[80:83], a[80:83], a[104:107], v[80:83]
    ds_read_b64_tr_b16 a[22:23], v228 offset:35264
    v_mfma_f32_16x16x32_bf16 v[84:87], a[80:83], a[108:111], v[84:87]
    s_waitcnt lgkmcnt(10)
    v_mfma_f32_16x16x32_bf16 v[96:99], a[80:83], a[112:115], v[96:99]
    s_mov_b32 m0, s91
    v_mfma_f32_16x16x32_bf16 v[100:103], a[80:83], a[116:119], v[100:103]
    buffer_load_dwordx4 v221, s[4:7], s57 offen sc1 lds
    v_mfma_f32_16x16x32_bf16 v[8:11], a[0:3], a[44:47], v[8:11]
    s_waitcnt vmcnt(11)
    ds_read2st64_b32 v[2:3], v232 offset0:64 offset1:68
    v_mfma_f32_16x16x32_bf16 v[12:15], a[0:3], a[48:51], v[12:15]
    ds_read2st64_b32 v[4:5], v232 offset0:72 offset1:76
    v_mfma_f32_16x16x32_bf16 v[24:27], a[0:3], a[52:55], v[24:27]
    s_add_u32 m0, s34, 0
    ds_read_b64_tr_b16 a[104:105], v224 offset:16384
    ds_read_b64_tr_b16 a[106:107], v224 offset:18432
    v_mfma_f32_16x16x32_bf16 v[28:31], a[0:3], a[56:59], v[28:31]
    buffer_load_dwordx4 v250, s[4:7], s44 offen offset:0 sc1 lds
    v_mfma_f32_16x16x32_bf16 v[60:63], a[8:11], a[56:59], v[60:63]
    ds_read_b64_tr_b16 a[108:109], v225 offset:16384
    v_mfma_f32_16x16x32_bf16 v[56:59], a[8:11], a[52:55], v[56:59]
    s_waitcnt lgkmcnt(3)
    ds_read_b64_tr_b16 a[110:111], v225 offset:18432
    v_max3_u32 v2, v2, v3, v4
    v_mfma_f32_16x16x32_bf16 v[44:47], a[8:11], a[48:51], v[44:47]
    ds_read_b64_tr_b16 a[112:113], v226 offset:16384
    ds_read_b64_tr_b16 a[114:115], v226 offset:18432
    v_mfma_f32_16x16x32_bf16 v[40:43], a[8:11], a[44:47], v[40:43]
    buffer_load_dwordx4 v250, s[4:7], s44 offen offset:1024 sc1 lds
    v_mfma_f32_16x16x32_bf16 v[104:107], a[24:27], a[44:47], v[104:107]
    ds_read_b64_tr_b16 a[116:117], v227 offset:16384
    v_max_u32 v2, v2, v5
    v_mfma_f32_16x16x32_bf16 v[108:111], a[24:27], a[48:51], v[108:111]
    ds_read_b64_tr_b16 a[118:119], v227 offset:18432
    v_cmp_eq_u32 vcc, -1, v2
    v_mfma_f32_16x16x32_bf16 v[112:115], a[24:27], a[52:55], v[112:115]
    ds_read_b64_tr_b16 a[60:61], v228 offset:37120
    ds_read_b64_tr_b16 a[62:63], v228 offset:38912
    v_mfma_f32_16x16x32_bf16 v[116:119], a[24:27], a[56:59], v[116:119]
    buffer_load_dwordx4 v250, s[4:7], s44 offen offset:2048 sc1 lds
    v_mfma_f32_16x16x32_bf16 v[92:95], a[16:19], a[56:59], v[92:95]
    s_cbranch_vccnz C_rt5
C_ok5:
    v_mfma_f32_16x16x32_bf16 v[88:91], a[16:19], a[52:55], v[88:91]
    ds_read_b64_tr_b16 a[68:69], v228 offset:37152
    v_mfma_f32_16x16x32_bf16 v[76:79], a[16:19], a[48:51], v[76:79]
    ds_read_b64_tr_b16 a[70:71], v228 offset:38944
    ds_read_b64_tr_b16 a[84:85], v230 offset:37120
    v_mfma_f32_16x16x32_bf16 v[72:75], a[16:19], a[44:47], v[72:75]
    buffer_load_dwordx4 v250, s[4:7], s44 offen offset:3072 sc1 lds
    v_mfma_f32_16x16x32_bf16 v[16:19], a[4:7], a[44:47], v[16:19]
    ds_read_b64_tr_b16 a[86:87], v230 offset:38912
    v_mfma_f32_16x16x32_bf16 v[20:23], a[4:7], a[48:51], v[20:23]
    ds_read_b64_tr_b16 a[76:77], v228 offset:37184
    v_mfma_f32_16x16x32_bf16 v[32:35], a[4:7], a[52:55], v[32:35]
    s_add_u32 m0, s33, 7424
    ds_read_b64_tr_b16 a[78:79], v228 offset:38976
    ds_read_b64_tr_b16 a[64:65], v228 offset:40832
    v_mfma_f32_16x16x32_bf16 v[36:39], a[4:7], a[56:59], v[36:39]
    buffer_load_dwordx4 v240, s[12:15], s32 offen lds
    v_mfma_f32_16x16x32_bf16 v[68:71], a[12:15], a[56:59], v[68:71]
    ds_read_b64_tr_b16 a[66:67], v228 offset:42624
    v_mfma_f32_16x16x32_bf16 v[64:67], a[12:15], a[52:55], v[64:67]
    ds_read_b64_tr_b16 a[72:73], v228 offset:40864
    v_mfma_f32_16x16x32_bf16 v[52:55], a[12:15], a[48:51], v[52:55]
    ds_read_b64_tr_b16 a[74:75], v228 offset:42656
    ds_read_b64_tr_b16 a[80:81], v228 offset:40896
    v_mfma_f32_16x16x32_bf16 v[48:51], a[12:15], a[44:47], v[48:51]
    buffer_load_dwordx4 v240, s[16:19], s32 offen offset:3712 lds
    v_mfma_f32_16x16x32_bf16 v[80:83], a[20:23], a[44:47], v[80:83]
    ds_read_b64_tr_b16 a[82:83], v228 offset:42688
    v_mfma_f32_16x16x32_bf16 v[84:87], a[20:23], a[48:51], v[84:87]
    s_waitcnt lgkmcnt(10)
    v_mfma_f32_16x16x32_bf16 v[96:99], a[20:23], a[52:55], v[96:99]
    v_mfma_f32_16x16x32_bf16 v[100:103], a[20:23], a[56:59], v[100:103]
    v_mfma_f32_16x16x32_bf16 v[8:11], a[60:63], a[104:107], v[8:11]
    s_waitcnt vmcnt(13)
    ds_read2st64_b32 v[2:3], v232 offset0:128 offset1:132
    v_mfma_f32_16x16x32_bf16 v[12:15], a[60:63], a[108:111], v[12:15]
    ds_read2st64_b32 v[4:5], v232 offset0:136 offset1:140
    v_mfma_f32_16x16x32_bf16 v[24:27], a[60:63], a[112:115], v[24:27]
    s_add_u32 m0, s34, 16384
    ds_read_b64_tr_b16 a[44:45], v224 offset:32768
    ds_read_b64_tr_b16 a[46:47], v224 offset:34816
    v_mfma_f32_16x16x32_bf16 v[28:31], a[60:63], a[116:119], v[28:31]
    buffer_load_dwordx4 v251, s[4:7], s52 offen offset:0 sc1 lds
    v_mfma_f32_16x16x32_bf16 v[60:63], a[68:71], a[116:119], v[60:63]
    ds_read_b64_tr_b16 a[48:49], v225 offset:32768
    v_mfma_f32_16x16x32_bf16 v[56:59], a[68:71], a[112:115], v[56:59]
    s_waitcnt lgkmcnt(3)
    ds_read_b64_tr_b16 a[50:51], v225 offset:34816
    v_max3_u32 v2, v2, v3, v4
    v_mfma_f32_16x16x32_bf16 v[44:47], a[68:71], a[108:111], v[44:47]
    ds_read_b64_tr_b16 a[52:53], v226 offset:32768
    ds_read_b64_tr_b16 a[54:55], v226 offset:34816
    v_mfma_f32_16x16x32_bf16 v[40:43], a[68:71], a[104:107], v[40:43]
    buffer_load_dwordx4 v251, s[4:7], s52 offen offset:1024 sc1 lds
    v_mfma_f32_16x16x32_bf16 v[104:107], a[84:87], a[104:107], v[104:107]
    ds_read_b64_tr_b16 a[56:57], v227 offset:32768
    v_max_u32 v2, v2, v5
    v_mfma_f32_16x16x32_bf16 v[108:111], a[84:87], a[108:111], v[108:111]
    ds_read_b64_tr_b16 a[58:59], v227 offset:34816
    v_cmp_eq_u32 vcc, -1, v2
    v_mfma_f32_16x16x32_bf16 v[112:115], a[84:87], a[112:115], v[112:115]
    ds_read_b64_tr_b16 a[0:1], v228 offset:44544
    ds_read_b64_tr_b16 a[2:3], v228 offset:46336
    v_mfma_f32_16x16x32_bf16 v[116:119], a[84:87], a[116:119], v[116:119]
    buffer_load_dwordx4 v251, s[4:7], s52 offen offset:2048 sc1 lds
    v_mfma_f32_16x16x32_bf16 v[92:95], a[76:79], a[116:119], v[92:95]
    s_cbranch_vccnz C_rt6
C_ok6:
    v_mfma_f32_16x16x32_bf16 v[88:91], a[76:79], a[112:115], v[88:91]
    s_waitcnt vmcnt(9)
    ds_read_b64_tr_b16 a[8:9], v228 offset:44576
    v_mfma_f32_16x16x32_bf16 v[76:79], a[76:79], a[108:111], v[76:79]
    ds_read_b64_tr_b16 a[10:11], v228 offset:46368
    ds_read_b64_tr_b16 a[24:25], v230 offset:44544
    v_mfma_f32_16x16x32_bf16 v[72:75], a[76:79], a[104:107], v[72:75]
    buffer_load_dwordx4 v251, s[4:7], s52 offen offset:3072 sc1 lds
    v_mfma_f32_16x16x32_bf16 v[16:19], a[64:67], a[104:107], v[16:19]
    ds_read_b64_tr_b16 a[26:27], v230 offset:46336
    v_mfma_f32_16x16x32_bf16 v[20:23], a[64:67], a[108:111], v[20:23]
    ds_read_b64_tr_b16 a[16:17], v228 offset:44608
    v_mfma_f32_16x16x32_bf16 v[32:35], a[64:67], a[112:115], v[32:35]
    s_add_u32 m0, s33, 14848
    ds_read_b64_tr_b16 a[18:19], v228 offset:46400
    ds_read_b64_tr_b16 a[4:5], v228 offset:48256
    v_mfma_f32_16x16x32_bf16 v[36:39], a[64:67], a[116:119], v[36:39]
    buffer_load_dwordx4 v241, s[12:15], s32 offen lds
    v_mfma_f32_16x16x32_bf16 v[68:71], a[72:75], a[116:119], v[68:71]
    ds_read_b64_tr_b16 a[6:7], v228 offset:50048
    v_mfma_f32_16x16x32_bf16 v[64:67], a[72:75], a[112:115], v[64:67]
    ds_read_b64_tr_b16 a[12:13], v228 offset:48288
    v_mfma_f32_16x16x32_bf16 v[52:55], a[72:75], a[108:111], v[52:55]
    ds_read_b64_tr_b16 a[14:15], v228 offset:50080
    ds_read_b64_tr_b16 a[20:21], v228 offset:48320
    v_mfma_f32_16x16x32_bf16 v[48:51], a[72:75], a[104:107], v[48:51]
    buffer_load_dwordx4 v241, s[16:19], s32 offen offset:3712 lds
    v_mfma_f32_16x16x32_bf16 v[80:83], a[80:83], a[104:107], v[80:83]
    ds_read_b64_tr_b16 a[22:23], v228 offset:50112
    v_mfma_f32_16x16x32_bf16 v[84:87], a[80:83], a[108:111], v[84:87]
    s_waitcnt lgkmcnt(10)
    ds_read_b128 v[120:123], v7 offset:0
    v_mfma_f32_16x16x32_bf16 v[96:99], a[80:83], a[112:115], v[96:99]
    ds_read_b128 v[124:127], v7 offset:256
    v_mfma_f32_16x16x32_bf16 v[100:103], a[80:83], a[116:119], v[100:103]
    ds_read_b128 v[128:131], v7 offset:64
    v_mfma_f32_16x16x32_bf16 v[8:11], a[0:3], a[44:47], v[8:11]
    ds_read2st64_b32 v[2:3], v232 offset0:192 offset1:196
    v_and_b32 v6, 15, v1
    v_mfma_f32_16x16x32_bf16 v[12:15], a[0:3], a[48:51], v[12:15]
    ds_read2st64_b32 v[4:5], v232 offset0:200 offset1:204
    v_lshlrev_b32 v6, 4, v6
    v_mfma_f32_16x16x32_bf16 v[24:27], a[0:3], a[52:55], v[24:27]
    s_add_u32 m0, s34, 32768
    ds_read_b64_tr_b16 a[104:105], v224 offset:49152
    ds_read_b64_tr_b16 a[106:107], v224 offset:51200
    v_mfma_f32_16x16x32_bf16 v[28:31], a[0:3], a[56:59], v[28:31]
    buffer_load_dwordx4 v250, s[4:7], s45 offen offset:0 sc1 lds
    v_mfma_f32_16x16x32_bf16 v[60:63], a[8:11], a[56:59], v[60:63]
    ds_read_b64_tr_b16 a[108:109], v225 offset:49152
    v_bfrev_b32 v196, 1
    v_mfma_f32_16x16x32_bf16 v[56:59], a[8:11], a[52:55], v[56:59]
    s_waitcnt lgkmcnt(3)
    ds_read_b64_tr_b16 a[110:111], v225 offset:51200
    v_max3_u32 v2, v2, v3, v4
    v_mfma_f32_16x16x32_bf16 v[44:47], a[8:11], a[48:51], v[44:47]
    ds_read_b64_tr_b16 a[112:113], v226 offset:49152
    ds_read_b64_tr_b16 a[114:115], v226 offset:51200
    v_mfma_f32_16x16x32_bf16 v[40:43], a[8:11], a[44:47], v[40:43]
    buffer_load_dwordx4 v250, s[4:7], s45 offen offset:1024 sc1 lds
    v_mfma_f32_16x16x32_bf16 v[104:107], a[24:27], a[44:47], v[104:107]
    ds_read_b64_tr_b16 a[116:117], v227 offset:49152
    v_max_u32 v2, v2, v5
    v_mfma_f32_16x16x32_bf16 v[108:111], a[24:27], a[48:51], v[108:111]
    ds_read_b64_tr_b16 a[118:119], v227 offset:51200
    v_cmp_eq_u32 vcc, -1, v2
    v_mfma_f32_16x16x32_bf16 v[112:115], a[24:27], a[52:55], v[112:115]
    ds_read_b64_tr_b16 a[60:61], v228 offset:51968
    ds_read_b64_tr_b16 a[62:63], v228 offset:53760
    v_mfma_f32_16x16x32_bf16 v[116:119], a[24:27], a[56:59], v[116:119]
    buffer_load_dwordx4 v250, s[4:7], s45 offen offset:2048 sc1 lds
    v_mfma_f32_16x16x32_bf16 v[92:95], a[16:19], a[56:59], v[92:95]
    ds_read_b128 v[132:135], v7 offset:320
    s_cbranch_vccnz C_rt7
C_ok7:
    v_mfma_f32_16x16x32_bf16 v[88:91], a[16:19], a[52:55], v[88:91]
    ds_read_b64_tr_b16 a[68:69], v228 offset:52000
    v_cndmask_b32 v6, v196, v6, s[42:43]
    v_mfma_f32_16x16x32_bf16 v[76:79], a[16:19], a[48:51], v[76:79]
    ds_read_b64_tr_b16 a[70:71], v228 offset:53792
    ds_read_b64_tr_b16 a[84:85], v230 offset:51968
    v_mfma_f32_16x16x32_bf16 v[72:75], a[16:19], a[44:47], v[72:75]
    buffer_load_dwordx4 v250, s[4:7], s45 offen offset:3072 sc1 lds
    v_mfma_f32_16x16x32_bf16 v[16:19], a[4:7], a[44:47], v[16:19]
    ds_read_b64_tr_b16 a[86:87], v230 offset:53760
    v_lshlrev_b32 v196, 4, v1
    v_mfma_f32_16x16x32_bf16 v[20:23], a[4:7], a[48:51], v[20:23]
    ds_read_b64_tr_b16 a[76:77], v228 offset:52032
    v_mfma_f32_16x16x32_bf16 v[32:35], a[4:7], a[52:55], v[32:35]
    s_add_u32 m0, s33, 22272
    ds_read_b64_tr_b16 a[78:79], v228 offset:53824
    ds_read_b64_tr_b16 a[64:65], v228 offset:55680
    v_mfma_f32_16x16x32_bf16 v[36:39], a[4:7], a[56:59], v[36:39]
    buffer_load_dwordx4 v242, s[12:15], s32 offen lds
    v_mfma_f32_16x16x32_bf16 v[68:71], a[12:15], a[56:59], v[68:71]
    ds_read_b64_tr_b16 a[66:67], v228 offset:57472
    v_mfma_f32_16x16x32_bf16 v[64:67], a[12:15], a[52:55], v[64:67]
    ds_read_b64_tr_b16 a[72:73], v228 offset:55712
    v_mfma_f32_16x16x32_bf16 v[52:55], a[12:15], a[48:51], v[52:55]
    ds_read_b64_tr_b16 a[74:75], v228 offset:57504
    ds_read_b64_tr_b16 a[80:81], v228 offset:55744
    v_mfma_f32_16x16x32_bf16 v[48:51], a[12:15], a[44:47], v[48:51]
    buffer_load_dwordx4 v242, s[16:19], s32 offen offset:3712 lds
    v_mfma_f32_16x16x32_bf16 v[80:83], a[20:23], a[44:47], v[80:83]
    ds_read_b64_tr_b16 a[82:83], v228 offset:57536
    v_mfma_f32_16x16x32_bf16 v[84:87], a[20:23], a[48:51], v[84:87]
    s_waitcnt lgkmcnt(10)
    ds_read_b128 v[136:139], v7 offset:128
    v_mfma_f32_16x16x32_bf16 v[96:99], a[20:23], a[52:55], v[96:99]
    ds_read_b128 v[140:143], v7 offset:384
    v_mfma_f32_16x16x32_bf16 v[100:103], a[20:23], a[56:59], v[100:103]
    ds_read_b128 v[144:147], v192 offset:192
    v_mfma_f32_16x16x32_bf16 v[8:11], a[60:63], a[104:107], v[8:11]
    s_lshr_b32 s95, s3, 1
    s_waitcnt vmcnt(14)
    ds_read2st64_b32 v[2:3], v232 offset0:0 offset1:4
    v_mfma_f32_16x16x32_bf16 v[12:15], a[60:63], a[108:111], v[12:15]
    s_lshl2_add_u32 s95, s95, s78
    s_lshl_b32 s95, s95, 5
    ds_read2st64_b32 v[4:5], v232 offset0:8 offset1:12
    v_mfma_f32_16x16x32_bf16 v[24:27], a[60:63], a[112:115], v[24:27]
    s_add_u32 m0, s34, 49152
    ds_read_b64_tr_b16 a[44:45], v224 offset:0
    ds_read_b64_tr_b16 a[46:47], v224 offset:2048
    v_mfma_f32_16x16x32_bf16 v[28:31], a[60:63], a[116:119], v[28:31]
    buffer_load_dwordx4 v250, s[4:7], s46 offen offset:0 sc1 lds
    v_mfma_f32_16x16x32_bf16 v[60:63], a[68:71], a[116:119], v[60:63]
    s_and_b32 s87, s3, 1
    s_add_u32 s95, s95, s87
    ds_read_b64_tr_b16 a[48:49], v225 offset:0
    v_mfma_f32_16x16x32_bf16 v[56:59], a[68:71], a[112:115], v[56:59]
    s_waitcnt lgkmcnt(3)
    ds_read_b64_tr_b16 a[50:51], v225 offset:2048
    v_max3_u32 v2, v2, v3, v4
    v_mfma_f32_16x16x32_bf16 v[44:47], a[68:71], a[108:111], v[44:47]
    s_lshl3_add_u32 s87, s95, s56
    ds_read_b64_tr_b16 a[52:53], v226 offset:0
    ds_read_b64_tr_b16 a[54:55], v226 offset:2048
    v_mfma_f32_16x16x32_bf16 v[40:43], a[68:71], a[104:107], v[40:43]
    buffer_load_dwordx4 v250, s[4:7], s46 offen offset:1024 sc1 lds
    v_mfma_f32_16x16x32_bf16 v[104:107], a[84:87], a[104:107], v[104:107]
    ds_read_b64_tr_b16 a[56:57], v227 offset:0
    v_max_u32 v2, v2, v5
    v_mfma_f32_16x16x32_bf16 v[108:111], a[84:87], a[108:111], v[108:111]
    s_barrier
    ds_read_b64_tr_b16 a[58:59], v227 offset:2048
    v_cmp_eq_u32 vcc, -1, v2
    v_mfma_f32_16x16x32_bf16 v[112:115], a[84:87], a[112:115], v[112:115]
    ds_read_b64_tr_b16 a[0:1], v229 offset:0
    ds_read_b64_tr_b16 a[2:3], v229 offset:1792
    v_mfma_f32_16x16x32_bf16 v[116:119], a[84:87], a[116:119], v[116:119]
    buffer_load_dwordx4 v250, s[4:7], s46 offen offset:2048 sc1 lds
    v_mfma_f32_16x16x32_bf16 v[92:95], a[76:79], a[116:119], v[92:95]
    ds_read_b128 v[148:151], v192 offset:448
    s_cbranch_vccnz C_rt8
C_ok8:
    v_mfma_f32_16x16x32_bf16 v[88:91], a[76:79], a[112:115], v[88:91]
    ds_read_b64_tr_b16 a[8:9], v229 offset:32
    v_mfma_f32_16x16x32_bf16 v[76:79], a[76:79], a[108:111], v[76:79]
    ds_read_b64_tr_b16 a[10:11], v229 offset:1824
    ds_read_b64_tr_b16 a[24:25], v231 offset:0
    v_mfma_f32_16x16x32_bf16 v[72:75], a[76:79], a[104:107], v[72:75]
    buffer_load_dwordx4 v250, s[4:7], s46 offen offset:3072 sc1 lds
    v_mfma_f32_16x16x32_bf16 v[16:19], a[64:67], a[104:107], v[16:19]
    ds_read_b64_tr_b16 a[26:27], v231 offset:1792
    v_mfma_f32_16x16x32_bf16 v[20:23], a[64:67], a[108:111], v[20:23]
    ds_read_b64_tr_b16 a[16:17], v229 offset:64
    v_mfma_f32_16x16x32_bf16 v[32:35], a[64:67], a[112:115], v[32:35]
    s_add_u32 m0, s33, 29696
    ds_read_b64_tr_b16 a[18:19], v229 offset:1856
    ds_read_b64_tr_b16 a[4:5], v229 offset:3712
    v_mfma_f32_16x16x32_bf16 v[36:39], a[64:67], a[116:119], v[36:39]
    buffer_load_dwordx4 v243, s[12:15], s32 offen lds
    v_mfma_f32_16x16x32_bf16 v[68:71], a[72:75], a[116:119], v[68:71]
    ds_read_b64_tr_b16 a[6:7], v229 offset:5504
    v_mfma_f32_16x16x32_bf16 v[64:67], a[72:75], a[112:115], v[64:67]
    ds_read_b64_tr_b16 a[12:13], v229 offset:3744
    v_mfma_f32_16x16x32_bf16 v[52:55], a[72:75], a[108:111], v[52:55]
    ds_read_b64_tr_b16 a[14:15], v229 offset:5536
    ds_read_b64_tr_b16 a[20:21], v229 offset:3776
    v_mfma_f32_16x16x32_bf16 v[48:51], a[72:75], a[104:107], v[48:51]
    buffer_load_dwordx4 v243, s[16:19], s32 offen offset:3712 lds
    v_mfma_f32_16x16x32_bf16 v[80:83], a[80:83], a[104:107], v[80:83]
    ds_read_b64_tr_b16 a[22:23], v229 offset:5568
    v_mfma_f32_16x16x32_bf16 v[84:87], a[80:83], a[108:111], v[84:87]
    s_waitcnt lgkmcnt(10)
    v_mfma_f32_16x16x32_bf16 v[96:99], a[80:83], a[112:115], v[96:99]
    s_add_u32 s94, s60, 0
    v_mfma_f32_16x16x32_bf16 v[100:103], a[80:83], a[116:119], v[100:103]
    buffer_load_dwordx4 a[120:123], v252, s[4:7], s94 offen offset:0 sc1
    v_mfma_f32_16x16x32_bf16 v[8:11], a[0:3], a[44:47], v[8:11]
    s_waitcnt vmcnt(15)
    ds_read2st64_b32 v[2:3], v232 offset0:64 offset1:68
    v_mfma_f32_16x16x32_bf16 v[12:15], a[0:3], a[48:51], v[12:15]
    ds_read2st64_b32 v[4:5], v232 offset0:72 offset1:76
    v_mfma_f32_16x16x32_bf16 v[24:27], a[0:3], a[52:55], v[24:27]
    s_add_u32 m0, s34, 0
    ds_read_b64_tr_b16 a[104:105], v224 offset:16384
    ds_read_b64_tr_b16 a[106:107], v224 offset:18432
    v_mfma_f32_16x16x32_bf16 v[28:31], a[0:3], a[56:59], v[28:31]
    buffer_load_dwordx4 v250, s[4:7], s47 offen offset:0 sc1 lds
    v_mfma_f32_16x16x32_bf16 v[60:63], a[8:11], a[56:59], v[60:63]
    ds_read_b64_tr_b16 a[108:109], v225 offset:16384
    v_mfma_f32_16x16x32_bf16 v[56:59], a[8:11], a[52:55], v[56:59]
    s_waitcnt lgkmcnt(3)
    ds_read_b64_tr_b16 a[110:111], v225 offset:18432
    v_max3_u32 v2, v2, v3, v4
    v_mfma_f32_16x16x32_bf16 v[44:47], a[8:11], a[48:51], v[44:47]
    ds_read_b64_tr_b16 a[112:113], v226 offset:16384
    ds_read_b64_tr_b16 a[114:115], v226 offset:18432
    v_mfma_f32_16x16x32_bf16 v[40:43], a[8:11], a[44:47], v[40:43]
    buffer_load_dwordx4 v250, s[4:7], s47 offen offset:1024 sc1 lds
    v_mfma_f32_16x16x32_bf16 v[104:107], a[24:27], a[44:47], v[104:107]
    ds_read_b64_tr_b16 a[116:117], v227 offset:16384
    v_max_u32 v2, v2, v5
    v_mfma_f32_16x16x32_bf16 v[160:163], a[44:47], a[44:47], v[160:163]
    v_mfma_f32_16x16x32_bf16 v[164:167], a[252:255], a[44:47], v[164:167]
    v_mfma_f32_16x16x32_bf16 v[108:111], a[24:27], a[48:51], v[108:111]
    ds_read_b64_tr_b16 a[118:119], v227 offset:18432
    v_cmp_eq_u32 vcc, -1, v2
    v_mfma_f32_16x16x32_bf16 v[112:115], a[24:27], a[52:55], v[112:115]
    ds_read_b64_tr_b16 a[60:61], v229 offset:7424
    ds_read_b64_tr_b16 a[62:63], v229 offset:9216
    v_mfma_f32_16x16x32_bf16 v[116:119], a[24:27], a[56:59], v[116:119]
    buffer_load_dwordx4 v250, s[4:7], s47 offen offset:2048 sc1 lds
    v_mfma_f32_16x16x32_bf16 v[92:95], a[16:19], a[56:59], v[92:95]
    s_cbranch_vccnz C_rt9
C_ok9:
    v_mfma_f32_16x16x32_bf16 v[88:91], a[16:19], a[52:55], v[88:91]
    ds_read_b64_tr_b16 a[68:69], v229 offset:7456
    v_mfma_f32_16x16x32_bf16 v[76:79], a[16:19], a[48:51], v[76:79]
    ds_read_b64_tr_b16 a[70:71], v229 offset:9248
    ds_read_b64_tr_b16 a[84:85], v231 offset:7424
    v_mfma_f32_16x16x32_bf16 v[72:75], a[16:19], a[44:47], v[72:75]
    buffer_load_dwordx4 v250, s[4:7], s47 offen offset:3072 sc1 lds
    v_mfma_f32_16x16x32_bf16 v[16:19], a[4:7], a[44:47], v[16:19]
    ds_read_b64_tr_b16 a[86:87], v231 offset:9216
    v_mfma_f32_16x16x32_bf16 v[20:23], a[4:7], a[48:51], v[20:23]
    ds_read_b64_tr_b16 a[76:77], v229 offset:7488
    v_mfma_f32_16x16x32_bf16 v[32:35], a[4:7], a[52:55], v[32:35]
    s_add_u32 m0, s33, 37120
    ds_read_b64_tr_b16 a[78:79], v229 offset:9280
    ds_read_b64_tr_b16 a[64:65], v229 offset:11136
    v_mfma_f32_16x16x32_bf16 v[36:39], a[4:7], a[56:59], v[36:39]
    buffer_load_dwordx4 v245, s[12:15], 0 offen lds
    v_mfma_f32_16x16x32_bf16 v[68:71], a[12:15], a[56:59], v[68:71]
    ds_read_b64_tr_b16 a[66:67], v229 offset:12928
    v_mfma_f32_16x16x32_bf16 v[64:67], a[12:15], a[52:55], v[64:67]
    ds_read_b64_tr_b16 a[72:73], v229 offset:11168
    v_mfma_f32_16x16x32_bf16 v[52:55], a[12:15], a[48:51], v[52:55]
    ds_read_b64_tr_b16 a[74:75], v229 offset:12960
    ds_read_b64_tr_b16 a[80:81], v229 offset:11200
    v_mfma_f32_16x16x32_bf16 v[48:51], a[12:15], a[44:47], v[48:51]
    buffer_load_dwordx4 v245, s[16:19], 0 offen offset:3712 lds
    v_mfma_f32_16x16x32_bf16 v[80:83], a[20:23], a[44:47], v[80:83]
    ds_read_b64_tr_b16 a[82:83], v229 offset:12992
    v_mfma_f32_16x16x32_bf16 v[84:87], a[20:23], a[48:51], v[84:87]
    s_waitcnt lgkmcnt(10)
    v_mfma_f32_16x16x32_bf16 v[96:99], a[20:23], a[52:55], v[96:99]
    v_mfma_f32_16x16x32_bf16 v[100:103], a[20:23], a[56:59], v[100:103]
    buffer_load_dwordx4 a[124:127], v252, s[4:7], s94 offen offset:1024 sc1
    v_mfma_f32_16x16x32_bf16 v[8:11], a[60:63], a[104:107], v[8:11]
    s_waitcnt vmcnt(16)
    ds_read2st64_b32 v[2:3], v232 offset0:128 offset1:132
    v_mfma_f32_16x16x32_bf16 v[12:15], a[60:63], a[108:111], v[12:15]
    ds_read2st64_b32 v[4:5], v232 offset0:136 offset1:140
    v_mfma_f32_16x16x32_bf16 v[24:27], a[60:63], a[112:115], v[24:27]
    s_add_u32 m0, s34, 16384
    ds_read_b64_tr_b16 a[44:45], v224 offset:32768
    ds_read_b64_tr_b16 a[46:47], v224 offset:34816
    v_mfma_f32_16x16x32_bf16 v[28:31], a[60:63], a[116:119], v[28:31]
    buffer_load_dwordx4 v250, s[4:7], s48 offen offset:0 sc1 lds
    v_mfma_f32_16x16x32_bf16 v[60:63], a[68:71], a[116:119], v[60:63]
    ds_read_b64_tr_b16 a[48:49], v225 offset:32768
    v_mfma_f32_16x16x32_bf16 v[56:59], a[68:71], a[112:115], v[56:59]
    s_waitcnt lgkmcnt(3)
    ds_read_b64_tr_b16 a[50:51], v225 offset:34816
    v_max3_u32 v2, v2, v3, v4
    v_mfma_f32_16x16x32_bf16 v[44:47], a[68:71], a[108:111], v[44:47]
    ds_read_b64_tr_b16 a[52:53], v226 offset:32768
    ds_read_b64_tr_b16 a[54:55], v226 offset:34816
    v_mfma_f32_16x16x32_bf16 v[40:43], a[68:71], a[104:107], v[40:43]
    buffer_load_dwordx4 v250, s[4:7], s48 offen offset:1024 sc1 lds
    v_mfma_f32_16x16x32_bf16 v[104:107], a[84:87], a[104:107], v[104:107]
    ds_read_b64_tr_b16 a[56:57], v227 offset:32768
    v_max_u32 v2, v2, v5
    v_mfma_f32_16x16x32_bf16 v[168:171], a[104:107], a[104:107], 0
    v_mfma_f32_16x16x32_bf16 v[172:175], a[252:255], a[104:107], 0
    v_mfma_f32_16x16x32_bf16 v[108:111], a[84:87], a[108:111], v[108:111]
    ds_read_b64_tr_b16 a[58:59], v227 offset:34816
    v_cmp_eq_u32 vcc, -1, v2
    v_mfma_f32_16x16x32_bf16 v[112:115], a[84:87], a[112:115], v[112:115]
    ds_read_b64_tr_b16 a[0:1], v229 offset:14848
    ds_read_b64_tr_b16 a[2:3], v229 offset:16640
    v_mfma_f32_16x16x32_bf16 v[116:119], a[84:87], a[116:119], v[116:119]
    buffer_load_dwordx4 v250, s[4:7], s48 offen offset:2048 sc1 lds
    v_mfma_f32_16x16x32_bf16 v[92:95], a[76:79], a[116:119], v[92:95]
    s_cbranch_vccnz C_rt10
C_ok10:
    v_mfma_f32_16x16x32_bf16 v[88:91], a[76:79], a[112:115], v[88:91]
    ds_read_b64_tr_b16 a[8:9], v229 offset:14880
    v_fma_f32 v160, v168, s59, v160
    v_mfma_f32_16x16x32_bf16 v[76:79], a[76:79], a[108:111], v[76:79]
    ds_read_b64_tr_b16 a[10:11], v229 offset:16672
    ds_read_b64_tr_b16 a[24:25], v231 offset:14848
    v_mfma_f32_16x16x32_bf16 v[72:75], a[76:79], a[104:107], v[72:75]
    buffer_load_dwordx4 v250, s[4:7], s48 offen offset:3072 sc1 lds
    v_mfma_f32_16x16x32_bf16 v[16:19], a[64:67], a[104:107], v[16:19]
    ds_read_b64_tr_b16 a[26:27], v231 offset:16640
    v_fma_f32 v161, v169, s59, v161
    v_mfma_f32_16x16x32_bf16 v[20:23], a[64:67], a[108:111], v[20:23]
    ds_read_b64_tr_b16 a[16:17], v229 offset:14912
    v_fma_f32 v162, v170, s59, v162
    v_mfma_f32_16x16x32_bf16 v[32:35], a[64:67], a[112:115], v[32:35]
    s_add_u32 m0, s33, 44544
    ds_read_b64_tr_b16 a[18:19], v229 offset:16704
    ds_read_b64_tr_b16 a[4:5], v229 offset:18560
    v_mfma_f32_16x16x32_bf16 v[36:39], a[64:67], a[116:119], v[36:39]
    buffer_load_dwordx4 v246, s[12:15], 0 offen lds
    v_mfma_f32_16x16x32_bf16 v[68:71], a[72:75], a[116:119], v[68:71]
    ds_read_b64_tr_b16 a[6:7], v229 offset:20352
    v_fma_f32 v163, v171, s59, v163
    v_mfma_f32_16x16x32_bf16 v[64:67], a[72:75], a[112:115], v[64:67]
    ds_read_b64_tr_b16 a[12:13], v229 offset:18592
    v_fma_f32 v164, v172, s59, v164
    v_mfma_f32_16x16x32_bf16 v[52:55], a[72:75], a[108:111], v[52:55]
    ds_read_b64_tr_b16 a[14:15], v229 offset:20384
    ds_read_b64_tr_b16 a[20:21], v229 offset:18624
    v_mfma_f32_16x16x32_bf16 v[48:51], a[72:75], a[104:107], v[48:51]
    buffer_load_dwordx4 v246, s[16:19], 0 offen offset:3712 lds
    v_mfma_f32_16x16x32_bf16 v[80:83], a[80:83], a[104:107], v[80:83]
    ds_read_b64_tr_b16 a[22:23], v229 offset:20416
    v_cndmask_b32 v165, v160, v161, s[36:37]
    v_mfma_f32_16x16x32_bf16 v[84:87], a[80:83], a[108:111], v[84:87]
    s_waitcnt lgkmcnt(10)
    v_cndmask_b32 v165, v165, v162, s[38:39]
    v_cndmask_b32 v165, v165, v163, s[40:41]
    v_mfma_f32_16x16x32_bf16 v[96:99], a[80:83], a[112:115], v[96:99]
    v_mfma_f32_16x16x32_bf16 v[100:103], a[80:83], a[116:119], v[100:103]
    buffer_store_dwordx2 v[164:165], v6, s[4:7], s87 offen sc1
    v_mfma_f32_16x16x32_bf16 v[8:11], a[0:3], a[44:47], v[8:11]
    s_and_b32 s92, s28, 1
    s_waitcnt vmcnt(17)
    ds_read2st64_b32 v[2:3], v232 offset0:192 offset1:196
    v_mfma_f32_16x16x32_bf16 v[12:15], a[0:3], a[48:51], v[12:15]
    s_lshl_b32 s92, s92, 1
    ds_read2st64_b32 v[4:5], v232 offset0:200 offset1:204
    v_bfe_u32 v233, v1, 3, 1
    v_mfma_f32_16x16x32_bf16 v[24:27], a[0:3], a[52:55], v[24:27]
    s_add_u32 m0, s34, 32768
    ds_read_b64_tr_b16 a[104:105], v224 offset:49152
    ds_read_b64_tr_b16 a[106:107], v224 offset:51200
    v_mfma_f32_16x16x32_bf16 v[28:31], a[0:3], a[56:59], v[28:31]
    buffer_load_dwordx4 v250, s[4:7], s49 offen offset:0 sc1 lds
    v_mfma_f32_16x16x32_bf16 v[60:63], a[8:11], a[56:59], v[60:63]
    ds_read_b64_tr_b16 a[108:109], v225 offset:49152
    v_add_u32 v233, s92, v233
    v_mfma_f32_16x16x32_bf16 v[56:59], a[8:11], a[52:55], v[56:59]
    s_waitcnt lgkmcnt(3)
    ds_read_b64_tr_b16 a[110:111], v225 offset:51200
    v_max3_u32 v2, v2, v3, v4
    v_mfma_f32_16x16x32_bf16 v[44:47], a[8:11], a[48:51], v[44:47]
    ds_read_b64_tr_b16 a[112:113], v226 offset:49152
    ds_read_b64_tr_b16 a[114:115], v226 offset:51200
    v_mfma_f32_16x16x32_bf16 v[40:43], a[8:11], a[44:47], v[40:43]
    buffer_load_dwordx4 v250, s[4:7], s49 offen offset:1024 sc1 lds
    v_mfma_f32_16x16x32_bf16 v[104:107], a[24:27], a[44:47], v[104:107]
    ds_read_b64_tr_b16 a[116:117], v227 offset:49152
    v_max_u32 v2, v2, v5
    v_mfma_f32_16x16x32_bf16 v[108:111], a[24:27], a[48:51], v[108:111]
    ds_read_b64_tr_b16 a[118:119], v227 offset:51200
    v_cmp_eq_u32 vcc, -1, v2
    v_mfma_f32_16x16x32_bf16 v[112:115], a[24:27], a[52:55], v[112:115]
    ds_read_b64_tr_b16 a[60:61], v229 offset:22272
    ds_read_b64_tr_b16 a[62:63], v229 offset:24064
    v_mfma_f32_16x16x32_bf16 v[116:119], a[24:27], a[56:59], v[116:119]
    buffer_load_dwordx4 v250, s[4:7], s49 offen offset:2048 sc1 lds
    v_mfma_f32_16x16x32_bf16 v[92:95], a[16:19], a[56:59], v[92:95]
    s_cbranch_vccnz C_rt11
C_ok11:
    v_mfma_f32_16x16x32_bf16 v[88:91], a[16:19], a[52:55], v[88:91]
    ds_read_b64_tr_b16 a[68:69], v229 offset:22304
    v_lshrrev_b32 v234, 4, v1
    v_mfma_f32_16x16x32_bf16 v[76:79], a[16:19], a[48:51], v[76:79]
    ds_read_b64_tr_b16 a[70:71], v229 offset:24096
    ds_read_b64_tr_b16 a[84:85], v231 offset:22272
    v_mfma_f32_16x16x32_bf16 v[72:75], a[16:19], a[44:47], v[72:75]
    buffer_load_dwordx4 v250, s[4:7], s49 offen offset:3072 sc1 lds
    v_mfma_f32_16x16x32_bf16 v[16:19], a[4:7], a[44:47], v[16:19]
    ds_read_b64_tr_b16 a[86:87], v231 offset:24064
    v_xor_b32 v233, v233, v234
    v_mfma_f32_16x16x32_bf16 v[20:23], a[4:7], a[48:51], v[20:23]
    ds_read_b64_tr_b16 a[76:77], v229 offset:22336
    v_bfe_u32 v234, v1, 1, 2
    v_mfma_f32_16x16x32_bf16 v[32:35], a[4:7], a[52:55], v[32:35]
    s_add_u32 m0, s33, 51968
    ds_read_b64_tr_b16 a[78:79], v229 offset:24128
    ds_read_b64_tr_b16 a[64:65], v229 offset:25984
    v_mfma_f32_16x16x32_bf16 v[36:39], a[4:7], a[56:59], v[36:39]
    buffer_load_dwordx4 v247, s[12:15], 0 offen lds
    v_mfma_f32_16x16x32_bf16 v[68:71], a[12:15], a[56:59], v[68:71]
    ds_read_b64_tr_b16 a[66:67], v229 offset:27776
    v_lshl_add_u32 v233, v233, 2, v234
    v_mfma_f32_16x16x32_bf16 v[64:67], a[12:15], a[52:55], v[64:67]
    ds_read_b64_tr_b16 a[72:73], v229 offset:26016
    v_and_b32 v234, 1, v1
    v_mfma_f32_16x16x32_bf16 v[52:55], a[12:15], a[48:51], v[52:55]
    ds_read_b64_tr_b16 a[74:75], v229 offset:27808
    ds_read_b64_tr_b16 a[80:81], v229 offset:26048
    v_mfma_f32_16x16x32_bf16 v[48:51], a[12:15], a[44:47], v[48:51]
    buffer_load_dwordx4 v247, s[16:19], 0 offen offset:3712 lds
    v_mfma_f32_16x16x32_bf16 v[80:83], a[20:23], a[44:47], v[80:83]
    ds_read_b64_tr_b16 a[82:83], v229 offset:27840
    v_lshlrev_b32 v234, 4, v234
    v_mfma_f32_16x16x32_bf16 v[84:87], a[20:23], a[48:51], v[84:87]
    s_movk_i32 s92, 0x3f80
    s_waitcnt lgkmcnt(10)
    v_lshlrev_b32 v234, v234, s92
    v_mfma_f32_16x16x32_bf16 v[96:99], a[20:23], a[52:55], v[96:99]
    v_cmp_eq_u32 s[36:37], 0, v233
    v_cmp_eq_u32 s[38:39], 1, v233
    v_mfma_f32_16x16x32_bf16 v[100:103], a[20:23], a[56:59], v[100:103]
    buffer_load_dwordx4 a[128:131], v252, s[4:7], s94 offen offset:2048 sc1
    v_mfma_f32_16x16x32_bf16 v[8:11], a[60:63], a[104:107], v[8:11]
    s_waitcnt vmcnt(17)
    ds_read2st64_b32 v[2:3], v232 offset0:0 offset1:4
    v_mfma_f32_16x16x32_bf16 v[12:15], a[60:63], a[108:111], v[12:15]
    ds_read2st64_b32 v[4:5], v232 offset0:8 offset1:12
    v_max3_u32 v193, v120, v124, v128
    v_mfma_f32_16x16x32_bf16 v[24:27], a[60:63], a[112:115], v[24:27]
    s_add_u32 m0, s34, 49152
    ds_read_b64_tr_b16 a[44:45], v224 offset:0
    ds_read_b64_tr_b16 a[46:47], v224 offset:2048
    v_mfma_f32_16x16x32_bf16 v[28:31], a[60:63], a[116:119], v[28:31]
    buffer_load_dwordx4 v250, s[4:7], s50 offen offset:0 sc1 lds
    v_mfma_f32_16x16x32_bf16 v[60:63], a[68:71], a[116:119], v[60:63]
    ds_read_b64_tr_b16 a[48:49], v225 offset:0
    v_max3_u32 v193, v193, v132, v136
    v_mfma_f32_16x16x32_bf16 v[56:59], a[68:71], a[112:115], v[56:59]
    s_waitcnt lgkmcnt(3)
    ds_read_b64_tr_b16 a[50:51], v225 offset:2048
    v_max3_u32 v2, v2, v3, v4
    v_mfma_f32_16x16x32_bf16 v[44:47], a[68:71], a[108:111], v[44:47]
    ds_read_b64_tr_b16 a[52:53], v226 offset:0
    ds_read_b64_tr_b16 a[54:55], v226 offset:2048
    v_mfma_f32_16x16x32_bf16 v[40:43], a[68:71], a[104:107], v[40:43]
    buffer_load_dwordx4 v250, s[4:7], s50 offen offset:1024 sc1 lds
    v_mfma_f32_16x16x32_bf16 v[104:107], a[84:87], a[104:107], v[104:107]
    ds_read_b64_tr_b16 a[56:57], v227 offset:0
    v_max_u32 v2, v2, v5
    v_mfma_f32_16x16x32_bf16 v[108:111], a[84:87], a[108:111], v[108:111]
    s_barrier
    ds_read_b64_tr_b16 a[58:59], v227 offset:2048
    v_cmp_eq_u32 vcc, -1, v2
    v_mfma_f32_16x16x32_bf16 v[112:115], a[84:87], a[112:115], v[112:115]
    ds_read_b64_tr_b16 a[0:1], v228 offset:0
    ds_read_b64_tr_b16 a[2:3], v228 offset:1792
    v_mfma_f32_16x16x32_bf16 v[116:119], a[84:87], a[116:119], v[116:119]
    buffer_load_dwordx4 v250, s[4:7], s50 offen offset:2048 sc1 lds
    v_mfma_f32_16x16x32_bf16 v[92:95], a[76:79], a[116:119], v[92:95]
    s_cbranch_vccnz C_rt12
C_ok12:
    v_mfma_f32_16x16x32_bf16 v[88:91], a[76:79], a[112:115], v[88:91]
    ds_read_b64_tr_b16 a[8:9], v228 offset:32
    v_max3_u32 v193, v193, v140, v144
    v_mfma_f32_16x16x32_bf16 v[76:79], a[76:79], a[108:111], v[76:79]
    ds_read_b64_tr_b16 a[10:11], v228 offset:1824
    ds_read_b64_tr_b16 a[24:25], v230 offset:0
    v_mfma_f32_16x16x32_bf16 v[72:75], a[76:79], a[104:107], v[72:75]
    buffer_load_dwordx4 v250, s[4:7], s50 offen offset:3072 sc1 lds
    v_mfma_f32_16x16x32_bf16 v[16:19], a[64:67], a[104:107], v[16:19]
    ds_read_b64_tr_b16 a[26:27], v230 offset:1792
    v_max_u32 v193, v193, v148
    v_mfma_f32_16x16x32_bf16 v[20:23], a[64:67], a[108:111], v[20:23]
    ds_read_b64_tr_b16 a[16:17], v228 offset:64
    v_cmp_eq_u32 vcc, -1, v193
    v_mfma_f32_16x16x32_bf16 v[32:35], a[64:67], a[112:115], v[32:35]
    ds_read_b64_tr_b16 a[18:19], v228 offset:1856
    ds_read_b64_tr_b16 a[4:5], v228 offset:3712
    v_mfma_f32_16x16x32_bf16 v[36:39], a[64:67], a[116:119], v[36:39]
    buffer_load_dwordx4 a[132:135], v252, s[4:7], s94 offen offset:3072 sc1
    v_mfma_f32_16x16x32_bf16 v[68:71], a[72:75], a[116:119], v[68:71]
    ds_read_b64_tr_b16 a[6:7], v228 offset:5504
    v_cmp_eq_u32 s[40:41], 2, v233
    v_mfma_f32_16x16x32_bf16 v[64:67], a[72:75], a[112:115], v[64:67]
    ds_read_b64_tr_b16 a[12:13], v228 offset:3744
    v_cndmask_b32 v235, 0, v234, s[36:37]
    v_mfma_f32_16x16x32_bf16 v[52:55], a[72:75], a[108:111], v[52:55]
    s_add_u32 s94, s60, 4096
    ds_read_b64_tr_b16 a[14:15], v228 offset:5536
    ds_read_b64_tr_b16 a[20:21], v228 offset:3776
    v_mfma_f32_16x16x32_bf16 v[48:51], a[72:75], a[104:107], v[48:51]
    buffer_load_dwordx4 a[136:139], v252, s[4:7], s94 offen offset:0 sc1
    v_mfma_f32_16x16x32_bf16 v[80:83], a[80:83], a[104:107], v[80:83]
    ds_read_b64_tr_b16 a[22:23], v228 offset:5568
    v_cmp_eq_u32 s[36:37], 3, v233
    v_mfma_f32_16x16x32_bf16 v[84:87], a[80:83], a[108:111], v[84:87]
    s_waitcnt lgkmcnt(10)
    v_accvgpr_write_b32 a252, v235
    v_cndmask_b32 v235, 0, v234, s[38:39]
    v_mfma_f32_16x16x32_bf16 v[96:99], a[80:83], a[112:115], v[96:99]
    s_cbranch_vccnz C_cs_rt
C_cs_ok:
    v_mfma_f32_16x16x32_bf16 v[100:103], a[80:83], a[116:119], v[100:103]
    buffer_load_dwordx4 a[140:143], v252, s[4:7], s94 offen offset:1024 sc1
    v_mfma_f32_16x16x32_bf16 v[8:11], a[0:3], a[44:47], v[8:11]
    s_lshl_b32 s88, s28, 10
    s_waitcnt vmcnt(17)
    ds_read2st64_b32 v[2:3], v232 offset0:64 offset1:68
    v_mfma_f32_16x16x32_bf16 v[12:15], a[0:3], a[48:51], v[12:15]
    s_add_u32 s88, s88, 154496
    s_lshl_b32 s89, s78, 8
    ds_read2st64_b32 v[4:5], v232 offset0:72 offset1:76
    v_mfma_f32_16x16x32_bf16 v[24:27], a[0:3], a[52:55], v[24:27]
    s_add_u32 m0, s34, 0
    ds_read_b64_tr_b16 a[104:105], v224 offset:16384
    ds_read_b64_tr_b16 a[106:107], v224 offset:18432
    v_mfma_f32_16x16x32_bf16 v[28:31], a[0:3], a[56:59], v[28:31]
    buffer_load_dwordx4 v250, s[4:7], s51 offen offset:0 sc1 lds
    v_mfma_f32_16x16x32_bf16 v[60:63], a[8:11], a[56:59], v[60:63]
    ds_read_b64_tr_b16 a[108:109], v225 offset:16384
    v_and_b32 v198, 0xf0, v252
    v_mfma_f32_16x16x32_bf16 v[56:59], a[8:11], a[52:55], v[56:59]
    s_waitcnt lgkmcnt(3)
    ds_read_b64_tr_b16 a[110:111], v225 offset:18432
    v_max3_u32 v2, v2, v3, v4
    v_mfma_f32_16x16x32_bf16 v[44:47], a[8:11], a[48:51], v[44:47]
    ds_read_b64_tr_b16 a[112:113], v226 offset:16384
    ds_read_b64_tr_b16 a[114:115], v226 offset:18432
    v_mfma_f32_16x16x32_bf16 v[40:43], a[8:11], a[44:47], v[40:43]
    buffer_load_dwordx4 v250, s[4:7], s51 offen offset:1024 sc1 lds
    v_mfma_f32_16x16x32_bf16 v[104:107], a[24:27], a[44:47], v[104:107]
    ds_read_b64_tr_b16 a[116:117], v227 offset:16384
    v_max_u32 v2, v2, v5
    v_mfma_f32_16x16x32_bf16 v[108:111], a[24:27], a[48:51], v[108:111]
    ds_read_b64_tr_b16 a[118:119], v227 offset:18432
    v_cmp_eq_u32 vcc, -1, v2
    v_mfma_f32_16x16x32_bf16 v[112:115], a[24:27], a[52:55], v[112:115]
    ds_read_b64_tr_b16 a[60:61], v228 offset:7424
    ds_read_b64_tr_b16 a[62:63], v228 offset:9216
    v_mfma_f32_16x16x32_bf16 v[116:119], a[24:27], a[56:59], v[116:119]
    buffer_load_dwordx4 v250, s[4:7], s51 offen offset:2048 sc1 lds
    v_mfma_f32_16x16x32_bf16 v[92:95], a[16:19], a[56:59], v[92:95]
    s_cbranch_vccnz C_rt13
C_ok13:
    v_mfma_f32_16x16x32_bf16 v[88:91], a[16:19], a[52:55], v[88:91]
    ds_read_b64_tr_b16 a[68:69], v228 offset:7456
    v_xor_b32 v198, s89, v198
    v_mfma_f32_16x16x32_bf16 v[76:79], a[16:19], a[48:51], v[76:79]
    ds_read_b64_tr_b16 a[70:71], v228 offset:9248
    ds_read_b64_tr_b16 a[84:85], v230 offset:7424
    v_mfma_f32_16x16x32_bf16 v[72:75], a[16:19], a[44:47], v[72:75]
    buffer_load_dwordx4 v250, s[4:7], s51 offen offset:3072 sc1 lds
    v_mfma_f32_16x16x32_bf16 v[16:19], a[4:7], a[44:47], v[16:19]
    ds_read_b64_tr_b16 a[86:87], v230 offset:9216
    v_and_b32 v197, 0x200, v252
    v_mfma_f32_16x16x32_bf16 v[20:23], a[4:7], a[48:51], v[20:23]
    ds_read_b64_tr_b16 a[76:77], v228 offset:7488
    v_lshrrev_b32 v197, 1, v197
    v_mfma_f32_16x16x32_bf16 v[32:35], a[4:7], a[52:55], v[32:35]
    ds_read_b64_tr_b16 a[78:79], v228 offset:9280
    ds_read_b64_tr_b16 a[64:65], v228 offset:11136
    v_mfma_f32_16x16x32_bf16 v[36:39], a[4:7], a[56:59], v[36:39]
    buffer_load_dwordx4 a[144:147], v252, s[4:7], s94 offen offset:2048 sc1
    v_mfma_f32_16x16x32_bf16 v[68:71], a[12:15], a[56:59], v[68:71]
    ds_read_b64_tr_b16 a[66:67], v228 offset:12928
    v_xor_b32 v197, v197, v198
    v_mfma_f32_16x16x32_bf16 v[64:67], a[12:15], a[52:55], v[64:67]
    ds_read_b64_tr_b16 a[72:73], v228 offset:11168
    v_xor_b32 v200, 0x200, v197
    v_mfma_f32_16x16x32_bf16 v[52:55], a[12:15], a[48:51], v[52:55]
    ds_read_b64_tr_b16 a[74:75], v228 offset:12960
    ds_read_b64_tr_b16 a[80:81], v228 offset:11200
    v_mfma_f32_16x16x32_bf16 v[48:51], a[12:15], a[44:47], v[48:51]
    buffer_load_dwordx4 a[148:151], v252, s[4:7], s94 offen offset:3072 sc1
    v_mfma_f32_16x16x32_bf16 v[80:83], a[20:23], a[44:47], v[80:83]
    ds_read_b64_tr_b16 a[82:83], v228 offset:12992
    v_xor_b32 v201, 256, v198
    v_mfma_f32_16x16x32_bf16 v[84:87], a[20:23], a[48:51], v[84:87]
    s_waitcnt lgkmcnt(10)
    v_xor_b32 v202, 512, v198
    v_xor_b32 v203, 768, v198
    v_mfma_f32_16x16x32_bf16 v[96:99], a[20:23], a[52:55], v[96:99]
    s_add_u32 s94, s60, 8192
    v_add_u32 v198, s88, v198
    v_add_u32 v202, s88, v202
    v_mfma_f32_16x16x32_bf16 v[100:103], a[20:23], a[56:59], v[100:103]
    buffer_load_dwordx4 a[152:155], v252, s[4:7], s94 offen offset:0 sc1
    v_mfma_f32_16x16x32_bf16 v[8:11], a[60:63], a[104:107], v[8:11]
    s_waitcnt vmcnt(17)
    ds_read2st64_b32 v[2:3], v232 offset0:128 offset1:132
    v_add_u32 v203, s88, v203
    v_mfma_f32_16x16x32_bf16 v[12:15], a[60:63], a[108:111], v[12:15]
    ds_read2st64_b32 v[4:5], v232 offset0:136 offset1:140
    v_add_u32 v197, s88, v197
    v_mfma_f32_16x16x32_bf16 v[24:27], a[60:63], a[112:115], v[24:27]
    s_add_u32 m0, s34, 16384
    ds_read_b64_tr_b16 a[44:45], v224 offset:32768
    ds_read_b64_tr_b16 a[46:47], v224 offset:34816
    v_mfma_f32_16x16x32_bf16 v[28:31], a[60:63], a[116:119], v[28:31]
    buffer_load_dwordx4 v251, s[4:7], s53 offen offset:0 sc1 lds
    v_mfma_f32_16x16x32_bf16 v[60:63], a[68:71], a[116:119], v[60:63]
    ds_read_b64_tr_b16 a[48:49], v225 offset:32768
    v_add_u32 v200, s88, v200
    v_mfma_f32_16x16x32_bf16 v[56:59], a[68:71], a[112:115], v[56:59]
    s_waitcnt lgkmcnt(3)
    ds_read_b64_tr_b16 a[50:51], v225 offset:34816
    v_max3_u32 v2, v2, v3, v4
    v_mfma_f32_16x16x32_bf16 v[44:47], a[68:71], a[108:111], v[44:47]
    ds_read_b64_tr_b16 a[52:53], v226 offset:32768
    ds_read_b64_tr_b16 a[54:55], v226 offset:34816
    v_mfma_f32_16x16x32_bf16 v[40:43], a[68:71], a[104:107], v[40:43]
    buffer_load_dwordx4 v251, s[4:7], s53 offen offset:1024 sc1 lds
    v_mfma_f32_16x16x32_bf16 v[104:107], a[84:87], a[104:107], v[104:107]
    ds_read_b64_tr_b16 a[56:57], v227 offset:32768
    v_max_u32 v2, v2, v5
    v_mfma_f32_16x16x32_bf16 v[108:111], a[84:87], a[108:111], v[108:111]
    ds_read_b64_tr_b16 a[58:59], v227 offset:34816
    v_cmp_eq_u32 vcc, -1, v2
    v_mfma_f32_16x16x32_bf16 v[112:115], a[84:87], a[112:115], v[112:115]
    ds_read_b64_tr_b16 a[0:1], v228 offset:14848
    ds_read_b64_tr_b16 a[2:3], v228 offset:16640
    v_mfma_f32_16x16x32_bf16 v[116:119], a[84:87], a[116:119], v[116:119]
    buffer_load_dwordx4 v251, s[4:7], s53 offen offset:2048 sc1 lds
    v_mfma_f32_16x16x32_bf16 v[92:95], a[76:79], a[116:119], v[92:95]
    s_cbranch_vccnz C_rt14
C_ok14:
    v_mfma_f32_16x16x32_bf16 v[88:91], a[76:79], a[112:115], v[88:91]
    ds_read_b64_tr_b16 a[8:9], v228 offset:14880
    v_add_u32 v201, s88, v201
    v_mfma_f32_16x16x32_bf16 v[76:79], a[76:79], a[108:111], v[76:79]
    ds_read_b64_tr_b16 a[10:11], v228 offset:16672
    ds_read_b64_tr_b16 a[24:25], v230 offset:14848
    v_mfma_f32_16x16x32_bf16 v[72:75], a[76:79], a[104:107], v[72:75]
    buffer_load_dwordx4 v251, s[4:7], s53 offen offset:3072 sc1 lds
    v_mfma_f32_16x16x32_bf16 v[16:19], a[64:67], a[104:107], v[16:19]
    ds_read_b64_tr_b16 a[26:27], v230 offset:16640
    v_add_u32 v199, s88, v252
    v_mfma_f32_16x16x32_bf16 v[20:23], a[64:67], a[108:111], v[20:23]
    s_lshl_b32 s89, s78, 10
    ds_read_b64_tr_b16 a[16:17], v228 offset:14912
    v_xor_b32 v248, s89, v248
    v_mfma_f32_16x16x32_bf16 v[32:35], a[64:67], a[112:115], v[32:35]
    ds_read_b64_tr_b16 a[18:19], v228 offset:16704
    ds_read_b64_tr_b16 a[4:5], v228 offset:18560
    v_mfma_f32_16x16x32_bf16 v[36:39], a[64:67], a[116:119], v[36:39]
    buffer_load_dwordx4 a[156:159], v252, s[4:7], s94 offen offset:1024 sc1
    v_mfma_f32_16x16x32_bf16 v[68:71], a[72:75], a[116:119], v[68:71]
    ds_read_b64_tr_b16 a[6:7], v228 offset:20352
    v_xor_b32 v220, 0x800, v248
    v_mfma_f32_16x16x32_bf16 v[64:67], a[72:75], a[112:115], v[64:67]
    ds_read_b64_tr_b16 a[12:13], v228 offset:18592
    v_accvgpr_write_b32 a253, v235
    v_mfma_f32_16x16x32_bf16 v[52:55], a[72:75], a[108:111], v[52:55]
    ds_read_b64_tr_b16 a[14:15], v228 offset:20384
    ds_read_b64_tr_b16 a[20:21], v228 offset:18624
    v_mfma_f32_16x16x32_bf16 v[48:51], a[72:75], a[104:107], v[48:51]
    buffer_load_dwordx4 a[160:163], v252, s[4:7], s94 offen offset:2048 sc1
    v_mfma_f32_16x16x32_bf16 v[80:83], a[80:83], a[104:107], v[80:83]
    ds_read_b64_tr_b16 a[22:23], v228 offset:20416
    v_cndmask_b32 v235, 0, v234, s[40:41]
    v_mfma_f32_16x16x32_bf16 v[84:87], a[80:83], a[108:111], v[84:87]
    s_waitcnt lgkmcnt(10)
    v_accvgpr_write_b32 a254, v235
    v_cndmask_b32 v235, 0, v234, s[36:37]
    v_mfma_f32_16x16x32_bf16 v[96:99], a[80:83], a[112:115], v[96:99]
    v_accvgpr_write_b32 a255, v235
    v_mfma_f32_16x16x32_bf16 v[100:103], a[80:83], a[116:119], v[100:103]
    buffer_load_dwordx4 a[164:167], v252, s[4:7], s94 offen offset:3072 sc1
    v_mfma_f32_16x16x32_bf16 v[8:11], a[0:3], a[44:47], v[8:11]
    s_waitcnt vmcnt(17)
    ds_read2st64_b32 v[2:3], v232 offset0:192 offset1:196
    v_mfma_f32_16x16x32_bf16 v[12:15], a[0:3], a[48:51], v[12:15]
    ds_read2st64_b32 v[4:5], v232 offset0:200 offset1:204
    v_mfma_f32_16x16x32_bf16 v[24:27], a[0:3], a[52:55], v[24:27]
    s_add_u32 m0, s34, 32768
    ds_read_b64_tr_b16 a[104:105], v224 offset:49152
    ds_read_b64_tr_b16 a[106:107], v224 offset:51200
    v_mfma_f32_16x16x32_bf16 v[28:31], a[0:3], a[56:59], v[28:31]
    buffer_load_dwordx4 v251, s[4:7], s54 offen offset:0 sc1 lds
    v_mfma_f32_16x16x32_bf16 v[60:63], a[8:11], a[56:59], v[60:63]
    ds_read_b64_tr_b16 a[108:109], v225 offset:49152
    v_mfma_f32_16x16x32_bf16 v[56:59], a[8:11], a[52:55], v[56:59]
    s_waitcnt lgkmcnt(3)
    ds_read_b64_tr_b16 a[110:111], v225 offset:51200
    v_max3_u32 v2, v2, v3, v4
    v_mfma_f32_16x16x32_bf16 v[44:47], a[8:11], a[48:51], v[44:47]
    ds_read_b64_tr_b16 a[112:113], v226 offset:49152
    ds_read_b64_tr_b16 a[114:115], v226 offset:51200
    v_mfma_f32_16x16x32_bf16 v[40:43], a[8:11], a[44:47], v[40:43]
    buffer_load_dwordx4 v251, s[4:7], s54 offen offset:1024 sc1 lds
    v_mfma_f32_16x16x32_bf16 v[104:107], a[24:27], a[44:47], v[104:107]
    ds_read_b64_tr_b16 a[116:117], v227 offset:49152
    v_max_u32 v2, v2, v5
    v_mfma_f32_16x16x32_bf16 v[108:111], a[24:27], a[48:51], v[108:111]
    ds_read_b64_tr_b16 a[118:119], v227 offset:51200
    v_cmp_eq_u32 vcc, -1, v2
    v_mfma_f32_16x16x32_bf16 v[112:115], a[24:27], a[52:55], v[112:115]
    ds_read_b64_tr_b16 a[60:61], v228 offset:22272
    ds_read_b64_tr_b16 a[62:63], v228 offset:24064
    v_mfma_f32_16x16x32_bf16 v[116:119], a[24:27], a[56:59], v[116:119]
    buffer_load_dwordx4 v251, s[4:7], s54 offen offset:2048 sc1 lds
    v_mfma_f32_16x16x32_bf16 v[92:95], a[16:19], a[56:59], v[92:95]
    s_cbranch_vccnz C_rt15
C_ok15:
    v_mfma_f32_16x16x32_bf16 v[88:91], a[16:19], a[52:55], v[88:91]
    ds_read_b64_tr_b16 a[68:69], v228 offset:22304
    v_mfma_f32_16x16x32_bf16 v[76:79], a[16:19], a[48:51], v[76:79]
    ds_read_b64_tr_b16 a[70:71], v228 offset:24096
    ds_read_b64_tr_b16 a[84:85], v230 offset:22272
    v_mfma_f32_16x16x32_bf16 v[72:75], a[16:19], a[44:47], v[72:75]
    buffer_load_dwordx4 v251, s[4:7], s54 offen offset:3072 sc1 lds
    v_mfma_f32_16x16x32_bf16 v[16:19], a[4:7], a[44:47], v[16:19]
    ds_read_b64_tr_b16 a[86:87], v230 offset:24064
    v_mfma_f32_16x16x32_bf16 v[20:23], a[4:7], a[48:51], v[20:23]
    ds_read_b64_tr_b16 a[76:77], v228 offset:22336
    v_mfma_f32_16x16x32_bf16 v[32:35], a[4:7], a[52:55], v[32:35]
    s_add_u32 s94, s60, 12288
    ds_read_b64_tr_b16 a[78:79], v228 offset:24128
    ds_read_b64_tr_b16 a[64:65], v228 offset:25984
    v_mfma_f32_16x16x32_bf16 v[36:39], a[4:7], a[56:59], v[36:39]
    buffer_load_dwordx4 a[168:171], v252, s[4:7], s94 offen offset:0 sc1
    v_mfma_f32_16x16x32_bf16 v[68:71], a[12:15], a[56:59], v[68:71]
    ds_read_b64_tr_b16 a[66:67], v228 offset:27776
    v_mfma_f32_16x16x32_bf16 v[64:67], a[12:15], a[52:55], v[64:67]
    ds_read_b64_tr_b16 a[72:73], v228 offset:26016
    v_mfma_f32_16x16x32_bf16 v[52:55], a[12:15], a[48:51], v[52:55]
    ds_read_b64_tr_b16 a[74:75], v228 offset:27808
    ds_read_b64_tr_b16 a[80:81], v228 offset:26048
    v_mfma_f32_16x16x32_bf16 v[48:51], a[12:15], a[44:47], v[48:51]
    buffer_load_dwordx4 a[172:175], v252, s[4:7], s94 offen offset:1024 sc1
    v_mfma_f32_16x16x32_bf16 v[80:83], a[20:23], a[44:47], v[80:83]
    ds_read_b64_tr_b16 a[82:83], v228 offset:27840
    v_mfma_f32_16x16x32_bf16 v[84:87], a[20:23], a[48:51], v[84:87]
    s_waitcnt lgkmcnt(10)
    v_mfma_f32_16x16x32_bf16 v[96:99], a[20:23], a[52:55], v[96:99]
    v_mfma_f32_16x16x32_bf16 v[100:103], a[20:23], a[56:59], v[100:103]
    buffer_load_dwordx4 a[176:179], v252, s[4:7], s94 offen offset:2048 sc1
    v_mfma_f32_16x16x32_bf16 v[8:11], a[60:63], a[104:107], v[8:11]
    s_waitcnt vmcnt(17)
    ds_read2st64_b32 v[2:3], v232 offset0:0 offset1:4
    v_mfma_f32_16x16x32_bf16 v[12:15], a[60:63], a[108:111], v[12:15]
    ds_read2st64_b32 v[4:5], v232 offset0:8 offset1:12
    v_mfma_f32_16x16x32_bf16 v[24:27], a[60:63], a[112:115], v[24:27]
    s_add_u32 m0, s34, 49152
    ds_read_b64_tr_b16 a[44:45], v224 offset:0
    ds_read_b64_tr_b16 a[46:47], v224 offset:2048
    v_mfma_f32_16x16x32_bf16 v[28:31], a[60:63], a[116:119], v[28:31]
    buffer_load_dwordx4 v251, s[4:7], s55 offen offset:0 sc1 lds
    v_mfma_f32_16x16x32_bf16 v[60:63], a[68:71], a[116:119], v[60:63]
    ds_read_b64_tr_b16 a[48:49], v225 offset:0
    v_mfma_f32_16x16x32_bf16 v[56:59], a[68:71], a[112:115], v[56:59]
    s_waitcnt lgkmcnt(3)
    ds_read_b64_tr_b16 a[50:51], v225 offset:2048
    v_max3_u32 v2, v2, v3, v4
    v_mfma_f32_16x16x32_bf16 v[44:47], a[68:71], a[108:111], v[44:47]
    ds_read_b64_tr_b16 a[52:53], v226 offset:0
    ds_read_b64_tr_b16 a[54:55], v226 offset:2048
    v_mfma_f32_16x16x32_bf16 v[40:43], a[68:71], a[104:107], v[40:43]
    buffer_load_dwordx4 v251, s[4:7], s55 offen offset:1024 sc1 lds
    v_mfma_f32_16x16x32_bf16 v[104:107], a[84:87], a[104:107], v[104:107]
    ds_read_b64_tr_b16 a[56:57], v227 offset:0
    v_max_u32 v2, v2, v5
    v_mfma_f32_16x16x32_bf16 v[108:111], a[84:87], a[108:111], v[108:111]
    s_barrier
    ds_read_b64_tr_b16 a[58:59], v227 offset:2048
    v_cmp_eq_u32 vcc, -1, v2
    v_mfma_f32_16x16x32_bf16 v[112:115], a[84:87], a[112:115], v[112:115]
    ds_read_b64_tr_b16 a[0:1], v228 offset:29696
    ds_read_b64_tr_b16 a[2:3], v228 offset:31488
    v_mfma_f32_16x16x32_bf16 v[116:119], a[84:87], a[116:119], v[116:119]
    buffer_load_dwordx4 v251, s[4:7], s55 offen offset:2048 sc1 lds
    v_mfma_f32_16x16x32_bf16 v[92:95], a[76:79], a[116:119], v[92:95]
    s_cbranch_vccnz C_rt16
C_ok16:
    v_mfma_f32_16x16x32_bf16 v[88:91], a[76:79], a[112:115], v[88:91]
    ds_read_b64_tr_b16 a[8:9], v228 offset:29728
    v_mfma_f32_16x16x32_bf16 v[76:79], a[76:79], a[108:111], v[76:79]
    ds_read_b64_tr_b16 a[10:11], v228 offset:31520
    ds_read_b64_tr_b16 a[24:25], v230 offset:29696
    v_mfma_f32_16x16x32_bf16 v[72:75], a[76:79], a[104:107], v[72:75]
    buffer_load_dwordx4 v251, s[4:7], s55 offen offset:3072 sc1 lds
    v_mfma_f32_16x16x32_bf16 v[16:19], a[64:67], a[104:107], v[16:19]
    ds_read_b64_tr_b16 a[26:27], v230 offset:31488
    v_mfma_f32_16x16x32_bf16 v[20:23], a[64:67], a[108:111], v[20:23]
    ds_read_b64_tr_b16 a[16:17], v228 offset:29760
    v_mfma_f32_16x16x32_bf16 v[32:35], a[64:67], a[112:115], v[32:35]
    ds_read_b64_tr_b16 a[18:19], v228 offset:31552
    ds_read_b64_tr_b16 a[4:5], v228 offset:33408
    v_mfma_f32_16x16x32_bf16 v[36:39], a[64:67], a[116:119], v[36:39]
    buffer_load_dwordx4 v[176:179], v196, s[4:7], s56 offen offset:0 sc1
    v_mfma_f32_16x16x32_bf16 v[68:71], a[72:75], a[116:119], v[68:71]
    ds_read_b64_tr_b16 a[6:7], v228 offset:35200
    v_mfma_f32_16x16x32_bf16 v[64:67], a[72:75], a[112:115], v[64:67]
    ds_read_b64_tr_b16 a[12:13], v228 offset:33440
    v_mfma_f32_16x16x32_bf16 v[52:55], a[72:75], a[108:111], v[52:55]
    ds_read_b64_tr_b16 a[14:15], v228 offset:35232
    ds_read_b64_tr_b16 a[20:21], v228 offset:33472
    v_mfma_f32_16x16x32_bf16 v[48:51], a[72:75], a[104:107], v[48:51]
    buffer_load_dwordx4 v[180:183], v196, s[4:7], s56 offen offset:1024 sc1
    v_mfma_f32_16x16x32_bf16 v[80:83], a[80:83], a[104:107], v[80:83]
    ds_read_b64_tr_b16 a[22:23], v228 offset:35264
    v_mfma_f32_16x16x32_bf16 v[84:87], a[80:83], a[108:111], v[84:87]
    s_waitcnt lgkmcnt(10)
    v_mfma_f32_16x16x32_bf16 v[96:99], a[80:83], a[112:115], v[96:99]
    v_mfma_f32_16x16x32_bf16 v[100:103], a[80:83], a[116:119], v[100:103]
    buffer_load_dwordx4 v[184:187], v196, s[4:7], s56 offen offset:2048 sc1
    v_mfma_f32_16x16x32_bf16 v[8:11], a[0:3], a[44:47], v[8:11]
    s_waitcnt vmcnt(17)
    ds_read2st64_b32 v[2:3], v232 offset0:64 offset1:68
    v_mfma_f32_16x16x32_bf16 v[12:15], a[0:3], a[48:51], v[12:15]
    ds_read2st64_b32 v[4:5], v232 offset0:72 offset1:76
    v_mfma_f32_16x16x32_bf16 v[24:27], a[0:3], a[52:55], v[24:27]
    ds_read_b64_tr_b16 a[104:105], v224 offset:16384
    ds_read_b64_tr_b16 a[106:107], v224 offset:18432
    v_mfma_f32_16x16x32_bf16 v[28:31], a[0:3], a[56:59], v[28:31]
    buffer_load_dwordx4 v[188:191], v196, s[4:7], s56 offen offset:3072 sc1
    v_mfma_f32_16x16x32_bf16 v[60:63], a[8:11], a[56:59], v[60:63]
    ds_read_b64_tr_b16 a[108:109], v225 offset:16384
    v_mfma_f32_16x16x32_bf16 v[56:59], a[8:11], a[52:55], v[56:59]
    s_waitcnt lgkmcnt(3)
    ds_read_b64_tr_b16 a[110:111], v225 offset:18432
    v_max3_u32 v2, v2, v3, v4
    v_mfma_f32_16x16x32_bf16 v[44:47], a[8:11], a[48:51], v[44:47]
    ds_read_b64_tr_b16 a[112:113], v226 offset:16384
    ds_read_b64_tr_b16 a[114:115], v226 offset:18432
    v_mfma_f32_16x16x32_bf16 v[40:43], a[8:11], a[44:47], v[40:43]
    buffer_load_dwordx4 a[180:183], v252, s[4:7], s94 offen offset:3072 sc1
    v_mfma_f32_16x16x32_bf16 v[104:107], a[24:27], a[44:47], v[104:107]
    ds_read_b64_tr_b16 a[116:117], v227 offset:16384
    v_max_u32 v2, v2, v5
    v_mfma_f32_16x16x32_bf16 v[108:111], a[24:27], a[48:51], v[108:111]
    ds_read_b64_tr_b16 a[118:119], v227 offset:18432
    v_cmp_eq_u32 vcc, -1, v2
    v_mfma_f32_16x16x32_bf16 v[112:115], a[24:27], a[52:55], v[112:115]
    s_add_u32 s94, s60, 16384
    ds_read_b64_tr_b16 a[60:61], v228 offset:37120
    ds_read_b64_tr_b16 a[62:63], v228 offset:38912
    v_mfma_f32_16x16x32_bf16 v[116:119], a[24:27], a[56:59], v[116:119]
    buffer_load_dwordx4 a[184:187], v252, s[4:7], s94 offen offset:0 sc1
    v_mfma_f32_16x16x32_bf16 v[92:95], a[16:19], a[56:59], v[92:95]
    s_cbranch_vccnz C_rt17
C_ok17:
    v_mfma_f32_16x16x32_bf16 v[88:91], a[16:19], a[52:55], v[88:91]
    ds_read_b64_tr_b16 a[68:69], v228 offset:37152
    v_mfma_f32_16x16x32_bf16 v[76:79], a[16:19], a[48:51], v[76:79]
    ds_read_b64_tr_b16 a[70:71], v228 offset:38944
    ds_read_b64_tr_b16 a[84:85], v230 offset:37120
    v_mfma_f32_16x16x32_bf16 v[72:75], a[16:19], a[44:47], v[72:75]
    buffer_load_dwordx4 a[188:191], v252, s[4:7], s94 offen offset:1024 sc1
    v_mfma_f32_16x16x32_bf16 v[16:19], a[4:7], a[44:47], v[16:19]
    ds_read_b64_tr_b16 a[86:87], v230 offset:38912
    v_mfma_f32_16x16x32_bf16 v[20:23], a[4:7], a[48:51], v[20:23]
    ds_read_b64_tr_b16 a[76:77], v228 offset:37184
    v_mfma_f32_16x16x32_bf16 v[32:35], a[4:7], a[52:55], v[32:35]
    ds_read_b64_tr_b16 a[78:79], v228 offset:38976
    ds_read_b64_tr_b16 a[64:65], v228 offset:40832
    v_mfma_f32_16x16x32_bf16 v[36:39], a[4:7], a[56:59], v[36:39]
    buffer_load_dwordx4 a[192:195], v252, s[4:7], s94 offen offset:2048 sc1
    v_mfma_f32_16x16x32_bf16 v[68:71], a[12:15], a[56:59], v[68:71]
    ds_read_b64_tr_b16 a[66:67], v228 offset:42624
    v_mfma_f32_16x16x32_bf16 v[64:67], a[12:15], a[52:55], v[64:67]
    ds_read_b64_tr_b16 a[72:73], v228 offset:40864
    v_mfma_f32_16x16x32_bf16 v[52:55], a[12:15], a[48:51], v[52:55]
    ds_read_b64_tr_b16 a[74:75], v228 offset:42656
    ds_read_b64_tr_b16 a[80:81], v228 offset:40896
    v_mfma_f32_16x16x32_bf16 v[48:51], a[12:15], a[44:47], v[48:51]
    buffer_load_dwordx4 a[196:199], v252, s[4:7], s94 offen offset:3072 sc1
    v_mfma_f32_16x16x32_bf16 v[80:83], a[20:23], a[44:47], v[80:83]
    ds_read_b64_tr_b16 a[82:83], v228 offset:42688
    v_mfma_f32_16x16x32_bf16 v[84:87], a[20:23], a[48:51], v[84:87]
    s_waitcnt lgkmcnt(10)
    v_mfma_f32_16x16x32_bf16 v[96:99], a[20:23], a[52:55], v[96:99]
    s_add_u32 s94, s60, 20480
    v_mfma_f32_16x16x32_bf16 v[100:103], a[20:23], a[56:59], v[100:103]
    buffer_load_dwordx4 a[200:203], v252, s[4:7], s94 offen offset:0 sc1
    v_mfma_f32_16x16x32_bf16 v[8:11], a[60:63], a[104:107], v[8:11]
    s_waitcnt vmcnt(17)
    ds_read2st64_b32 v[2:3], v232 offset0:128 offset1:132
    v_mfma_f32_16x16x32_bf16 v[12:15], a[60:63], a[108:111], v[12:15]
    ds_read2st64_b32 v[4:5], v232 offset0:136 offset1:140
    v_mfma_f32_16x16x32_bf16 v[24:27], a[60:63], a[112:115], v[24:27]
    ds_read_b64_tr_b16 a[44:45], v224 offset:32768
    ds_read_b64_tr_b16 a[46:47], v224 offset:34816
    v_mfma_f32_16x16x32_bf16 v[28:31], a[60:63], a[116:119], v[28:31]
    buffer_load_dwordx4 a[204:207], v252, s[4:7], s94 offen offset:1024 sc1
    v_mfma_f32_16x16x32_bf16 v[60:63], a[68:71], a[116:119], v[60:63]
    ds_read_b64_tr_b16 a[48:49], v225 offset:32768
    v_mfma_f32_16x16x32_bf16 v[56:59], a[68:71], a[112:115], v[56:59]
    s_waitcnt lgkmcnt(3)
    ds_read_b64_tr_b16 a[50:51], v225 offset:34816
    v_max3_u32 v2, v2, v3, v4
    v_mfma_f32_16x16x32_bf16 v[44:47], a[68:71], a[108:111], v[44:47]
    ds_read_b64_tr_b16 a[52:53], v226 offset:32768
    ds_read_b64_tr_b16 a[54:55], v226 offset:34816
    v_mfma_f32_16x16x32_bf16 v[40:43], a[68:71], a[104:107], v[40:43]
    buffer_load_dwordx4 a[208:211], v252, s[4:7], s94 offen offset:2048 sc1
    v_mfma_f32_16x16x32_bf16 v[104:107], a[84:87], a[104:107], v[104:107]
    ds_read_b64_tr_b16 a[56:57], v227 offset:32768
    v_max_u32 v2, v2, v5
    v_mfma_f32_16x16x32_bf16 v[108:111], a[84:87], a[108:111], v[108:111]
    ds_read_b64_tr_b16 a[58:59], v227 offset:34816
    v_cmp_eq_u32 vcc, -1, v2
    v_mfma_f32_16x16x32_bf16 v[112:115], a[84:87], a[112:115], v[112:115]
    ds_read_b64_tr_b16 a[0:1], v228 offset:44544
    ds_read_b64_tr_b16 a[2:3], v228 offset:46336
    v_mfma_f32_16x16x32_bf16 v[116:119], a[84:87], a[116:119], v[116:119]
    buffer_load_dwordx4 a[212:215], v252, s[4:7], s94 offen offset:3072 sc1
    v_mfma_f32_16x16x32_bf16 v[92:95], a[76:79], a[116:119], v[92:95]
    s_cbranch_vccnz C_rt18
C_ok18:
    v_mfma_f32_16x16x32_bf16 v[88:91], a[76:79], a[112:115], v[88:91]
    s_waitcnt vmcnt(9)
    ds_read_b64_tr_b16 a[8:9], v228 offset:44576
    v_add_f32 v176, v176, v178
    v_mfma_f32_16x16x32_bf16 v[76:79], a[76:79], a[108:111], v[76:79]
    s_add_u32 s94, s60, 24576
    ds_read_b64_tr_b16 a[10:11], v228 offset:46368
    ds_read_b64_tr_b16 a[24:25], v230 offset:44544
    v_mfma_f32_16x16x32_bf16 v[72:75], a[76:79], a[104:107], v[72:75]
    buffer_load_dwordx4 a[216:219], v252, s[4:7], s94 offen offset:0 sc1
    v_mfma_f32_16x16x32_bf16 v[16:19], a[64:67], a[104:107], v[16:19]
    ds_read_b64_tr_b16 a[26:27], v230 offset:46336
    v_add_f32 v177, v177, v179
    v_mfma_f32_16x16x32_bf16 v[20:23], a[64:67], a[108:111], v[20:23]
    ds_read_b64_tr_b16 a[16:17], v228 offset:44608
    v_add_f32 v180, v180, v182
    v_mfma_f32_16x16x32_bf16 v[32:35], a[64:67], a[112:115], v[32:35]
    ds_read_b64_tr_b16 a[18:19], v228 offset:46400
    ds_read_b64_tr_b16 a[4:5], v228 offset:48256
    v_mfma_f32_16x16x32_bf16 v[36:39], a[64:67], a[116:119], v[36:39]
    buffer_load_dwordx4 a[220:223], v252, s[4:7], s94 offen offset:1024 sc1
    v_mfma_f32_16x16x32_bf16 v[68:71], a[72:75], a[116:119], v[68:71]
    ds_read_b64_tr_b16 a[6:7], v228 offset:50048
    v_add_f32 v181, v181, v183
    v_mfma_f32_16x16x32_bf16 v[64:67], a[72:75], a[112:115], v[64:67]
    ds_read_b64_tr_b16 a[12:13], v228 offset:48288
    v_add_f32 v184, v184, v186
    v_mfma_f32_16x16x32_bf16 v[52:55], a[72:75], a[108:111], v[52:55]
    ds_read_b64_tr_b16 a[14:15], v228 offset:50080
    ds_read_b64_tr_b16 a[20:21], v228 offset:48320
    v_mfma_f32_16x16x32_bf16 v[48:51], a[72:75], a[104:107], v[48:51]
    buffer_load_dwordx4 a[224:227], v252, s[4:7], s94 offen offset:2048 sc1
    v_mfma_f32_16x16x32_bf16 v[80:83], a[80:83], a[104:107], v[80:83]
    ds_read_b64_tr_b16 a[22:23], v228 offset:50112
    v_add_f32 v185, v185, v187
    v_mfma_f32_16x16x32_bf16 v[84:87], a[80:83], a[108:111], v[84:87]
    s_waitcnt lgkmcnt(10)
    v_add_f32 v188, v188, v190
    v_add_f32 v189, v189, v191
    v_mfma_f32_16x16x32_bf16 v[96:99], a[80:83], a[112:115], v[96:99]
    v_add_f32 v176, v176, v180
    v_add_f32 v177, v177, v181
    v_mfma_f32_16x16x32_bf16 v[100:103], a[80:83], a[116:119], v[100:103]
    buffer_load_dwordx4 a[228:231], v252, s[4:7], s94 offen offset:3072 sc1
    v_mfma_f32_16x16x32_bf16 v[8:11], a[0:3], a[44:47], v[8:11]
    ds_read2st64_b32 v[2:3], v232 offset0:192 offset1:196
    v_add_f32 v184, v184, v188
    v_mfma_f32_16x16x32_bf16 v[12:15], a[0:3], a[48:51], v[12:15]
    ds_read2st64_b32 v[4:5], v232 offset0:200 offset1:204
    v_add_f32 v185, v185, v189
    v_mfma_f32_16x16x32_bf16 v[24:27], a[0:3], a[52:55], v[24:27]
    s_add_u32 s94, s60, 28672
    ds_read_b64_tr_b16 a[104:105], v224 offset:49152
    ds_read_b64_tr_b16 a[106:107], v224 offset:51200
    v_mfma_f32_16x16x32_bf16 v[28:31], a[0:3], a[56:59], v[28:31]
    buffer_load_dwordx4 a[232:235], v252, s[4:7], s94 offen offset:0 sc1
    v_mfma_f32_16x16x32_bf16 v[60:63], a[8:11], a[56:59], v[60:63]
    ds_read_b64_tr_b16 a[108:109], v225 offset:49152
    v_add_f32 v176, v176, v184
    v_mfma_f32_16x16x32_bf16 v[56:59], a[8:11], a[52:55], v[56:59]
    s_waitcnt lgkmcnt(3)
    ds_read_b64_tr_b16 a[110:111], v225 offset:51200
    v_max3_u32 v2, v2, v3, v4
    v_mfma_f32_16x16x32_bf16 v[44:47], a[8:11], a[48:51], v[44:47]
    ds_read_b64_tr_b16 a[112:113], v226 offset:49152
    ds_read_b64_tr_b16 a[114:115], v226 offset:51200
    v_mfma_f32_16x16x32_bf16 v[40:43], a[8:11], a[44:47], v[40:43]
    buffer_load_dwordx4 a[236:239], v252, s[4:7], s94 offen offset:1024 sc1
    v_mfma_f32_16x16x32_bf16 v[104:107], a[24:27], a[44:47], v[104:107]
    ds_read_b64_tr_b16 a[116:117], v227 offset:49152
    v_max_u32 v2, v2, v5
    v_mfma_f32_16x16x32_bf16 v[108:111], a[24:27], a[48:51], v[108:111]
    ds_read_b64_tr_b16 a[118:119], v227 offset:51200
    v_cmp_eq_u32 vcc, -1, v2
    v_mfma_f32_16x16x32_bf16 v[112:115], a[24:27], a[52:55], v[112:115]
    ds_read_b64_tr_b16 a[60:61], v228 offset:51968
    ds_read_b64_tr_b16 a[62:63], v228 offset:53760
    v_mfma_f32_16x16x32_bf16 v[116:119], a[24:27], a[56:59], v[116:119]
    buffer_load_dwordx4 a[240:243], v252, s[4:7], s94 offen offset:2048 sc1
    v_mfma_f32_16x16x32_bf16 v[92:95], a[16:19], a[56:59], v[92:95]
    s_cbranch_vccnz C_rt19
C_ok19:
    v_mfma_f32_16x16x32_bf16 v[88:91], a[16:19], a[52:55], v[88:91]
    ds_read_b64_tr_b16 a[68:69], v228 offset:52000
    v_add_f32 v177, v177, v185
    v_mfma_f32_16x16x32_bf16 v[76:79], a[16:19], a[48:51], v[76:79]
    ds_read_b64_tr_b16 a[70:71], v228 offset:53792
    ds_read_b64_tr_b16 a[84:85], v230 offset:51968
    v_mfma_f32_16x16x32_bf16 v[72:75], a[16:19], a[44:47], v[72:75]
    buffer_load_dwordx4 v[208:211], v252, s[4:7], s94 offen offset:3072 sc1
    v_mfma_f32_16x16x32_bf16 v[16:19], a[4:7], a[44:47], v[16:19]
    ds_read_b64_tr_b16 a[86:87], v230 offset:53760
    v_cmp_u_f32 vcc, v176, v177
    v_mfma_f32_16x16x32_bf16 v[20:23], a[4:7], a[48:51], v[20:23]
    ds_read_b64_tr_b16 a[76:77], v228 offset:52032
    v_mfma_f32_16x16x32_bf16 v[32:35], a[4:7], a[52:55], v[32:35]
    s_add_u32 s94, s60, 32768
    ds_read_b64_tr_b16 a[78:79], v228 offset:53824
    ds_read_b64_tr_b16 a[64:65], v228 offset:55680
    v_mfma_f32_16x16x32_bf16 v[36:39], a[4:7], a[56:59], v[36:39]
    buffer_load_dwordx4 v[212:215], v252, s[4:7], s94 offen offset:0 sc1
    v_mfma_f32_16x16x32_bf16 v[68:71], a[12:15], a[56:59], v[68:71]
    ds_read_b64_tr_b16 a[66:67], v228 offset:57472
    v_mfma_f32_16x16x32_bf16 v[64:67], a[12:15], a[52:55], v[64:67]
    ds_read_b64_tr_b16 a[72:73], v228 offset:55712
    v_mfma_f32_16x16x32_bf16 v[52:55], a[12:15], a[48:51], v[52:55]
    ds_read_b64_tr_b16 a[74:75], v228 offset:57504
    ds_read_b64_tr_b16 a[80:81], v228 offset:55744
    v_mfma_f32_16x16x32_bf16 v[48:51], a[12:15], a[44:47], v[48:51]
    buffer_load_dwordx4 v[216:219], v252, s[4:7], s94 offen offset:1024 sc1
    v_mfma_f32_16x16x32_bf16 v[80:83], a[20:23], a[44:47], v[80:83]
    ds_read_b64_tr_b16 a[82:83], v228 offset:57536
    v_mfma_f32_16x16x32_bf16 v[84:87], a[20:23], a[48:51], v[84:87]
    s_waitcnt lgkmcnt(10)
    s_cbranch_vccnz C_pg_rt
C_pg_ok:
    v_mfma_f32_16x16x32_bf16 v[96:99], a[20:23], a[52:55], v[96:99]
    v_mul_f32 v176, 0x3acccccd, v176
    v_mul_f32 v177, 0x3acccccd, v177
    v_mfma_f32_16x16x32_bf16 v[100:103], a[20:23], a[56:59], v[100:103]
    buffer_load_dwordx4 v[236:239], v252, s[4:7], s94 offen offset:2048 sc1
    v_mfma_f32_16x16x32_bf16 v[8:11], a[60:63], a[104:107], v[8:11]
    v_fma_f32 v177, -v176, v176, v177
    v_max_f32 v177, 0, v177
    v_mfma_f32_16x16x32_bf16 v[12:15], a[60:63], a[108:111], v[12:15]
    v_cvt_pk_bf16_f32 v178, v176, v177
    v_and_b32 v177, 0xffff0000, v178
    v_mfma_f32_16x16x32_bf16 v[24:27], a[60:63], a[112:115], v[24:27]
    v_lshlrev_b32 v176, 16, v178
    v_add_f32 v177, 0x3727c5ac, v177
    v_mfma_f32_16x16x32_bf16 v[28:31], a[60:63], a[116:119], v[28:31]
    buffer_load_dwordx4 v[240:243], v252, s[4:7], s94 offen offset:3072 sc1
    v_mfma_f32_16x16x32_bf16 v[60:63], a[68:71], a[116:119], v[60:63]
    v_sub_f32 v180, 0, v176
    v_cvt_pk_bf16_f32 v177, v177, v177
    v_mfma_f32_16x16x32_bf16 v[56:59], a[68:71], a[112:115], v[56:59]
    s_waitcnt lgkmcnt(0)
    v_and_b32 v177, 0xffff0000, v177
    v_mfma_f32_16x16x32_bf16 v[44:47], a[68:71], a[108:111], v[44:47]
    s_add_u32 s94, s60, 36864
    v_sqrt_f32 v177, v177
    v_mfma_f32_16x16x32_bf16 v[40:43], a[68:71], a[104:107], v[40:43]
    buffer_load_dwordx4 v[244:247], v252, s[4:7], s94 offen offset:0 sc1
    v_mfma_f32_16x16x32_bf16 v[104:107], a[84:87], a[104:107], v[104:107]
    v_cvt_pk_bf16_f32 v177, v177, v177
    v_and_b32 v177, 0xffff0000, v177
    v_mfma_f32_16x16x32_bf16 v[108:111], a[84:87], a[108:111], v[108:111]
    s_barrier
    v_rcp_f32 v176, v177
    v_mfma_f32_16x16x32_bf16 v[112:115], a[84:87], a[112:115], v[112:115]
    v_mul_f32 v181, v177, v177
    v_mul_f32 v182, 0xc0135761, v176
    v_mfma_f32_16x16x32_bf16 v[116:119], a[84:87], a[116:119], v[116:119]
    v_mul_f32 v178, v176, v176
    v_mul_f32 v176, 0xbdd2d3e8, v176
    v_mfma_f32_16x16x32_bf16 v[92:95], a[76:79], a[116:119], v[92:95]
    v_mul_f32 v183, v176, v178
    v_mfma_f32_16x16x32_bf16 v[88:91], a[76:79], a[112:115], v[88:91]
    ds_write_b128 v199, v[180:183]
    v_mfma_f32_16x16x32_bf16 v[76:79], a[76:79], a[108:111], v[76:79]
    ds_read_b128 v[176:179], v198
    v_mfma_f32_16x16x32_bf16 v[72:75], a[76:79], a[104:107], v[72:75]
    ds_read_b128 v[184:187], v202
    v_mfma_f32_16x16x32_bf16 v[16:19], a[64:67], a[104:107], v[16:19]
    ds_read_b128 v[188:191], v203
    v_mfma_f32_16x16x32_bf16 v[20:23], a[64:67], a[108:111], v[20:23]
    ds_read_b128 v[152:155], v197
    v_mfma_f32_16x16x32_bf16 v[32:35], a[64:67], a[112:115], v[32:35]
    ds_read_b128 v[156:159], v200
    v_mfma_f32_16x16x32_bf16 v[36:39], a[64:67], a[116:119], v[36:39]
    ds_read_b128 v[180:183], v201
    v_mfma_f32_16x16x32_bf16 v[68:71], a[72:75], a[116:119], v[68:71]
    v_mfma_f32_16x16x32_bf16 v[64:67], a[72:75], a[112:115], v[64:67]
    v_mfma_f32_16x16x32_bf16 v[52:55], a[72:75], a[108:111], v[52:55]
    v_mfma_f32_16x16x32_bf16 v[48:51], a[72:75], a[104:107], v[48:51]
    v_mfma_f32_16x16x32_bf16 v[80:83], a[80:83], a[104:107], v[80:83]
    v_mfma_f32_16x16x32_bf16 v[84:87], a[80:83], a[108:111], v[84:87]
    v_mfma_f32_16x16x32_bf16 v[96:99], a[80:83], a[112:115], v[96:99]
    v_mfma_f32_16x16x32_bf16 v[100:103], a[80:83], a[116:119], v[100:103]
    s_waitcnt lgkmcnt(5)
    v_pk_fma_f32 v[8:9], v[120:121], v[176:177], v[8:9] op_sel_hi:[1,0,1]
    v_pk_fma_f32 v[10:11], v[122:123], v[176:177], v[10:11] op_sel_hi:[1,0,1]
    s_waitcnt lgkmcnt(0)
    v_pk_fma_f32 v[12:13], v[120:121], v[180:181], v[12:13] op_sel_hi:[1,0,1]
    v_pk_fma_f32 v[14:15], v[122:123], v[180:181], v[14:15] op_sel_hi:[1,0,1]
    v_pk_mul_f32 v[192:193], v[8:9], v[8:9]
    v_pk_mul_f32 v[194:195], v[10:11], v[10:11]
    v_pk_mul_f32 v[196:197], v[12:13], v[12:13]
    v_pk_mul_f32 v[198:199], v[14:15], v[14:15]
    v_pk_fma_f32 v[16:17], v[124:125], v[176:177], v[16:17] op_sel_hi:[1,0,1]
    v_pk_fma_f32 v[18:19], v[126:127], v[176:177], v[18:19] op_sel_hi:[1,0,1]
    v_pk_fma_f32 v[20:21], v[124:125], v[180:181], v[20:21] op_sel_hi:[1,0,1]
    v_pk_fma_f32 v[22:23], v[126:127], v[180:181], v[22:23] op_sel_hi:[1,0,1]
    v_pk_fma_f32 v[192:193], v[192:193], v[178:179], v[178:179] op_sel:[0,1,0] op_sel_hi:[1,1,0]
    v_pk_fma_f32 v[194:195], v[194:195], v[178:179], v[178:179] op_sel:[0,1,0] op_sel_hi:[1,1,0]
    v_pk_fma_f32 v[196:197], v[196:197], v[182:183], v[182:183] op_sel:[0,1,0] op_sel_hi:[1,1,0]
    v_pk_fma_f32 v[198:199], v[198:199], v[182:183], v[182:183] op_sel:[0,1,0] op_sel_hi:[1,1,0]
    v_pk_mul_f32 v[192:193], v[192:193], v[8:9]
    v_pk_mul_f32 v[194:195], v[194:195], v[10:11]
    v_pk_mul_f32 v[196:197], v[196:197], v[12:13]
    v_pk_mul_f32 v[198:199], v[198:199], v[14:15]
    s_lshl_b32 s92, s28, 10
    v_xor_b32 v2, s92, v252
    v_xor_b32 v3, 1024, v2
    v_xor_b32 v4, 2048, v2
    v_xor_b32 v5, 3072, v2
    s_bfe_u32 s94, s63, 262172
    s_mul_i32 s94, s94, 5120
    s_add_u32 s94, s94, s60
    buffer_load_dwordx4 a[0:3], v252, s[4:7], s94 offen offset:2048 sc1
    buffer_load_dwordx4 a[4:7], v252, s[4:7], s94 offen offset:3072 sc1
    v_exp_f32 v192, v192
    v_exp_f32 v193, v193
    v_exp_f32 v194, v194
    v_exp_f32 v195, v195
    v_exp_f32 v196, v196
    v_exp_f32 v197, v197
    v_exp_f32 v198, v198
    v_exp_f32 v199, v199
    v_pk_mul_f32 v[8:9], v[8:9], v[16:17]
    v_pk_mul_f32 v[10:11], v[10:11], v[18:19]
    v_pk_mul_f32 v[12:13], v[12:13], v[20:21]
    v_pk_mul_f32 v[14:15], v[14:15], v[22:23]
    v_pk_fma_f32 v[192:193], v[192:193], v[176:177], v[176:177] op_sel:[0,1,1] op_sel_hi:[1,1,1]
    v_pk_fma_f32 v[194:195], v[194:195], v[176:177], v[176:177] op_sel:[0,1,1] op_sel_hi:[1,1,1]
    v_pk_fma_f32 v[196:197], v[196:197], v[180:181], v[180:181] op_sel:[0,1,1] op_sel_hi:[1,1,1]
    v_pk_fma_f32 v[198:199], v[198:199], v[180:181], v[180:181] op_sel:[0,1,1] op_sel_hi:[1,1,1]
    s_add_u32 s94, s94, 4096
    buffer_load_dwordx4 a[8:11], v252, s[4:7], s94 offen offset:0 sc1
    s_bfe_u32 s94, s35, 262144
    s_mul_i32 s94, s94, 5120
    s_add_u32 s94, s94, s60
    buffer_load_dwordx4 a[12:15], v252, s[4:7], s94 offen offset:0 sc1
    v_rcp_f32 v192, v192
    v_rcp_f32 v193, v193
    v_rcp_f32 v194, v194
    v_rcp_f32 v195, v195
    v_rcp_f32 v196, v196
    v_rcp_f32 v197, v197
    v_rcp_f32 v198, v198
    v_rcp_f32 v199, v199
    v_pk_mul_f32 v[8:9], v[8:9], v[192:193]
    v_pk_mul_f32 v[10:11], v[10:11], v[194:195]
    v_pk_mul_f32 v[12:13], v[12:13], v[196:197]
    v_pk_mul_f32 v[14:15], v[14:15], v[198:199]
    v_cvt_pk_bf16_f32 v200, v8, v9
    v_cvt_pk_bf16_f32 v201, v10, v11
    v_cvt_pk_bf16_f32 v202, v12, v13
    v_cvt_pk_bf16_f32 v203, v14, v15
    s_nop 0
    v_permlane16_swap_b32 v200, v202
    v_permlane16_swap_b32 v201, v203
    s_add_u32 s88, s85, 0
    buffer_store_dwordx4 v[200:203], v248, s[4:7], s88 offen offset:0 sc1
    v_pk_fma_f32 v[24:25], v[120:121], v[184:185], v[24:25] op_sel_hi:[1,0,1]
    v_pk_fma_f32 v[26:27], v[122:123], v[184:185], v[26:27] op_sel_hi:[1,0,1]
    v_pk_fma_f32 v[28:29], v[120:121], v[188:189], v[28:29] op_sel_hi:[1,0,1]
    v_pk_fma_f32 v[30:31], v[122:123], v[188:189], v[30:31] op_sel_hi:[1,0,1]
    v_pk_mul_f32 v[192:193], v[24:25], v[24:25]
    v_pk_mul_f32 v[194:195], v[26:27], v[26:27]
    v_pk_mul_f32 v[196:197], v[28:29], v[28:29]
    v_pk_mul_f32 v[198:199], v[30:31], v[30:31]
    v_pk_fma_f32 v[32:33], v[124:125], v[184:185], v[32:33] op_sel_hi:[1,0,1]
    v_pk_fma_f32 v[34:35], v[126:127], v[184:185], v[34:35] op_sel_hi:[1,0,1]
    v_pk_fma_f32 v[36:37], v[124:125], v[188:189], v[36:37] op_sel_hi:[1,0,1]
    v_pk_fma_f32 v[38:39], v[126:127], v[188:189], v[38:39] op_sel_hi:[1,0,1]
    v_pk_fma_f32 v[192:193], v[192:193], v[186:187], v[186:187] op_sel:[0,1,0] op_sel_hi:[1,1,0]
    v_pk_fma_f32 v[194:195], v[194:195], v[186:187], v[186:187] op_sel:[0,1,0] op_sel_hi:[1,1,0]
    v_pk_fma_f32 v[196:197], v[196:197], v[190:191], v[190:191] op_sel:[0,1,0] op_sel_hi:[1,1,0]
    v_pk_fma_f32 v[198:199], v[198:199], v[190:191], v[190:191] op_sel:[0,1,0] op_sel_hi:[1,1,0]
    v_pk_mul_f32 v[192:193], v[192:193], v[24:25]
    v_pk_mul_f32 v[194:195], v[194:195], v[26:27]
    v_pk_mul_f32 v[196:197], v[196:197], v[28:29]
    v_pk_mul_f32 v[198:199], v[198:199], v[30:31]
    buffer_load_dwordx4 a[16:19], v252, s[4:7], s94 offen offset:1024 sc1
    buffer_load_dwordx4 a[20:23], v252, s[4:7], s94 offen offset:2048 sc1
    v_exp_f32 v192, v192
    v_exp_f32 v193, v193
    v_exp_f32 v194, v194
    v_exp_f32 v195, v195
    v_exp_f32 v196, v196
    v_exp_f32 v197, v197
    v_exp_f32 v198, v198
    v_exp_f32 v199, v199
    v_pk_mul_f32 v[24:25], v[24:25], v[32:33]
    v_pk_mul_f32 v[26:27], v[26:27], v[34:35]
    v_pk_mul_f32 v[28:29], v[28:29], v[36:37]
    v_pk_mul_f32 v[30:31], v[30:31], v[38:39]
    v_pk_fma_f32 v[192:193], v[192:193], v[184:185], v[184:185] op_sel:[0,1,1] op_sel_hi:[1,1,1]
    v_pk_fma_f32 v[194:195], v[194:195], v[184:185], v[184:185] op_sel:[0,1,1] op_sel_hi:[1,1,1]
    v_pk_fma_f32 v[196:197], v[196:197], v[188:189], v[188:189] op_sel:[0,1,1] op_sel_hi:[1,1,1]
    v_pk_fma_f32 v[198:199], v[198:199], v[188:189], v[188:189] op_sel:[0,1,1] op_sel_hi:[1,1,1]
    buffer_load_dwordx4 a[24:27], v252, s[4:7], s94 offen offset:3072 sc1
    s_add_u32 s94, s94, 4096
    buffer_load_dwordx4 a[28:31], v252, s[4:7], s94 offen offset:0 sc1
    v_rcp_f32 v192, v192
    v_rcp_f32 v193, v193
    v_rcp_f32 v194, v194
    v_rcp_f32 v195, v195
    v_rcp_f32 v196, v196
    v_rcp_f32 v197, v197
    v_rcp_f32 v198, v198
    v_rcp_f32 v199, v199
    v_pk_mul_f32 v[24:25], v[24:25], v[192:193]
    v_pk_mul_f32 v[26:27], v[26:27], v[194:195]
    v_pk_mul_f32 v[28:29], v[28:29], v[196:197]
    v_pk_mul_f32 v[30:31], v[30:31], v[198:199]
    v_cvt_pk_bf16_f32 v204, v24, v25
    v_cvt_pk_bf16_f32 v205, v26, v27
    v_cvt_pk_bf16_f32 v206, v28, v29
    v_cvt_pk_bf16_f32 v207, v30, v31
    s_nop 0
    v_permlane16_swap_b32 v204, v206
    v_permlane16_swap_b32 v205, v207
    buffer_store_dwordx4 v[204:207], v220, s[4:7], s88 offen offset:0 sc1
    v_pk_fma_f32 v[40:41], v[128:129], v[176:177], v[40:41] op_sel_hi:[1,0,1]
    v_pk_fma_f32 v[42:43], v[130:131], v[176:177], v[42:43] op_sel_hi:[1,0,1]
    v_pk_fma_f32 v[44:45], v[128:129], v[180:181], v[44:45] op_sel_hi:[1,0,1]
    v_pk_fma_f32 v[46:47], v[130:131], v[180:181], v[46:47] op_sel_hi:[1,0,1]
    v_pk_mul_f32 v[192:193], v[40:41], v[40:41]
    v_pk_mul_f32 v[194:195], v[42:43], v[42:43]
    v_pk_mul_f32 v[196:197], v[44:45], v[44:45]
    v_pk_mul_f32 v[198:199], v[46:47], v[46:47]
    v_pk_fma_f32 v[48:49], v[132:133], v[176:177], v[48:49] op_sel_hi:[1,0,1]
    v_pk_fma_f32 v[50:51], v[134:135], v[176:177], v[50:51] op_sel_hi:[1,0,1]
    v_pk_fma_f32 v[52:53], v[132:133], v[180:181], v[52:53] op_sel_hi:[1,0,1]
    v_pk_fma_f32 v[54:55], v[134:135], v[180:181], v[54:55] op_sel_hi:[1,0,1]
    v_pk_fma_f32 v[192:193], v[192:193], v[178:179], v[178:179] op_sel:[0,1,0] op_sel_hi:[1,1,0]
    v_pk_fma_f32 v[194:195], v[194:195], v[178:179], v[178:179] op_sel:[0,1,0] op_sel_hi:[1,1,0]
    v_pk_fma_f32 v[196:197], v[196:197], v[182:183], v[182:183] op_sel:[0,1,0] op_sel_hi:[1,1,0]
    v_pk_fma_f32 v[198:199], v[198:199], v[182:183], v[182:183] op_sel:[0,1,0] op_sel_hi:[1,1,0]
    v_pk_mul_f32 v[192:193], v[192:193], v[40:41]
    v_pk_mul_f32 v[194:195], v[194:195], v[42:43]
    v_pk_mul_f32 v[196:197], v[196:197], v[44:45]
    v_pk_mul_f32 v[198:199], v[198:199], v[46:47]
    s_waitcnt vmcnt(10)
    s_bfe_u32 s94, s35, 262148
    s_mul_i32 s94, s94, 5120
    s_add_u32 s94, s94, s60
    buffer_load_dwordx4 a[32:35], v252, s[4:7], s94 offen offset:0 sc1
    buffer_load_dwordx4 a[36:39], v252, s[4:7], s94 offen offset:1024 sc1
    v_exp_f32 v192, v192
    v_exp_f32 v193, v193
    v_exp_f32 v194, v194
    v_exp_f32 v195, v195
    v_exp_f32 v196, v196
    v_exp_f32 v197, v197
    v_exp_f32 v198, v198
    v_exp_f32 v199, v199
    v_pk_mul_f32 v[40:41], v[40:41], v[48:49]
    v_pk_mul_f32 v[42:43], v[42:43], v[50:51]
    v_pk_mul_f32 v[44:45], v[44:45], v[52:53]
    v_pk_mul_f32 v[46:47], v[46:47], v[54:55]
    v_pk_fma_f32 v[192:193], v[192:193], v[176:177], v[176:177] op_sel:[0,1,1] op_sel_hi:[1,1,1]
    v_pk_fma_f32 v[194:195], v[194:195], v[176:177], v[176:177] op_sel:[0,1,1] op_sel_hi:[1,1,1]
    v_pk_fma_f32 v[196:197], v[196:197], v[180:181], v[180:181] op_sel:[0,1,1] op_sel_hi:[1,1,1]
    v_pk_fma_f32 v[198:199], v[198:199], v[180:181], v[180:181] op_sel:[0,1,1] op_sel_hi:[1,1,1]
    buffer_load_dwordx4 a[40:43], v252, s[4:7], s94 offen offset:2048 sc1
    buffer_load_dwordx4 a[44:47], v252, s[4:7], s94 offen offset:3072 sc1
    v_rcp_f32 v192, v192
    v_rcp_f32 v193, v193
    v_rcp_f32 v194, v194
    v_rcp_f32 v195, v195
    v_rcp_f32 v196, v196
    v_rcp_f32 v197, v197
    v_rcp_f32 v198, v198
    v_rcp_f32 v199, v199
    v_pk_mul_f32 v[40:41], v[40:41], v[192:193]
    v_pk_mul_f32 v[42:43], v[42:43], v[194:195]
    v_pk_mul_f32 v[44:45], v[44:45], v[196:197]
    v_pk_mul_f32 v[46:47], v[46:47], v[198:199]
    v_cvt_pk_bf16_f32 v200, v40, v41
    v_cvt_pk_bf16_f32 v201, v42, v43
    v_cvt_pk_bf16_f32 v202, v44, v45
    v_cvt_pk_bf16_f32 v203, v46, v47
    s_nop 0
    v_permlane16_swap_b32 v200, v202
    v_permlane16_swap_b32 v201, v203
    s_add_u32 s88, s85, 2129920
    buffer_store_dwordx4 v[200:203], v248, s[4:7], s88 offen offset:0 sc1
    v_pk_fma_f32 v[56:57], v[128:129], v[184:185], v[56:57] op_sel_hi:[1,0,1]
    v_pk_fma_f32 v[58:59], v[130:131], v[184:185], v[58:59] op_sel_hi:[1,0,1]
    v_pk_fma_f32 v[60:61], v[128:129], v[188:189], v[60:61] op_sel_hi:[1,0,1]
    v_pk_fma_f32 v[62:63], v[130:131], v[188:189], v[62:63] op_sel_hi:[1,0,1]
    v_pk_mul_f32 v[192:193], v[56:57], v[56:57]
    v_pk_mul_f32 v[194:195], v[58:59], v[58:59]
    v_pk_mul_f32 v[196:197], v[60:61], v[60:61]
    v_pk_mul_f32 v[198:199], v[62:63], v[62:63]
    v_pk_fma_f32 v[64:65], v[132:133], v[184:185], v[64:65] op_sel_hi:[1,0,1]
    v_pk_fma_f32 v[66:67], v[134:135], v[184:185], v[66:67] op_sel_hi:[1,0,1]
    v_pk_fma_f32 v[68:69], v[132:133], v[188:189], v[68:69] op_sel_hi:[1,0,1]
    v_pk_fma_f32 v[70:71], v[134:135], v[188:189], v[70:71] op_sel_hi:[1,0,1]
    v_pk_fma_f32 v[192:193], v[192:193], v[186:187], v[186:187] op_sel:[0,1,0] op_sel_hi:[1,1,0]
    v_pk_fma_f32 v[194:195], v[194:195], v[186:187], v[186:187] op_sel:[0,1,0] op_sel_hi:[1,1,0]
    v_pk_fma_f32 v[196:197], v[196:197], v[190:191], v[190:191] op_sel:[0,1,0] op_sel_hi:[1,1,0]
    v_pk_fma_f32 v[198:199], v[198:199], v[190:191], v[190:191] op_sel:[0,1,0] op_sel_hi:[1,1,0]
    v_pk_mul_f32 v[192:193], v[192:193], v[56:57]
    v_pk_mul_f32 v[194:195], v[194:195], v[58:59]
    v_pk_mul_f32 v[196:197], v[196:197], v[60:61]
    v_pk_mul_f32 v[198:199], v[198:199], v[62:63]
    s_add_u32 s94, s94, 4096
    buffer_load_dwordx4 a[48:51], v252, s[4:7], s94 offen offset:0 sc1
    s_bfe_u32 s94, s35, 262152
    s_mul_i32 s94, s94, 5120
    s_add_u32 s94, s94, s60
    buffer_load_dwordx4 a[52:55], v252, s[4:7], s94 offen offset:0 sc1
    v_exp_f32 v192, v192
    v_exp_f32 v193, v193
    v_exp_f32 v194, v194
    v_exp_f32 v195, v195
    v_exp_f32 v196, v196
    v_exp_f32 v197, v197
    v_exp_f32 v198, v198
    v_exp_f32 v199, v199
    v_pk_mul_f32 v[56:57], v[56:57], v[64:65]
    v_pk_mul_f32 v[58:59], v[58:59], v[66:67]
    v_pk_mul_f32 v[60:61], v[60:61], v[68:69]
    v_pk_mul_f32 v[62:63], v[62:63], v[70:71]
    v_pk_fma_f32 v[192:193], v[192:193], v[184:185], v[184:185] op_sel:[0,1,1] op_sel_hi:[1,1,1]
    v_pk_fma_f32 v[194:195], v[194:195], v[184:185], v[184:185] op_sel:[0,1,1] op_sel_hi:[1,1,1]
    v_pk_fma_f32 v[196:197], v[196:197], v[188:189], v[188:189] op_sel:[0,1,1] op_sel_hi:[1,1,1]
    v_pk_fma_f32 v[198:199], v[198:199], v[188:189], v[188:189] op_sel:[0,1,1] op_sel_hi:[1,1,1]
    buffer_load_dwordx4 a[56:59], v252, s[4:7], s94 offen offset:1024 sc1
    buffer_load_dwordx4 a[60:63], v252, s[4:7], s94 offen offset:2048 sc1
    v_rcp_f32 v192, v192
    v_rcp_f32 v193, v193
    v_rcp_f32 v194, v194
    v_rcp_f32 v195, v195
    v_rcp_f32 v196, v196
    v_rcp_f32 v197, v197
    v_rcp_f32 v198, v198
    v_rcp_f32 v199, v199
    v_pk_mul_f32 v[56:57], v[56:57], v[192:193]
    v_pk_mul_f32 v[58:59], v[58:59], v[194:195]
    v_pk_mul_f32 v[60:61], v[60:61], v[196:197]
    v_pk_mul_f32 v[62:63], v[62:63], v[198:199]
    v_cvt_pk_bf16_f32 v204, v56, v57
    v_cvt_pk_bf16_f32 v205, v58, v59
    v_cvt_pk_bf16_f32 v206, v60, v61
    v_cvt_pk_bf16_f32 v207, v62, v63
    s_nop 0
    v_permlane16_swap_b32 v204, v206
    v_permlane16_swap_b32 v205, v207
    buffer_store_dwordx4 v[204:207], v220, s[4:7], s88 offen offset:0 sc1
    v_pk_fma_f32 v[72:73], v[136:137], v[176:177], v[72:73] op_sel_hi:[1,0,1]
    v_pk_fma_f32 v[74:75], v[138:139], v[176:177], v[74:75] op_sel_hi:[1,0,1]
    v_pk_fma_f32 v[76:77], v[136:137], v[180:181], v[76:77] op_sel_hi:[1,0,1]
    v_pk_fma_f32 v[78:79], v[138:139], v[180:181], v[78:79] op_sel_hi:[1,0,1]
    v_pk_mul_f32 v[192:193], v[72:73], v[72:73]
    v_pk_mul_f32 v[194:195], v[74:75], v[74:75]
    v_pk_mul_f32 v[196:197], v[76:77], v[76:77]
    v_pk_mul_f32 v[198:199], v[78:79], v[78:79]
    v_pk_fma_f32 v[80:81], v[140:141], v[176:177], v[80:81] op_sel_hi:[1,0,1]
    v_pk_fma_f32 v[82:83], v[142:143], v[176:177], v[82:83] op_sel_hi:[1,0,1]
    v_pk_fma_f32 v[84:85], v[140:141], v[180:181], v[84:85] op_sel_hi:[1,0,1]
    v_pk_fma_f32 v[86:87], v[142:143], v[180:181], v[86:87] op_sel_hi:[1,0,1]
    v_pk_fma_f32 v[192:193], v[192:193], v[178:179], v[178:179] op_sel:[0,1,0] op_sel_hi:[1,1,0]
    v_pk_fma_f32 v[194:195], v[194:195], v[178:179], v[178:179] op_sel:[0,1,0] op_sel_hi:[1,1,0]
    v_pk_fma_f32 v[196:197], v[196:197], v[182:183], v[182:183] op_sel:[0,1,0] op_sel_hi:[1,1,0]
    v_pk_fma_f32 v[198:199], v[198:199], v[182:183], v[182:183] op_sel:[0,1,0] op_sel_hi:[1,1,0]
    v_pk_mul_f32 v[192:193], v[192:193], v[72:73]
    v_pk_mul_f32 v[194:195], v[194:195], v[74:75]
    v_pk_mul_f32 v[196:197], v[196:197], v[76:77]
    v_pk_mul_f32 v[198:199], v[198:199], v[78:79]
    buffer_load_dwordx4 a[64:67], v252, s[4:7], s94 offen offset:3072 sc1
    s_add_u32 s94, s94, 4096
    buffer_load_dwordx4 a[68:71], v252, s[4:7], s94 offen offset:0 sc1
    v_exp_f32 v192, v192
    v_exp_f32 v193, v193
    v_exp_f32 v194, v194
    v_exp_f32 v195, v195
    v_exp_f32 v196, v196
    v_exp_f32 v197, v197
    v_exp_f32 v198, v198
    v_exp_f32 v199, v199
    v_pk_mul_f32 v[72:73], v[72:73], v[80:81]
    v_pk_mul_f32 v[74:75], v[74:75], v[82:83]
    v_pk_mul_f32 v[76:77], v[76:77], v[84:85]
    v_pk_mul_f32 v[78:79], v[78:79], v[86:87]
    v_pk_fma_f32 v[192:193], v[192:193], v[176:177], v[176:177] op_sel:[0,1,1] op_sel_hi:[1,1,1]
    v_pk_fma_f32 v[194:195], v[194:195], v[176:177], v[176:177] op_sel:[0,1,1] op_sel_hi:[1,1,1]
    v_pk_fma_f32 v[196:197], v[196:197], v[180:181], v[180:181] op_sel:[0,1,1] op_sel_hi:[1,1,1]
    v_pk_fma_f32 v[198:199], v[198:199], v[180:181], v[180:181] op_sel:[0,1,1] op_sel_hi:[1,1,1]
    s_bfe_u32 s94, s35, 262156
    s_mul_i32 s94, s94, 5120
    s_add_u32 s94, s94, s60
    buffer_load_dwordx4 a[72:75], v252, s[4:7], s94 offen offset:0 sc1
    buffer_load_dwordx4 a[76:79], v252, s[4:7], s94 offen offset:1024 sc1
    v_rcp_f32 v192, v192
    v_rcp_f32 v193, v193
    v_rcp_f32 v194, v194
    v_rcp_f32 v195, v195
    v_rcp_f32 v196, v196
    v_rcp_f32 v197, v197
    v_rcp_f32 v198, v198
    v_rcp_f32 v199, v199
    v_pk_mul_f32 v[72:73], v[72:73], v[192:193]
    v_pk_mul_f32 v[74:75], v[74:75], v[194:195]
    v_pk_mul_f32 v[76:77], v[76:77], v[196:197]
    v_pk_mul_f32 v[78:79], v[78:79], v[198:199]
    v_cvt_pk_bf16_f32 v200, v72, v73
    v_cvt_pk_bf16_f32 v201, v74, v75
    v_cvt_pk_bf16_f32 v202, v76, v77
    v_cvt_pk_bf16_f32 v203, v78, v79
    s_nop 0
    v_permlane16_swap_b32 v200, v202
    v_permlane16_swap_b32 v201, v203
    s_add_u32 s88, s85, 4259840
    buffer_store_dwordx4 v[200:203], v248, s[4:7], s88 offen offset:0 sc1
    v_pk_fma_f32 v[88:89], v[136:137], v[184:185], v[88:89] op_sel_hi:[1,0,1]
    v_pk_fma_f32 v[90:91], v[138:139], v[184:185], v[90:91] op_sel_hi:[1,0,1]
    v_pk_fma_f32 v[92:93], v[136:137], v[188:189], v[92:93] op_sel_hi:[1,0,1]
    v_pk_fma_f32 v[94:95], v[138:139], v[188:189], v[94:95] op_sel_hi:[1,0,1]
    v_pk_mul_f32 v[192:193], v[88:89], v[88:89]
    v_pk_mul_f32 v[194:195], v[90:91], v[90:91]
    v_pk_mul_f32 v[196:197], v[92:93], v[92:93]
    v_pk_mul_f32 v[198:199], v[94:95], v[94:95]
    v_pk_fma_f32 v[96:97], v[140:141], v[184:185], v[96:97] op_sel_hi:[1,0,1]
    v_pk_fma_f32 v[98:99], v[142:143], v[184:185], v[98:99] op_sel_hi:[1,0,1]
    v_pk_fma_f32 v[100:101], v[140:141], v[188:189], v[100:101] op_sel_hi:[1,0,1]
    v_pk_fma_f32 v[102:103], v[142:143], v[188:189], v[102:103] op_sel_hi:[1,0,1]
    v_pk_fma_f32 v[192:193], v[192:193], v[186:187], v[186:187] op_sel:[0,1,0] op_sel_hi:[1,1,0]
    v_pk_fma_f32 v[194:195], v[194:195], v[186:187], v[186:187] op_sel:[0,1,0] op_sel_hi:[1,1,0]
    v_pk_fma_f32 v[196:197], v[196:197], v[190:191], v[190:191] op_sel:[0,1,0] op_sel_hi:[1,1,0]
    v_pk_fma_f32 v[198:199], v[198:199], v[190:191], v[190:191] op_sel:[0,1,0] op_sel_hi:[1,1,0]
    v_pk_mul_f32 v[192:193], v[192:193], v[88:89]
    v_pk_mul_f32 v[194:195], v[194:195], v[90:91]
    v_pk_mul_f32 v[196:197], v[196:197], v[92:93]
    v_pk_mul_f32 v[198:199], v[198:199], v[94:95]
    buffer_load_dwordx4 a[80:83], v252, s[4:7], s94 offen offset:2048 sc1
    buffer_load_dwordx4 a[84:87], v252, s[4:7], s94 offen offset:3072 sc1
    s_add_u32 s94, s94, 4096
    buffer_load_dwordx4 a[88:91], v252, s[4:7], s94 offen offset:0 sc1
    v_exp_f32 v192, v192
    v_exp_f32 v193, v193
    v_exp_f32 v194, v194
    v_exp_f32 v195, v195
    v_exp_f32 v196, v196
    v_exp_f32 v197, v197
    v_exp_f32 v198, v198
    v_exp_f32 v199, v199
    v_pk_mul_f32 v[88:89], v[88:89], v[96:97]
    v_pk_mul_f32 v[90:91], v[90:91], v[98:99]
    v_pk_mul_f32 v[92:93], v[92:93], v[100:101]
    v_pk_mul_f32 v[94:95], v[94:95], v[102:103]
    v_pk_fma_f32 v[192:193], v[192:193], v[184:185], v[184:185] op_sel:[0,1,1] op_sel_hi:[1,1,1]
    v_pk_fma_f32 v[194:195], v[194:195], v[184:185], v[184:185] op_sel:[0,1,1] op_sel_hi:[1,1,1]
    v_pk_fma_f32 v[196:197], v[196:197], v[188:189], v[188:189] op_sel:[0,1,1] op_sel_hi:[1,1,1]
    v_pk_fma_f32 v[198:199], v[198:199], v[188:189], v[188:189] op_sel:[0,1,1] op_sel_hi:[1,1,1]
    v_rcp_f32 v192, v192
    v_rcp_f32 v193, v193
    v_rcp_f32 v194, v194
    v_rcp_f32 v195, v195
    v_rcp_f32 v196, v196
    v_rcp_f32 v197, v197
    v_rcp_f32 v198, v198
    v_rcp_f32 v199, v199
    v_pk_mul_f32 v[88:89], v[88:89], v[192:193]
    v_pk_mul_f32 v[90:91], v[90:91], v[194:195]
    v_pk_mul_f32 v[92:93], v[92:93], v[196:197]
    v_pk_mul_f32 v[94:95], v[94:95], v[198:199]
    v_cvt_pk_bf16_f32 v204, v88, v89
    v_cvt_pk_bf16_f32 v205, v90, v91
    v_cvt_pk_bf16_f32 v206, v92, v93
    v_cvt_pk_bf16_f32 v207, v94, v95
    s_nop 0
    v_permlane16_swap_b32 v204, v206
    v_permlane16_swap_b32 v205, v207
    buffer_store_dwordx4 v[204:207], v220, s[4:7], s88 offen offset:0 sc1
    v_permlane32_swap_b32 v104, v108
    v_permlane32_swap_b32 v105, v109
    v_permlane32_swap_b32 v106, v110
    v_permlane32_swap_b32 v107, v111
    v_permlane32_swap_b32 v112, v116
    v_permlane32_swap_b32 v113, v117
    v_permlane32_swap_b32 v114, v118
    v_permlane32_swap_b32 v115, v119
    s_cmp_eq_u32 s86, 0
    s_cselect_b32 s89, 0, -1
    s_add_u32 s88, s85, 6389760
    v_pk_fma_f32 v[104:105], v[144:145], v[152:153], v[104:105] op_sel_hi:[1,0,1]
    v_pk_fma_f32 v[106:107], v[146:147], v[152:153], v[106:107] op_sel_hi:[1,0,1]
    v_pk_mul_f32 v[192:193], v[104:105], v[104:105]
    v_pk_mul_f32 v[194:195], v[106:107], v[106:107]
    v_pk_fma_f32 v[108:109], v[148:149], v[152:153], v[108:109] op_sel_hi:[1,0,1]
    v_pk_fma_f32 v[110:111], v[150:151], v[152:153], v[110:111] op_sel_hi:[1,0,1]
    v_pk_fma_f32 v[192:193], v[192:193], v[154:155], v[154:155] op_sel:[0,1,0] op_sel_hi:[1,1,0]
    v_pk_fma_f32 v[194:195], v[194:195], v[154:155], v[154:155] op_sel:[0,1,0] op_sel_hi:[1,1,0]
    v_pk_mul_f32 v[192:193], v[192:193], v[104:105]
    v_pk_mul_f32 v[194:195], v[194:195], v[106:107]
    s_bfe_u32 s44, s63, 262144
    s_mul_i32 s44, s44, 532480
    s_add_u32 s44, s44, s61
    buffer_load_dwordx4 v[8:11], v2, s[4:7], s44 offen sc1
    buffer_load_dwordx4 v[12:15], v3, s[4:7], s44 offen sc1
    buffer_load_dwordx4 v[16:19], v4, s[4:7], s44 offen sc1
    buffer_load_dwordx4 v[20:23], v5, s[4:7], s44 offen sc1
    v_exp_f32 v192, v192
    v_exp_f32 v193, v193
    v_exp_f32 v194, v194
    v_exp_f32 v195, v195
    v_pk_mul_f32 v[104:105], v[104:105], v[108:109]
    v_pk_mul_f32 v[106:107], v[106:107], v[110:111]
    v_pk_fma_f32 v[192:193], v[192:193], v[152:153], v[152:153] op_sel:[0,1,1] op_sel_hi:[1,1,1]
    v_pk_fma_f32 v[194:195], v[194:195], v[152:153], v[152:153] op_sel:[0,1,1] op_sel_hi:[1,1,1]
    s_bfe_u32 s45, s63, 262148
    s_mul_i32 s45, s45, 532480
    s_add_u32 s45, s45, s61
    buffer_load_dwordx4 v[24:27], v2, s[4:7], s45 offen sc1
    buffer_load_dwordx4 v[28:31], v3, s[4:7], s45 offen sc1
    buffer_load_dwordx4 v[32:35], v4, s[4:7], s45 offen sc1
    buffer_load_dwordx4 v[36:39], v5, s[4:7], s45 offen sc1
    v_rcp_f32 v192, v192
    v_rcp_f32 v193, v193
    v_rcp_f32 v194, v194
    v_rcp_f32 v195, v195
    v_pk_mul_f32 v[104:105], v[104:105], v[192:193]
    v_pk_mul_f32 v[106:107], v[106:107], v[194:195]
    v_cvt_pk_bf16_f32 v200, v104, v105
    v_cvt_pk_bf16_f32 v201, v106, v107
    v_pk_fma_f32 v[112:113], v[144:145], v[156:157], v[112:113] op_sel_hi:[1,0,1]
    v_pk_fma_f32 v[114:115], v[146:147], v[156:157], v[114:115] op_sel_hi:[1,0,1]
    v_pk_mul_f32 v[192:193], v[112:113], v[112:113]
    v_pk_mul_f32 v[194:195], v[114:115], v[114:115]
    v_pk_fma_f32 v[116:117], v[148:149], v[156:157], v[116:117] op_sel_hi:[1,0,1]
    v_pk_fma_f32 v[118:119], v[150:151], v[156:157], v[118:119] op_sel_hi:[1,0,1]
    v_pk_fma_f32 v[192:193], v[192:193], v[158:159], v[158:159] op_sel:[0,1,0] op_sel_hi:[1,1,0]
    v_pk_fma_f32 v[194:195], v[194:195], v[158:159], v[158:159] op_sel:[0,1,0] op_sel_hi:[1,1,0]
    v_pk_mul_f32 v[192:193], v[192:193], v[112:113]
    v_pk_mul_f32 v[194:195], v[194:195], v[114:115]
    s_bfe_u32 s46, s63, 262152
    s_mul_i32 s46, s46, 532480
    s_add_u32 s46, s46, s61
    buffer_load_dwordx4 v[40:43], v2, s[4:7], s46 offen sc1
    buffer_load_dwordx4 v[44:47], v3, s[4:7], s46 offen sc1
    buffer_load_dwordx4 v[48:51], v4, s[4:7], s46 offen sc1
    buffer_load_dwordx4 v[52:55], v5, s[4:7], s46 offen sc1
    v_exp_f32 v192, v192
    v_exp_f32 v193, v193
    v_exp_f32 v194, v194
    v_exp_f32 v195, v195
    v_pk_mul_f32 v[112:113], v[112:113], v[116:117]
    v_pk_mul_f32 v[114:115], v[114:115], v[118:119]
    v_pk_fma_f32 v[192:193], v[192:193], v[156:157], v[156:157] op_sel:[0,1,1] op_sel_hi:[1,1,1]
    v_pk_fma_f32 v[194:195], v[194:195], v[156:157], v[156:157] op_sel:[0,1,1] op_sel_hi:[1,1,1]
    s_bfe_u32 s47, s63, 262156
    s_mul_i32 s47, s47, 532480
    s_add_u32 s47, s47, s61
    buffer_load_dwordx4 v[56:59], v2, s[4:7], s47 offen sc1
    buffer_load_dwordx4 v[60:63], v3, s[4:7], s47 offen sc1
    buffer_load_dwordx4 v[64:67], v4, s[4:7], s47 offen sc1
    buffer_load_dwordx4 v[68:71], v5, s[4:7], s47 offen sc1
    v_rcp_f32 v192, v192
    v_rcp_f32 v193, v193
    v_rcp_f32 v194, v194
    v_rcp_f32 v195, v195
    v_pk_mul_f32 v[112:113], v[112:113], v[192:193]
    v_pk_mul_f32 v[114:115], v[114:115], v[194:195]
    v_cvt_pk_bf16_f32 v202, v112, v113
    v_cvt_pk_bf16_f32 v203, v114, v115
    s_nop 0
    v_permlane16_swap_b32 v200, v202
    v_permlane16_swap_b32 v201, v203
    v_and_b32 v200, s89, v200
    v_and_b32 v201, s89, v201
    v_and_b32 v202, s89, v202
    v_and_b32 v203, s89, v203
    buffer_store_dwordx4 v[200:203], v249, s[4:7], s88 offen sc1
    s_waitcnt vmcnt(14)
    v_max3_u32 v6, v11, v15, v19
    s_waitcnt vmcnt(13)
    v_max_u32 v6, v6, v23
    v_cmp_le_u32 vcc, 0xffff0000, v6
    s_cbranch_vccnz D_rt0
D_ok0:
    v_mfma_f32_16x16x32_bf16 v[92:95], a[120:123], v[12:15], 0
    s_bfe_u32 s48, s63, 262160
    s_mul_i32 s48, s48, 532480
    s_add_u32 s48, s48, s61
    v_mfma_f32_16x16x32_bf16 v[96:99], a[124:127], v[12:15], 0
    buffer_load_dwordx4 v[156:159], v3, s[4:7], s48 offen sc1
    v_mfma_f32_16x16x32_bf16 v[100:103], a[128:131], v[12:15], 0
    v_mfma_f32_16x16x32_bf16 v[104:107], a[132:135], v[12:15], 0
    v_mfma_f32_16x16x32_bf16 v[108:111], a[136:139], v[12:15], 0
    v_mfma_f32_16x16x32_bf16 v[128:131], a[136:139], v[16:19], 0
    buffer_load_dwordx4 v[160:163], v4, s[4:7], s48 offen sc1
    v_mfma_f32_16x16x32_bf16 v[124:127], a[132:135], v[16:19], 0
    v_mfma_f32_16x16x32_bf16 v[120:123], a[128:131], v[16:19], 0
    v_mfma_f32_16x16x32_bf16 v[116:119], a[124:127], v[16:19], 0
    v_mfma_f32_16x16x32_bf16 v[112:115], a[120:123], v[16:19], 0
    buffer_load_dwordx4 v[164:167], v5, s[4:7], s48 offen sc1
    v_mfma_f32_16x16x32_bf16 v[132:135], a[120:123], v[20:23], 0
    v_mfma_f32_16x16x32_bf16 v[136:139], a[124:127], v[20:23], 0
    v_mfma_f32_16x16x32_bf16 v[140:143], a[128:131], v[20:23], 0
    v_mfma_f32_16x16x32_bf16 v[144:147], a[132:135], v[20:23], 0
    buffer_load_dwordx4 v[152:155], v2, s[4:7], s48 offen sc1
    s_waitcnt vmcnt(13)
    v_max3_u32 v6, v31, v35, v39
    v_mfma_f32_16x16x32_bf16 v[148:151], a[136:139], v[20:23], 0
    v_mfma_f32_16x16x32_bf16 v[88:91], a[136:139], v[8:11], 0
    v_max_u32 v6, v6, v27
    v_mfma_f32_16x16x32_bf16 v[84:87], a[132:135], v[8:11], 0
    s_bfe_u32 s49, s63, 262164
    s_mul_i32 s49, s49, 532480
    s_add_u32 s49, s49, s61
    v_mfma_f32_16x16x32_bf16 v[80:83], a[128:131], v[8:11], 0
    buffer_load_dwordx4 v[172:175], v3, s[4:7], s49 offen sc1
    v_cmp_le_u32 vcc, 0xffff0000, v6
    v_mfma_f32_16x16x32_bf16 v[76:79], a[124:127], v[8:11], 0
    s_cbranch_vccnz D_rt1
D_ok1:
    v_mfma_f32_16x16x32_bf16 v[72:75], a[120:123], v[8:11], 0
    v_mfma_f32_16x16x32_bf16 v[92:95], a[140:143], v[28:31], v[92:95]
    v_mfma_f32_16x16x32_bf16 v[96:99], a[144:147], v[28:31], v[96:99]
    buffer_load_dwordx4 v[176:179], v4, s[4:7], s49 offen sc1
    v_mfma_f32_16x16x32_bf16 v[100:103], a[148:151], v[28:31], v[100:103]
    v_mfma_f32_16x16x32_bf16 v[104:107], a[152:155], v[28:31], v[104:107]
    v_mfma_f32_16x16x32_bf16 v[108:111], a[156:159], v[28:31], v[108:111]
    v_mfma_f32_16x16x32_bf16 v[128:131], a[156:159], v[32:35], v[128:131]
    buffer_load_dwordx4 v[180:183], v5, s[4:7], s49 offen sc1
    v_mfma_f32_16x16x32_bf16 v[124:127], a[152:155], v[32:35], v[124:127]
    v_mfma_f32_16x16x32_bf16 v[120:123], a[148:151], v[32:35], v[120:123]
    v_mfma_f32_16x16x32_bf16 v[116:119], a[144:147], v[32:35], v[116:119]
    v_mfma_f32_16x16x32_bf16 v[112:115], a[140:143], v[32:35], v[112:115]
    buffer_load_dwordx4 v[168:171], v2, s[4:7], s49 offen sc1
    v_mfma_f32_16x16x32_bf16 v[132:135], a[140:143], v[36:39], v[132:135]
    v_mfma_f32_16x16x32_bf16 v[136:139], a[144:147], v[36:39], v[136:139]
    v_mfma_f32_16x16x32_bf16 v[140:143], a[148:151], v[36:39], v[140:143]
    s_bfe_u32 s50, s63, 262168
    s_mul_i32 s50, s50, 532480
    s_add_u32 s50, s50, s61
    v_mfma_f32_16x16x32_bf16 v[144:147], a[152:155], v[36:39], v[144:147]
    buffer_load_dwordx4 v[12:15], v3, s[4:7], s50 offen sc1
    s_waitcnt vmcnt(14)
    v_max3_u32 v6, v47, v51, v55
    v_mfma_f32_16x16x32_bf16 v[148:151], a[156:159], v[36:39], v[148:151]
    v_mfma_f32_16x16x32_bf16 v[88:91], a[156:159], v[24:27], v[88:91]
    v_max_u32 v6, v6, v43
    v_mfma_f32_16x16x32_bf16 v[84:87], a[152:155], v[24:27], v[84:87]
    v_mfma_f32_16x16x32_bf16 v[80:83], a[148:151], v[24:27], v[80:83]
    buffer_load_dwordx4 v[16:19], v4, s[4:7], s50 offen sc1
    v_cmp_le_u32 vcc, 0xffff0000, v6
    v_mfma_f32_16x16x32_bf16 v[76:79], a[144:147], v[24:27], v[76:79]
    s_cbranch_vccnz D_rt2
D_ok2:
    v_mfma_f32_16x16x32_bf16 v[72:75], a[140:143], v[24:27], v[72:75]
    v_mfma_f32_16x16x32_bf16 v[92:95], a[160:163], v[44:47], v[92:95]
    v_mfma_f32_16x16x32_bf16 v[96:99], a[164:167], v[44:47], v[96:99]
    buffer_load_dwordx4 v[20:23], v5, s[4:7], s50 offen sc1
    v_mfma_f32_16x16x32_bf16 v[100:103], a[168:171], v[44:47], v[100:103]
    v_mfma_f32_16x16x32_bf16 v[104:107], a[172:175], v[44:47], v[104:107]
    v_mfma_f32_16x16x32_bf16 v[108:111], a[176:179], v[44:47], v[108:111]
    v_mfma_f32_16x16x32_bf16 v[128:131], a[176:179], v[48:51], v[128:131]
    buffer_load_dwordx4 v[8:11], v2, s[4:7], s50 offen sc1
    v_mfma_f32_16x16x32_bf16 v[124:127], a[172:175], v[48:51], v[124:127]
    v_mfma_f32_16x16x32_bf16 v[120:123], a[168:171], v[48:51], v[120:123]
    v_mfma_f32_16x16x32_bf16 v[116:119], a[164:167], v[48:51], v[116:119]
    s_bfe_u32 s51, s63, 262172
    s_mul_i32 s51, s51, 532480
    s_add_u32 s51, s51, s61
    v_mfma_f32_16x16x32_bf16 v[112:115], a[160:163], v[48:51], v[112:115]
    buffer_load_dwordx4 v[28:31], v3, s[4:7], s51 offen sc1
    v_mfma_f32_16x16x32_bf16 v[132:135], a[160:163], v[52:55], v[132:135]
    v_mfma_f32_16x16x32_bf16 v[136:139], a[164:167], v[52:55], v[136:139]
    v_mfma_f32_16x16x32_bf16 v[140:143], a[168:171], v[52:55], v[140:143]
    v_mfma_f32_16x16x32_bf16 v[144:147], a[172:175], v[52:55], v[144:147]
    buffer_load_dwordx4 v[32:35], v4, s[4:7], s51 offen sc1
    s_waitcnt vmcnt(15)
    v_max3_u32 v6, v63, v67, v71
    v_mfma_f32_16x16x32_bf16 v[148:151], a[176:179], v[52:55], v[148:151]
    v_mfma_f32_16x16x32_bf16 v[88:91], a[176:179], v[40:43], v[88:91]
    v_max_u32 v6, v6, v59
    v_mfma_f32_16x16x32_bf16 v[84:87], a[172:175], v[40:43], v[84:87]
    v_mfma_f32_16x16x32_bf16 v[80:83], a[168:171], v[40:43], v[80:83]
    buffer_load_dwordx4 v[36:39], v5, s[4:7], s51 offen sc1
    v_cmp_le_u32 vcc, 0xffff0000, v6
    v_mfma_f32_16x16x32_bf16 v[76:79], a[164:167], v[40:43], v[76:79]
    s_cbranch_vccnz D_rt3
D_ok3:
    v_mfma_f32_16x16x32_bf16 v[72:75], a[160:163], v[40:43], v[72:75]
    v_mfma_f32_16x16x32_bf16 v[92:95], a[180:183], v[60:63], v[92:95]
    v_mfma_f32_16x16x32_bf16 v[96:99], a[184:187], v[60:63], v[96:99]
    buffer_load_dwordx4 v[24:27], v2, s[4:7], s51 offen sc1
    v_mfma_f32_16x16x32_bf16 v[100:103], a[188:191], v[60:63], v[100:103]
    v_mfma_f32_16x16x32_bf16 v[104:107], a[192:195], v[60:63], v[104:107]
    v_mfma_f32_16x16x32_bf16 v[108:111], a[196:199], v[60:63], v[108:111]
    s_bfe_u32 s52, s35, 262144
    s_mul_i32 s52, s52, 532480
    s_add_u32 s52, s52, s61
    v_mfma_f32_16x16x32_bf16 v[128:131], a[196:199], v[64:67], v[128:131]
    buffer_load_dwordx4 v[44:47], v3, s[4:7], s52 offen sc1
    v_mfma_f32_16x16x32_bf16 v[124:127], a[192:195], v[64:67], v[124:127]
    v_mfma_f32_16x16x32_bf16 v[120:123], a[188:191], v[64:67], v[120:123]
    v_mfma_f32_16x16x32_bf16 v[116:119], a[184:187], v[64:67], v[116:119]
    s_xor_b32 s88, s28, 1
    s_mul_i32 s88, s88, 15360
    v_mfma_f32_16x16x32_bf16 v[112:115], a[180:183], v[64:67], v[112:115]
    buffer_load_dwordx4 v[48:51], v4, s[4:7], s52 offen sc1
    v_mfma_f32_16x16x32_bf16 v[132:135], a[180:183], v[68:71], v[132:135]
    s_add_u32 s88, s88, 0
    v_add_u32 v232, s88, v252
    v_mfma_f32_16x16x32_bf16 v[136:139], a[184:187], v[68:71], v[136:139]
    s_xor_b32 s88, s28, 2
    s_mul_i32 s88, s88, 15360
    v_mfma_f32_16x16x32_bf16 v[140:143], a[188:191], v[68:71], v[140:143]
    s_add_u32 s88, s88, 5120
    v_add_u32 v233, s88, v252
    v_mfma_f32_16x16x32_bf16 v[144:147], a[192:195], v[68:71], v[144:147]
    buffer_load_dwordx4 v[52:55], v5, s[4:7], s52 offen sc1
    s_waitcnt vmcnt(16)
    v_max3_u32 v6, v159, v163, v167
    v_mfma_f32_16x16x32_bf16 v[148:151], a[196:199], v[68:71], v[148:151]
    s_xor_b32 s88, s28, 3
    s_mul_i32 s88, s88, 15360
    v_mfma_f32_16x16x32_bf16 v[88:91], a[196:199], v[56:59], v[88:91]
    s_waitcnt vmcnt(15)
    v_max_u32 v6, v6, v155
    s_add_u32 s88, s88, 10240
    v_mfma_f32_16x16x32_bf16 v[84:87], a[192:195], v[56:59], v[84:87]
    v_add_u32 v234, s88, v252
    s_mul_i32 s88, s28, 15360
    v_mfma_f32_16x16x32_bf16 v[80:83], a[188:191], v[56:59], v[80:83]
    buffer_load_dwordx4 v[40:43], v2, s[4:7], s52 offen sc1
    v_cmp_le_u32 vcc, 0xffff0000, v6
    v_mfma_f32_16x16x32_bf16 v[76:79], a[184:187], v[56:59], v[76:79]
    s_cbranch_vccnz D_rt4
D_ok4:
    s_add_u32 s88, s88, 0
    v_mfma_f32_16x16x32_bf16 v[72:75], a[180:183], v[56:59], v[72:75]
    v_add_u32 v235, s88, v252
    v_and_b32 v7, 15, v1
    v_mfma_f32_16x16x32_bf16 v[92:95], a[200:203], v[156:159], v[92:95]
    s_bfe_u32 s53, s35, 262148
    s_mul_i32 s53, s53, 532480
    s_add_u32 s53, s53, s61
    v_mfma_f32_16x16x32_bf16 v[96:99], a[204:207], v[156:159], v[96:99]
    buffer_load_dwordx4 v[60:63], v3, s[4:7], s53 offen sc1
    v_mfma_f32_16x16x32_bf16 v[100:103], a[208:211], v[156:159], v[100:103]
    v_mul_u32_u24 v7, 1280, v7
    v_lshrrev_b32 v250, 4, v1
    v_mfma_f32_16x16x32_bf16 v[104:107], a[212:215], v[156:159], v[104:107]
    v_lshl_add_u32 v7, v250, 3, v7
    s_mov_b32 s8, s82
    v_mfma_f32_16x16x32_bf16 v[108:111], a[216:219], v[156:159], v[108:111]
    s_mov_b32 s9, s83
    s_lshl_b32 s88, s84, 2
    v_mfma_f32_16x16x32_bf16 v[128:131], a[216:219], v[160:163], v[128:131]
    buffer_load_dwordx4 v[64:67], v4, s[4:7], s53 offen sc1
    v_mfma_f32_16x16x32_bf16 v[124:127], a[212:215], v[160:163], v[124:127]
    s_add_u32 s88, s88, s78
    s_lshl_b32 s88, s88, 2
    v_mfma_f32_16x16x32_bf16 v[120:123], a[208:211], v[160:163], v[120:123]
    s_add_u32 s88, s88, s28
    s_mul_i32 s88, s88, 20480
    v_mfma_f32_16x16x32_bf16 v[116:119], a[204:207], v[160:163], v[116:119]
    s_mul_i32 s89, s77, 160
    s_add_u32 s88, s88, s89
    v_mfma_f32_16x16x32_bf16 v[112:115], a[200:203], v[160:163], v[112:115]
    buffer_load_dwordx4 v[68:71], v5, s[4:7], s53 offen sc1
    v_mfma_f32_16x16x32_bf16 v[132:135], a[200:203], v[164:167], v[132:135]
    v_lshl_add_u32 v250, v250, 3, v7
    s_and_b32 s90, s77, 1
    v_mfma_f32_16x16x32_bf16 v[136:139], a[204:207], v[164:167], v[136:139]
    s_lshl_b32 s90, s90, 5
    s_add_u32 s89, s88, s90
    v_mfma_f32_16x16x32_bf16 v[140:143], a[208:211], v[164:167], v[140:143]
    s_lshl_b32 s90, s90, 2
    s_sub_u32 s88, s88, s90
    v_mfma_f32_16x16x32_bf16 v[144:147], a[212:215], v[164:167], v[144:147]
    buffer_load_dwordx4 v[56:59], v2, s[4:7], s53 offen sc1
    s_waitcnt vmcnt(17)
    v_max3_u32 v6, v175, v179, v183
    v_mfma_f32_16x16x32_bf16 v[148:151], a[216:219], v[164:167], v[148:151]
    s_mul_i32 s91, s28, 5120
    v_and_b32 v206, 15, v1
    v_and_b32 v207, 48, v1
    v_lshl_add_u32 v206, v206, 6, v207
    s_add_u32 s91, s91, 65536
    v_add_u32 v206, s91, v206
    v_mfma_f32_16x16x32_bf16 v[88:91], a[216:219], v[152:155], v[88:91]
    s_waitcnt vmcnt(16)
    v_max_u32 v6, v6, v171
    v_mfma_f32_16x16x32_bf16 v[84:87], a[212:215], v[152:155], v[84:87]
    v_accvgpr_read_b32 v204, a244
    s_add_u32 m0, s91, 0
    v_mfma_f32_16x16x32_bf16 v[80:83], a[208:211], v[152:155], v[80:83]
    buffer_load_dwordx4 v204, s[4:7], s62 offen sc1 lds
    v_cmp_le_u32 vcc, 0xffff0000, v6
    v_mfma_f32_16x16x32_bf16 v[76:79], a[204:207], v[152:155], v[76:79]
    s_cbranch_vccnz D_rt5
D_ok5:
    v_mfma_f32_16x16x32_bf16 v[72:75], a[200:203], v[152:155], v[72:75]
    v_mfma_f32_16x16x32_bf16 v[92:95], a[220:223], v[172:175], v[92:95]
    v_accvgpr_read_b32 v205, a245
    s_add_u32 m0, s91, 1024
    v_mfma_f32_16x16x32_bf16 v[96:99], a[224:227], v[172:175], v[96:99]
    buffer_load_dwordx4 v205, s[4:7], s62 offen sc1 lds
    v_mfma_f32_16x16x32_bf16 v[100:103], a[228:231], v[172:175], v[100:103]
    v_mfma_f32_16x16x32_bf16 v[104:107], a[232:235], v[172:175], v[104:107]
    v_mfma_f32_16x16x32_bf16 v[108:111], a[236:239], v[172:175], v[108:111]
    v_accvgpr_read_b32 v204, a246
    s_add_u32 m0, s91, 2048
    v_mfma_f32_16x16x32_bf16 v[128:131], a[236:239], v[176:179], v[128:131]
    buffer_load_dwordx4 v204, s[4:7], s62 offen sc1 lds
    v_mfma_f32_16x16x32_bf16 v[124:127], a[232:235], v[176:179], v[124:127]
    v_mfma_f32_16x16x32_bf16 v[120:123], a[228:231], v[176:179], v[120:123]
    v_mfma_f32_16x16x32_bf16 v[116:119], a[224:227], v[176:179], v[116:119]
    v_accvgpr_read_b32 v205, a247
    s_add_u32 m0, s91, 3072
    v_mfma_f32_16x16x32_bf16 v[112:115], a[220:223], v[176:179], v[112:115]
    buffer_load_dwordx4 v205, s[4:7], s62 offen sc1 lds
    v_mfma_f32_16x16x32_bf16 v[132:135], a[220:223], v[180:183], v[132:135]
    v_mfma_f32_16x16x32_bf16 v[136:139], a[224:227], v[180:183], v[136:139]
    v_mfma_f32_16x16x32_bf16 v[140:143], a[228:231], v[180:183], v[140:143]
    v_accvgpr_read_b32 v204, a248
    s_add_u32 m0, s91, 4096
    v_mfma_f32_16x16x32_bf16 v[144:147], a[232:235], v[180:183], v[144:147]
    buffer_load_dwordx4 v204, s[4:7], s62 offen sc1 lds
    s_waitcnt vmcnt(18)
    v_max3_u32 v6, v15, v19, v23
    v_mfma_f32_16x16x32_bf16 v[148:151], a[236:239], v[180:183], v[148:151]
    v_mfma_f32_16x16x32_bf16 v[88:91], a[236:239], v[168:171], v[88:91]
    s_waitcnt vmcnt(17)
    v_max_u32 v6, v6, v11
    v_mfma_f32_16x16x32_bf16 v[84:87], a[232:235], v[168:171], v[84:87]
    s_bfe_u32 s54, s35, 262152
    s_mul_i32 s54, s54, 532480
    s_add_u32 s54, s54, s61
    v_mfma_f32_16x16x32_bf16 v[80:83], a[228:231], v[168:171], v[80:83]
    buffer_load_dwordx4 v[156:159], v3, s[4:7], s54 offen sc1
    v_cmp_le_u32 vcc, 0xffff0000, v6
    v_mfma_f32_16x16x32_bf16 v[76:79], a[224:227], v[168:171], v[76:79]
    s_cbranch_vccnz D_rt6
D_ok6:
    v_mfma_f32_16x16x32_bf16 v[72:75], a[220:223], v[168:171], v[72:75]
    v_mfma_f32_16x16x32_bf16 v[92:95], a[240:243], v[12:15], v[92:95]
    v_mfma_f32_16x16x32_bf16 v[96:99], v[208:211], v[12:15], v[96:99]
    buffer_load_dwordx4 v[160:163], v4, s[4:7], s54 offen sc1
    v_mfma_f32_16x16x32_bf16 v[100:103], v[212:215], v[12:15], v[100:103]
    v_mfma_f32_16x16x32_bf16 v[104:107], v[216:219], v[12:15], v[104:107]
    v_mfma_f32_16x16x32_bf16 v[108:111], v[236:239], v[12:15], v[108:111]
    v_mfma_f32_16x16x32_bf16 v[128:131], v[236:239], v[16:19], v[128:131]
    buffer_load_dwordx4 v[164:167], v5, s[4:7], s54 offen sc1
    v_mfma_f32_16x16x32_bf16 v[124:127], v[216:219], v[16:19], v[124:127]
    v_mfma_f32_16x16x32_bf16 v[120:123], v[212:215], v[16:19], v[120:123]
    v_mfma_f32_16x16x32_bf16 v[116:119], v[208:211], v[16:19], v[116:119]
    v_mfma_f32_16x16x32_bf16 v[112:115], a[240:243], v[16:19], v[112:115]
    buffer_load_dwordx4 v[152:155], v2, s[4:7], s54 offen sc1
    v_mfma_f32_16x16x32_bf16 v[132:135], a[240:243], v[20:23], v[132:135]
    v_mfma_f32_16x16x32_bf16 v[136:139], v[208:211], v[20:23], v[136:139]
    v_mfma_f32_16x16x32_bf16 v[140:143], v[212:215], v[20:23], v[140:143]
    s_bfe_u32 s55, s35, 262156
    s_mul_i32 s55, s55, 532480
    s_add_u32 s55, s55, s61
    v_mfma_f32_16x16x32_bf16 v[144:147], v[216:219], v[20:23], v[144:147]
    buffer_load_dwordx4 v[172:175], v3, s[4:7], s55 offen sc1
    s_waitcnt vmcnt(19)
    v_max3_u32 v6, v31, v35, v39
    v_mfma_f32_16x16x32_bf16 v[148:151], v[236:239], v[20:23], v[148:151]
    v_mfma_f32_16x16x32_bf16 v[88:91], v[236:239], v[8:11], v[88:91]
    s_waitcnt vmcnt(18)
    v_max_u32 v6, v6, v27
    v_mfma_f32_16x16x32_bf16 v[84:87], v[216:219], v[8:11], v[84:87]
    s_bfe_u32 s56, s35, 262160
    s_mul_i32 s56, s56, 532480
    s_add_u32 s56, s56, s61
    v_mfma_f32_16x16x32_bf16 v[80:83], v[212:215], v[8:11], v[80:83]
    buffer_load_dwordx4 v[12:15], v3, s[4:7], s56 offen sc1
    v_cmp_le_u32 vcc, 0xffff0000, v6
    v_mfma_f32_16x16x32_bf16 v[76:79], v[208:211], v[8:11], v[76:79]
    s_cbranch_vccnz D_rt7
D_ok7:
    v_mfma_f32_16x16x32_bf16 v[72:75], a[240:243], v[8:11], v[72:75]
    v_mfma_f32_16x16x32_bf16 v[92:95], v[240:243], v[28:31], v[92:95]
    v_mfma_f32_16x16x32_bf16 v[96:99], v[244:247], v[28:31], v[96:99]
    s_bfe_u32 s94, s35, 262160
    s_mul_i32 s94, s94, 5120
    s_add_u32 s94, s94, s60
    buffer_load_dwordx4 a[92:95], v252, s[4:7], s94 offen offset:0 sc1
    v_mfma_f32_16x16x32_bf16 v[100:103], a[0:3], v[28:31], v[100:103]
    v_mfma_f32_16x16x32_bf16 v[104:107], a[4:7], v[28:31], v[104:107]
    v_mfma_f32_16x16x32_bf16 v[108:111], a[8:11], v[28:31], v[108:111]
    s_bfe_u32 s57, s35, 262164
    s_mul_i32 s57, s57, 532480
    s_add_u32 s57, s57, s61
    v_mfma_f32_16x16x32_bf16 v[128:131], a[8:11], v[32:35], v[128:131]
    buffer_load_dwordx4 v[28:31], v3, s[4:7], s57 offen sc1
    v_mfma_f32_16x16x32_bf16 v[124:127], a[4:7], v[32:35], v[124:127]
    v_mfma_f32_16x16x32_bf16 v[120:123], a[0:3], v[32:35], v[120:123]
    v_mfma_f32_16x16x32_bf16 v[116:119], v[244:247], v[32:35], v[116:119]
    v_mfma_f32_16x16x32_bf16 v[112:115], v[240:243], v[32:35], v[112:115]
    buffer_load_dwordx4 a[96:99], v252, s[4:7], s94 offen offset:1024 sc1
    v_mfma_f32_16x16x32_bf16 v[132:135], v[240:243], v[36:39], v[132:135]
    v_mfma_f32_16x16x32_bf16 v[136:139], v[244:247], v[36:39], v[136:139]
    v_mfma_f32_16x16x32_bf16 v[140:143], a[0:3], v[36:39], v[140:143]
    v_mfma_f32_16x16x32_bf16 v[144:147], a[4:7], v[36:39], v[144:147]
    buffer_load_dwordx4 a[100:103], v252, s[4:7], s94 offen offset:2048 sc1
    s_waitcnt vmcnt(20)
    v_max3_u32 v6, v47, v51, v55
    v_mfma_f32_16x16x32_bf16 v[148:151], a[8:11], v[36:39], v[148:151]
    v_mfma_f32_16x16x32_bf16 v[88:91], a[8:11], v[24:27], v[88:91]
    s_waitcnt vmcnt(19)
    v_max_u32 v6, v6, v43
    v_mfma_f32_16x16x32_bf16 v[84:87], a[4:7], v[24:27], v[84:87]
    v_mfma_f32_16x16x32_bf16 v[80:83], a[0:3], v[24:27], v[80:83]
    buffer_load_dwordx4 v[176:179], v4, s[4:7], s55 offen sc1
    v_cmp_le_u32 vcc, 0xffff0000, v6
    v_mfma_f32_16x16x32_bf16 v[76:79], v[244:247], v[24:27], v[76:79]
    s_cbranch_vccnz D_rt8
D_ok8:
    v_mfma_f32_16x16x32_bf16 v[72:75], v[240:243], v[24:27], v[72:75]
    v_mfma_f32_16x16x32_bf16 v[92:95], a[12:15], v[44:47], v[92:95]
    v_mfma_f32_16x16x32_bf16 v[96:99], a[16:19], v[44:47], v[96:99]
    buffer_load_dwordx4 v[16:19], v4, s[4:7], s56 offen sc1
    v_mfma_f32_16x16x32_bf16 v[100:103], a[20:23], v[44:47], v[100:103]
    v_mfma_f32_16x16x32_bf16 v[104:107], a[24:27], v[44:47], v[104:107]
    v_mfma_f32_16x16x32_bf16 v[108:111], a[28:31], v[44:47], v[108:111]
    v_mfma_f32_16x16x32_bf16 v[128:131], a[28:31], v[48:51], v[128:131]
    buffer_load_dwordx4 v[32:35], v4, s[4:7], s57 offen sc1
    v_mfma_f32_16x16x32_bf16 v[124:127], a[24:27], v[48:51], v[124:127]
    v_mfma_f32_16x16x32_bf16 v[120:123], a[20:23], v[48:51], v[120:123]
    v_mfma_f32_16x16x32_bf16 v[116:119], a[16:19], v[48:51], v[116:119]
    v_mfma_f32_16x16x32_bf16 v[112:115], a[12:15], v[48:51], v[112:115]
    buffer_load_dwordx4 a[104:107], v252, s[4:7], s94 offen offset:3072 sc1
    v_mfma_f32_16x16x32_bf16 v[132:135], a[12:15], v[52:55], v[132:135]
    v_mfma_f32_16x16x32_bf16 v[136:139], a[16:19], v[52:55], v[136:139]
    v_mfma_f32_16x16x32_bf16 v[140:143], a[20:23], v[52:55], v[140:143]
    v_mfma_f32_16x16x32_bf16 v[144:147], a[24:27], v[52:55], v[144:147]
    s_add_u32 s94, s94, 4096
    buffer_load_dwordx4 a[108:111], v252, s[4:7], s94 offen offset:0 sc1
    s_waitcnt vmcnt(21)
    v_max3_u32 v6, v63, v67, v71
    v_mfma_f32_16x16x32_bf16 v[148:151], a[28:31], v[52:55], v[148:151]
    v_mfma_f32_16x16x32_bf16 v[88:91], a[28:31], v[40:43], v[88:91]
    s_waitcnt vmcnt(20)
    v_max_u32 v6, v6, v59
    v_mfma_f32_16x16x32_bf16 v[84:87], a[24:27], v[40:43], v[84:87]
    v_mfma_f32_16x16x32_bf16 v[80:83], a[20:23], v[40:43], v[80:83]
    s_bfe_u32 s94, s35, 262164
    s_mul_i32 s94, s94, 5120
    s_add_u32 s94, s94, s60
    buffer_load_dwordx4 a[112:115], v252, s[4:7], s94 offen offset:0 sc1
    v_cmp_le_u32 vcc, 0xffff0000, v6
    v_mfma_f32_16x16x32_bf16 v[76:79], a[16:19], v[40:43], v[76:79]
    s_cbranch_vccnz D_rt9
D_ok9:
    v_mfma_f32_16x16x32_bf16 v[72:75], a[12:15], v[40:43], v[72:75]
    v_mfma_f32_16x16x32_bf16 v[92:95], a[32:35], v[60:63], v[92:95]
    v_mfma_f32_16x16x32_bf16 v[96:99], a[36:39], v[60:63], v[96:99]
    buffer_load_dwordx4 a[116:119], v252, s[4:7], s94 offen offset:1024 sc1
    v_mfma_f32_16x16x32_bf16 v[100:103], a[40:43], v[60:63], v[100:103]
    v_mfma_f32_16x16x32_bf16 v[104:107], a[44:47], v[60:63], v[104:107]
    v_mfma_f32_16x16x32_bf16 v[108:111], a[48:51], v[60:63], v[108:111]
    v_mfma_f32_16x16x32_bf16 v[128:131], a[48:51], v[64:67], v[128:131]
    buffer_load_dwordx4 v[220:223], v252, s[4:7], s94 offen offset:2048 sc1
    v_mfma_f32_16x16x32_bf16 v[124:127], a[44:47], v[64:67], v[124:127]
    s_waitcnt vmcnt(18)
    ds_read_b128 v[184:187], v206 offset:0
    v_mfma_f32_16x16x32_bf16 v[120:123], a[40:43], v[64:67], v[120:123]
    v_mfma_f32_16x16x32_bf16 v[116:119], a[36:39], v[64:67], v[116:119]
    ds_read_b128 v[188:191], v206 offset:1024
    v_mfma_f32_16x16x32_bf16 v[112:115], a[32:35], v[64:67], v[112:115]
    buffer_load_dwordx4 v[224:227], v252, s[4:7], s94 offen offset:3072 sc1
    v_mfma_f32_16x16x32_bf16 v[132:135], a[32:35], v[68:71], v[132:135]
    ds_read_b128 v[192:195], v206 offset:2048
    v_mfma_f32_16x16x32_bf16 v[136:139], a[36:39], v[68:71], v[136:139]
    v_mfma_f32_16x16x32_bf16 v[140:143], a[40:43], v[68:71], v[140:143]
    ds_read_b128 v[196:199], v206 offset:3072
    v_mfma_f32_16x16x32_bf16 v[144:147], a[44:47], v[68:71], v[144:147]
    s_add_u32 s94, s94, 4096
    buffer_load_dwordx4 v[228:231], v252, s[4:7], s94 offen offset:0 sc1
    v_mfma_f32_16x16x32_bf16 v[148:151], a[48:51], v[68:71], v[148:151]
    ds_read_b128 v[200:203], v206 offset:4096
    v_mfma_f32_16x16x32_bf16 v[88:91], a[48:51], v[56:59], v[88:91]
    v_mfma_f32_16x16x32_bf16 v[84:87], a[44:47], v[56:59], v[84:87]
    v_mfma_f32_16x16x32_bf16 v[80:83], a[40:43], v[56:59], v[80:83]
    buffer_load_dwordx4 v[180:183], v5, s[4:7], s55 offen sc1
    v_mfma_f32_16x16x32_bf16 v[76:79], a[36:39], v[56:59], v[76:79]
    s_waitcnt vmcnt(18)
    v_max3_u32 v6, v159, v163, v167
    v_mfma_f32_16x16x32_bf16 v[72:75], a[32:35], v[56:59], v[72:75]
    s_waitcnt lgkmcnt(0)
    v_mfma_f32_16x16x32_bf16 v[88:91], v[200:203], a[252:255], v[88:91]
    s_waitcnt vmcnt(17)
    v_max_u32 v6, v6, v155
    v_mfma_f32_16x16x32_bf16 v[84:87], v[196:199], a[252:255], v[84:87]
    buffer_load_dwordx4 v[20:23], v5, s[4:7], s56 offen sc1
    v_mfma_f32_16x16x32_bf16 v[80:83], v[192:195], a[252:255], v[80:83]
    v_cmp_le_u32 vcc, 0xffff0000, v6
    v_mfma_f32_16x16x32_bf16 v[76:79], v[188:191], a[252:255], v[76:79]
    s_cbranch_vccnz D_rt10
D_ok10:
    v_mfma_f32_16x16x32_bf16 v[72:75], v[184:187], a[252:255], v[72:75]
    v_mfma_f32_16x16x32_bf16 v[92:95], a[52:55], v[156:159], v[92:95]
    buffer_load_dwordx4 v[36:39], v5, s[4:7], s57 offen sc1
    v_mfma_f32_16x16x32_bf16 v[96:99], a[56:59], v[156:159], v[96:99]
    v_mfma_f32_16x16x32_bf16 v[100:103], a[60:63], v[156:159], v[100:103]
    v_mfma_f32_16x16x32_bf16 v[104:107], a[64:67], v[156:159], v[104:107]
    v_mfma_f32_16x16x32_bf16 v[108:111], a[68:71], v[156:159], v[108:111]
    buffer_load_dwordx4 v[168:171], v2, s[4:7], s55 offen sc1
    v_mfma_f32_16x16x32_bf16 v[128:131], a[68:71], v[160:163], v[128:131]
    v_mfma_f32_16x16x32_bf16 v[124:127], a[64:67], v[160:163], v[124:127]
    v_mfma_f32_16x16x32_bf16 v[120:123], a[60:63], v[160:163], v[120:123]
    v_mfma_f32_16x16x32_bf16 v[116:119], a[56:59], v[160:163], v[116:119]
    buffer_load_dwordx4 v[8:11], v2, s[4:7], s56 offen sc1
    v_mfma_f32_16x16x32_bf16 v[112:115], a[52:55], v[160:163], v[112:115]
    v_mfma_f32_16x16x32_bf16 v[132:135], a[52:55], v[164:167], v[132:135]
    v_mfma_f32_16x16x32_bf16 v[136:139], a[56:59], v[164:167], v[136:139]
    v_mfma_f32_16x16x32_bf16 v[140:143], a[60:63], v[164:167], v[140:143]
    buffer_load_dwordx4 v[24:27], v2, s[4:7], s57 offen sc1
    v_mfma_f32_16x16x32_bf16 v[144:147], a[64:67], v[164:167], v[144:147]
    v_mfma_f32_16x16x32_bf16 v[148:151], a[68:71], v[164:167], v[148:151]
    v_mfma_f32_16x16x32_bf16 v[88:91], a[68:71], v[152:155], v[88:91]
    s_waitcnt vmcnt(18)
    v_max3_u32 v6, v175, v15, v31
    v_mfma_f32_16x16x32_bf16 v[84:87], a[64:67], v[152:155], v[84:87]
    v_mfma_f32_16x16x32_bf16 v[80:83], a[60:63], v[152:155], v[80:83]
    v_cmp_le_u32 vcc, 0xffff0000, v6
    v_mfma_f32_16x16x32_bf16 v[76:79], a[56:59], v[152:155], v[76:79]
    s_cbranch_vccnz D_rt11
D_ok11:
    v_mfma_f32_16x16x32_bf16 v[72:75], a[52:55], v[152:155], v[72:75]
    v_mfma_f32_16x16x32_bf16 v[92:95], a[72:75], v[172:175], v[92:95]
    v_mfma_f32_16x16x32_bf16 v[96:99], a[76:79], v[172:175], v[96:99]
    v_mfma_f32_16x16x32_bf16 v[100:103], a[80:83], v[172:175], v[100:103]
    v_mfma_f32_16x16x32_bf16 v[104:107], a[84:87], v[172:175], v[104:107]
    v_mfma_f32_16x16x32_bf16 v[108:111], a[88:91], v[172:175], v[108:111]
    v_mfma_f32_16x16x32_bf16 v[92:95], a[92:95], v[12:15], v[92:95]
    s_waitcnt vmcnt(17)
    v_mfma_f32_16x16x32_bf16 v[96:99], a[96:99], v[12:15], v[96:99]
    s_waitcnt vmcnt(16)
    v_mfma_f32_16x16x32_bf16 v[100:103], a[100:103], v[12:15], v[100:103]
    s_waitcnt vmcnt(12)
    v_mfma_f32_16x16x32_bf16 v[104:107], a[104:107], v[12:15], v[104:107]
    s_waitcnt vmcnt(11)
    v_mfma_f32_16x16x32_bf16 v[108:111], a[108:111], v[12:15], v[108:111]
    s_waitcnt vmcnt(10)
    v_mfma_f32_16x16x32_bf16 v[92:95], a[112:115], v[28:31], v[92:95]
    v_max3_u32 v6, v179, v19, v35
    s_waitcnt vmcnt(9)
    v_mfma_f32_16x16x32_bf16 v[96:99], a[116:119], v[28:31], v[96:99]
    s_waitcnt vmcnt(8)
    v_mfma_f32_16x16x32_bf16 v[100:103], v[220:223], v[28:31], v[100:103]
    v_cmp_le_u32 vcc, 0xffff0000, v6
    s_waitcnt vmcnt(7)
    v_mfma_f32_16x16x32_bf16 v[104:107], v[224:227], v[28:31], v[104:107]
    s_cbranch_vccnz D_rt12
D_ok12:
    s_waitcnt vmcnt(6)
    v_mfma_f32_16x16x32_bf16 v[108:111], v[228:231], v[28:31], v[108:111]
    ds_write_b128 v232, v[92:95] offset:0
    v_mfma_f32_16x16x32_bf16 v[112:115], a[72:75], v[176:179], v[112:115]
    v_mfma_f32_16x16x32_bf16 v[116:119], a[76:79], v[176:179], v[116:119]
    v_mfma_f32_16x16x32_bf16 v[120:123], a[80:83], v[176:179], v[120:123]
    ds_write_b128 v232, v[96:99] offset:1024
    v_mfma_f32_16x16x32_bf16 v[124:127], a[84:87], v[176:179], v[124:127]
    v_mfma_f32_16x16x32_bf16 v[128:131], a[88:91], v[176:179], v[128:131]
    v_mfma_f32_16x16x32_bf16 v[112:115], a[92:95], v[16:19], v[112:115]
    ds_write_b128 v232, v[100:103] offset:2048
    v_mfma_f32_16x16x32_bf16 v[116:119], a[96:99], v[16:19], v[116:119]
    v_mfma_f32_16x16x32_bf16 v[120:123], a[100:103], v[16:19], v[120:123]
    v_mfma_f32_16x16x32_bf16 v[124:127], a[104:107], v[16:19], v[124:127]
    ds_write_b128 v232, v[104:107] offset:3072
    v_mfma_f32_16x16x32_bf16 v[128:131], a[108:111], v[16:19], v[128:131]
    v_mfma_f32_16x16x32_bf16 v[112:115], a[112:115], v[32:35], v[112:115]
    s_waitcnt vmcnt(3)
    v_max3_u32 v6, v183, v23, v39
    v_mfma_f32_16x16x32_bf16 v[116:119], a[116:119], v[32:35], v[116:119]
    ds_write_b128 v232, v[108:111] offset:4096
    v_mfma_f32_16x16x32_bf16 v[120:123], v[220:223], v[32:35], v[120:123]
    v_cmp_le_u32 vcc, 0xffff0000, v6
    v_mfma_f32_16x16x32_bf16 v[124:127], v[224:227], v[32:35], v[124:127]
    s_cbranch_vccnz D_rt13
D_ok13:
    v_mfma_f32_16x16x32_bf16 v[128:131], v[228:231], v[32:35], v[128:131]
    ds_write_b128 v233, v[112:115] offset:0
    v_mfma_f32_16x16x32_bf16 v[132:135], a[72:75], v[180:183], v[132:135]
    v_mfma_f32_16x16x32_bf16 v[136:139], a[76:79], v[180:183], v[136:139]
    v_mfma_f32_16x16x32_bf16 v[140:143], a[80:83], v[180:183], v[140:143]
    ds_write_b128 v233, v[116:119] offset:1024
    v_mfma_f32_16x16x32_bf16 v[144:147], a[84:87], v[180:183], v[144:147]
    v_mfma_f32_16x16x32_bf16 v[148:151], a[88:91], v[180:183], v[148:151]
    v_mfma_f32_16x16x32_bf16 v[132:135], a[92:95], v[20:23], v[132:135]
    ds_write_b128 v233, v[120:123] offset:2048
    v_mfma_f32_16x16x32_bf16 v[136:139], a[96:99], v[20:23], v[136:139]
    v_mfma_f32_16x16x32_bf16 v[140:143], a[100:103], v[20:23], v[140:143]
    v_mfma_f32_16x16x32_bf16 v[144:147], a[104:107], v[20:23], v[144:147]
    ds_write_b128 v233, v[124:127] offset:3072
    v_mfma_f32_16x16x32_bf16 v[148:151], a[108:111], v[20:23], v[148:151]
    v_mfma_f32_16x16x32_bf16 v[132:135], a[112:115], v[36:39], v[132:135]
    s_waitcnt vmcnt(0)
    v_max3_u32 v6, v171, v11, v27
    v_mfma_f32_16x16x32_bf16 v[136:139], a[116:119], v[36:39], v[136:139]
    ds_write_b128 v233, v[128:131] offset:4096
    v_mfma_f32_16x16x32_bf16 v[140:143], v[220:223], v[36:39], v[140:143]
    v_cmp_le_u32 vcc, 0xffff0000, v6
    v_mfma_f32_16x16x32_bf16 v[144:147], v[224:227], v[36:39], v[144:147]
    s_cbranch_vccnz D_rt14
D_ok14:
    v_mfma_f32_16x16x32_bf16 v[148:151], v[228:231], v[36:39], v[148:151]
    ds_write_b128 v234, v[132:135] offset:0
    v_mfma_f32_16x16x32_bf16 v[72:75], a[72:75], v[168:171], v[72:75]
    v_mfma_f32_16x16x32_bf16 v[76:79], a[76:79], v[168:171], v[76:79]
    v_mfma_f32_16x16x32_bf16 v[80:83], a[80:83], v[168:171], v[80:83]
    ds_write_b128 v234, v[136:139] offset:1024
    v_mfma_f32_16x16x32_bf16 v[84:87], a[84:87], v[168:171], v[84:87]
    v_mfma_f32_16x16x32_bf16 v[88:91], a[88:91], v[168:171], v[88:91]
    v_mfma_f32_16x16x32_bf16 v[72:75], a[92:95], v[8:11], v[72:75]
    ds_write_b128 v234, v[140:143] offset:2048
    v_mfma_f32_16x16x32_bf16 v[76:79], a[96:99], v[8:11], v[76:79]
    v_mfma_f32_16x16x32_bf16 v[80:83], a[100:103], v[8:11], v[80:83]
    v_mfma_f32_16x16x32_bf16 v[84:87], a[104:107], v[8:11], v[84:87]
    ds_write_b128 v234, v[144:147] offset:3072
    v_mfma_f32_16x16x32_bf16 v[88:91], a[108:111], v[8:11], v[88:91]
    v_mfma_f32_16x16x32_bf16 v[72:75], a[112:115], v[24:27], v[72:75]
    v_mfma_f32_16x16x32_bf16 v[76:79], a[116:119], v[24:27], v[76:79]
    ds_write_b128 v234, v[148:151] offset:4096
    v_mfma_f32_16x16x32_bf16 v[80:83], v[220:223], v[24:27], v[80:83]
    v_mfma_f32_16x16x32_bf16 v[84:87], v[224:227], v[24:27], v[84:87]
    v_mfma_f32_16x16x32_bf16 v[88:91], v[228:231], v[24:27], v[88:91]
    s_waitcnt lgkmcnt(0)
    s_barrier
    ds_read_b128 v[8:11], v235 offset:0
    ds_read_b128 v[12:15], v235 offset:5120
    ds_read_b128 v[16:19], v235 offset:10240
    ds_read_b128 v[20:23], v235 offset:1024
    ds_read_b128 v[24:27], v235 offset:6144
    ds_read_b128 v[28:31], v235 offset:11264
    ds_read_b128 v[32:35], v235 offset:2048
    ds_read_b128 v[36:39], v235 offset:7168
    ds_read_b128 v[40:43], v235 offset:12288
    ds_read_b128 v[44:47], v235 offset:3072
    ds_read_b128 v[48:51], v235 offset:8192
    ds_read_b128 v[52:55], v235 offset:13312
    ds_read_b128 v[56:59], v235 offset:4096
    ds_read_b128 v[60:63], v235 offset:9216
    ds_read_b128 v[64:67], v235 offset:14336
    s_waitcnt lgkmcnt(14)
    v_pk_add_f32 v[72:73], v[72:73], v[8:9]
    v_pk_add_f32 v[74:75], v[74:75], v[10:11]
    s_waitcnt lgkmcnt(12)
    v_pk_add_f32 v[12:13], v[12:13], v[16:17]
    v_pk_add_f32 v[14:15], v[14:15], v[18:19]
    v_pk_add_f32 v[72:73], v[72:73], v[12:13]
    v_pk_add_f32 v[74:75], v[74:75], v[14:15]
    v_cvt_pk_bf16_f32 v8, v72, v73
    v_cvt_pk_bf16_f32 v9, v74, v75
    s_waitcnt lgkmcnt(11)
    v_pk_add_f32 v[76:77], v[76:77], v[20:21]
    v_pk_add_f32 v[78:79], v[78:79], v[22:23]
    s_waitcnt lgkmcnt(9)
    v_pk_add_f32 v[24:25], v[24:25], v[28:29]
    v_pk_add_f32 v[26:27], v[26:27], v[30:31]
    v_pk_add_f32 v[76:77], v[76:77], v[24:25]
    v_pk_add_f32 v[78:79], v[78:79], v[26:27]
    v_cvt_pk_bf16_f32 v10, v76, v77
    v_cvt_pk_bf16_f32 v11, v78, v79
    buffer_store_dwordx4 v[8:11], v250, s[8:11], s89 offen offset:0 sc1
    s_waitcnt lgkmcnt(8)
    v_pk_add_f32 v[80:81], v[80:81], v[32:33]
    v_pk_add_f32 v[82:83], v[82:83], v[34:35]
    s_waitcnt lgkmcnt(6)
    v_pk_add_f32 v[36:37], v[36:37], v[40:41]
    v_pk_add_f32 v[38:39], v[38:39], v[42:43]
    v_pk_add_f32 v[80:81], v[80:81], v[36:37]
    v_pk_add_f32 v[82:83], v[82:83], v[38:39]
    v_cvt_pk_bf16_f32 v32, v80, v81
    v_cvt_pk_bf16_f32 v33, v82, v83
    s_waitcnt lgkmcnt(5)
    v_pk_add_f32 v[84:85], v[84:85], v[44:45]
    v_pk_add_f32 v[86:87], v[86:87], v[46:47]
    s_waitcnt lgkmcnt(3)
    v_pk_add_f32 v[48:49], v[48:49], v[52:53]
    v_pk_add_f32 v[50:51], v[50:51], v[54:55]
    v_pk_add_f32 v[84:85], v[84:85], v[48:49]
    v_pk_add_f32 v[86:87], v[86:87], v[50:51]
    v_cvt_pk_bf16_f32 v34, v84, v85
    v_cvt_pk_bf16_f32 v35, v86, v87
    buffer_store_dwordx4 v[32:35], v250, s[8:11], s89 offen offset:64 sc1
    s_waitcnt lgkmcnt(2)
    v_pk_add_f32 v[88:89], v[88:89], v[56:57]
    v_pk_add_f32 v[90:91], v[90:91], v[58:59]
    s_waitcnt lgkmcnt(0)
    v_pk_add_f32 v[60:61], v[60:61], v[64:65]
    v_pk_add_f32 v[62:63], v[62:63], v[66:67]
    v_pk_add_f32 v[88:89], v[88:89], v[60:61]
    v_pk_add_f32 v[90:91], v[90:91], v[62:63]
    v_cvt_pk_bf16_f32 v56, v88, v89
    v_cvt_pk_bf16_f32 v57, v90, v91
    buffer_store_dwordx2 v[56:57], v7, s[8:11], s88 offen offset:128 sc1
    s_cmp_lg_u32 s2, 0
    s_cbranch_scc1 A_ne
    v_mov_b32 v2, s29
    v_mov_b32 v3, 0
    s_mov_b64 exec, 1
    buffer_store_dword v2, v3, s[4:7], 0 offen sc1
    s_mov_b64 exec, -1
A_ne:
END:
    s_endpgm
A_ks:
    s_lshr_b32 s88, s3, 1
    s_sub_u32 s88, s88, s3
    s_lshl_b32 s88, s88, 7
    v_add_u32 v40, s88, v250
    ds_read_b32 v236, v250 offset:0
    ds_read_b32 v237, v250 offset:128
    ds_read_b32 v238, v250 offset:256
    ds_read_b32 v239, v250 offset:384
    ds_read_b32 v240, v250 offset:512
    ds_read_b32 v241, v250 offset:640
    ds_read_b32 v242, v250 offset:768
    ds_read_b32 v243, v250 offset:896
    ds_read_b32 v244, v40 offset:2048
    ds_read_b32 v245, v40 offset:2176
    ds_read_b32 v246, v40 offset:2304
    ds_read_b32 v247, v40 offset:2432
    s_mul_i32 s88, s77, 320
    s_add_u32 s88, s88, 147168
    v_lshrrev_b32 v40, 2, v1
    v_lshl_add_u32 v40, v40, 2, s88
    s_bitcmp1_b32 s77, 0
    s_cselect_b32 s89, 64, 0
    s_cselect_b32 s90, 0, 256
    v_and_b32 v41, 48, v1
    v_add3_u32 v41, v41, v40, s89
    v_add_u32 v40, s90, v40
    ds_read_b32 v46, v41 offset:0
    ds_read_b32 v47, v41 offset:16
    ds_read_b32 v48, v41 offset:128
    ds_read_b32 v49, v41 offset:144
    ds_read_b32 v50, v40
    s_lshr_b32 s88, s28, 1
    s_lshl_b32 s88, s88, 6
    v_and_b32 v40, 48, v252
    v_or_b32 v40, s88, v40
    s_waitcnt lgkmcnt(15)
    v_add_u32 v236, v236, v251
    v_add_u32 v237, v237, v251
    s_waitcnt lgkmcnt(14)
    v_add_u32 v238, v238, v251
    s_waitcnt lgkmcnt(13)
    v_add_u32 v239, v239, v251
    s_waitcnt lgkmcnt(12)
    v_add_u32 v240, v240, v251
    s_waitcnt lgkmcnt(11)
    v_add_u32 v241, v241, v251
    s_waitcnt lgkmcnt(10)
    v_add_u32 v242, v242, v251
    s_waitcnt lgkmcnt(9)
    v_add_u32 v243, v243, v251
    s_waitcnt lgkmcnt(8)
    v_add_u32 v244, v244, v251
    s_waitcnt lgkmcnt(7)
    v_add_u32 v245, v245, v251
    s_waitcnt lgkmcnt(6)
    v_add_u32 v246, v246, v251
    s_waitcnt lgkmcnt(5)
    v_add_u32 v247, v247, v251
    s_waitcnt lgkmcnt(4)
    v_xor_b32 v46, v46, v40
    s_waitcnt lgkmcnt(3)
    v_xor_b32 v47, v47, v40
    s_waitcnt lgkmcnt(2)
    v_xor_b32 v48, v48, v40
    s_waitcnt lgkmcnt(1)
    v_xor_b32 v49, v49, v40
    s_waitcnt lgkmcnt(0)
    v_xor_b32 v50, v50, v40
    v_accvgpr_write_b32 a244, v46
    v_accvgpr_write_b32 a245, v47
    v_accvgpr_write_b32 a246, v48
    v_accvgpr_write_b32 a247, v49
    v_accvgpr_write_b32 a248, v50
    v_and_b32 v40, 3, v1
    v_bfe_u32 v41, v1, 2, 2
    v_lshrrev_b32 v42, 4, v1
    v_mul_u32_u24 v43, 1088, v40
    v_lshl_add_u32 v43, v41, 3, v43
    v_lshl_add_u32 v43, v42, 4, v43
    v_and_b32 v44, 1, v41
    v_mul_u32_u24 v44, 4376, v44
    s_mov_b32 s88, 101376
    v_add3_u32 v201, v43, v44, s88
    v_sub_u32 v43, v40, v41
    v_lshlrev_b32 v43, 3, v43
    v_lshlrev_b32 v44, 6, v42
    v_sub_u32 v43, v43, v44
    s_lshl_b32 s89, s28, 7
    s_add_u32 s88, s89, 110304
    v_add_u32 v202, s88, v43
    v_and_b32 v43, 1, v41
    v_mul_u32_u24 v43, 4160, v43
    v_lshrrev_b32 v44, 3, v1
    v_lshl_add_u32 v43, v44, 4, v43
    v_lshl_add_u32 v43, v40, 2, v43
    s_add_u32 s88, s89, 89088
    v_add_u32 v203, s88, v43
    v_add_u32 v204, 51936, v203
    v_lshlrev_b32 v43, 4, v0
    v_add_u32 v205, 89088, v43
    v_add_u32 v206, 141024, v43
    v_and_b32 v43, 7, v0
    v_cmp_eq_u32 vcc, 0, v43
    v_lshlrev_b32 v43, 2, v0
    s_nop 0
    v_cndmask_b32 v43, 0, v43, vcc
    v_add_u32 v207, 162752, v43
    s_lshl_b32 s88, s28, 5
    s_add_u32 s88, s88, 163040
    v_lshlrev_b32 v43, 2, v1
    v_sub_u32 v44, s88, v43
    v_and_b32 v43, 127, v43
    v_add_u32 v43, 149280, v43
    v_cmp_gt_u32 vcc, 61, v1
    s_nop 1
    v_cndmask_b32 v208, v44, v43, vcc
    s_mov_b32 s96, -1
    s_mov_b32 s97, 0x00ffffff
    s_mul_i32 s33, s28, 896
    s_lshl_b32 s34, s28, 12
    s_add_u32 s34, s34, 88960
    v_add_u32 v250, 32768, v252
    v_add_u32 v251, 65536, v252
    s_mov_b32 s98, 0x00003f80
    s_mov_b32 s99, 0x3f800000
    v_and_b32 v42, 3, v0
    v_and_b32 v43, 60, v0
    v_lshl_add_u32 v42, v42, 6, v43
    s_lshl_b32 s88, s28, 10
    s_add_u32 s88, s88, 110496
    v_add_u32 v42, s88, v42
    s_branch A_kd
A_retry:
    s_sub_u32 s30, s30, 1
    s_cbranch_scc1 A_giveup
    s_mov_b32 s93, 65536
    buffer_load_dwordx4 v[96:99], v197, s[4:7], s81 offen offset:0 sc1
    buffer_load_dwordx4 v[112:115], v197, s[4:7], s93 offen offset:0 sc1
    buffer_load_dwordx4 v[100:103], v197, s[4:7], s81 offen offset:1024 sc1
    buffer_load_dwordx4 v[116:119], v197, s[4:7], s93 offen offset:1024 sc1
    buffer_load_dwordx4 v[104:107], v197, s[4:7], s81 offen offset:2048 sc1
    buffer_load_dwordx4 v[120:123], v197, s[4:7], s93 offen offset:2048 sc1
    buffer_load_dwordx4 v[108:111], v197, s[4:7], s81 offen offset:3072 sc1
    buffer_load_dwordx4 v[124:127], v197, s[4:7], s93 offen offset:3072 sc1
    s_waitcnt vmcnt(0)
    s_branch A_chk
A_giveup:
    s_mov_b32 s30, 0
    s_branch A_ok
C_rt0:
    s_waitcnt lgkmcnt(0)
    s_mov_b32 s96, m0
C_rl0:
    s_sub_u32 s30, s30, 1
    s_cbranch_scc1 C_gv0
    s_add_u32 m0, s34, 0
    s_nop 0
    buffer_load_dwordx4 v252, s[4:7], s44 offen offset:0 sc1 lds
    buffer_load_dwordx4 v252, s[4:7], s44 offen offset:1024 sc1 lds
    buffer_load_dwordx4 v252, s[4:7], s44 offen offset:2048 sc1 lds
    buffer_load_dwordx4 v252, s[4:7], s44 offen offset:3072 sc1 lds
    s_waitcnt vmcnt(0)
    ds_read2st64_b32 v[2:3], v232 offset0:0 offset1:4
    ds_read2st64_b32 v[4:5], v232 offset0:8 offset1:12
    s_waitcnt lgkmcnt(0)
    v_max3_u32 v2, v2, v3, v4
    v_max_u32 v2, v2, v5
    v_cmp_eq_u32 vcc, -1, v2
    s_cbranch_vccnz C_rl0
    ds_read_b64_tr_b16 a[44:45], v224 offset:0
    ds_read_b64_tr_b16 a[46:47], v224 offset:2048
    ds_read_b64_tr_b16 a[48:49], v225 offset:0
    ds_read_b64_tr_b16 a[50:51], v225 offset:2048
    ds_read_b64_tr_b16 a[52:53], v226 offset:0
    ds_read_b64_tr_b16 a[54:55], v226 offset:2048
    ds_read_b64_tr_b16 a[56:57], v227 offset:0
    ds_read_b64_tr_b16 a[58:59], v227 offset:2048
    s_mov_b32 m0, s96
    s_waitcnt lgkmcnt(0)
    s_branch C_ok0
C_gv0:
    s_mov_b32 m0, s96
    s_mov_b32 s30, 0
    s_branch C_ok0
C_rt1:
    s_waitcnt lgkmcnt(0)
    s_mov_b32 s96, m0
C_rl1:
    s_sub_u32 s30, s30, 1
    s_cbranch_scc1 C_gv1
    s_add_u32 m0, s34, 16384
    s_nop 0
    buffer_load_dwordx4 v252, s[4:7], s45 offen offset:0 sc1 lds
    buffer_load_dwordx4 v252, s[4:7], s45 offen offset:1024 sc1 lds
    buffer_load_dwordx4 v252, s[4:7], s45 offen offset:2048 sc1 lds
    buffer_load_dwordx4 v252, s[4:7], s45 offen offset:3072 sc1 lds
    s_waitcnt vmcnt(0)
    ds_read2st64_b32 v[2:3], v232 offset0:64 offset1:68
    ds_read2st64_b32 v[4:5], v232 offset0:72 offset1:76
    s_waitcnt lgkmcnt(0)
    v_max3_u32 v2, v2, v3, v4
    v_max_u32 v2, v2, v5
    v_cmp_eq_u32 vcc, -1, v2
    s_cbranch_vccnz C_rl1
    ds_read_b64_tr_b16 a[104:105], v224 offset:16384
    ds_read_b64_tr_b16 a[106:107], v224 offset:18432
    ds_read_b64_tr_b16 a[108:109], v225 offset:16384
    ds_read_b64_tr_b16 a[110:111], v225 offset:18432
    ds_read_b64_tr_b16 a[112:113], v226 offset:16384
    ds_read_b64_tr_b16 a[114:115], v226 offset:18432
    ds_read_b64_tr_b16 a[116:117], v227 offset:16384
    ds_read_b64_tr_b16 a[118:119], v227 offset:18432
    s_mov_b32 m0, s96
    s_waitcnt lgkmcnt(0)
    s_branch C_ok1
C_gv1:
    s_mov_b32 m0, s96
    s_mov_b32 s30, 0
    s_branch C_ok1
C_rt2:
    s_waitcnt lgkmcnt(0)
    s_mov_b32 s96, m0
C_rl2:
    s_sub_u32 s30, s30, 1
    s_cbranch_scc1 C_gv2
    s_add_u32 m0, s34, 32768
    s_nop 0
    buffer_load_dwordx4 v252, s[4:7], s46 offen offset:0 sc1 lds
    buffer_load_dwordx4 v252, s[4:7], s46 offen offset:1024 sc1 lds
    buffer_load_dwordx4 v252, s[4:7], s46 offen offset:2048 sc1 lds
    buffer_load_dwordx4 v252, s[4:7], s46 offen offset:3072 sc1 lds
    s_waitcnt vmcnt(0)
    ds_read2st64_b32 v[2:3], v232 offset0:128 offset1:132
    ds_read2st64_b32 v[4:5], v232 offset0:136 offset1:140
    s_waitcnt lgkmcnt(0)
    v_max3_u32 v2, v2, v3, v4
    v_max_u32 v2, v2, v5
    v_cmp_eq_u32 vcc, -1, v2
    s_cbranch_vccnz C_rl2
    ds_read_b64_tr_b16 a[44:45], v224 offset:32768
    ds_read_b64_tr_b16 a[46:47], v224 offset:34816
    ds_read_b64_tr_b16 a[48:49], v225 offset:32768
    ds_read_b64_tr_b16 a[50:51], v225 offset:34816
    ds_read_b64_tr_b16 a[52:53], v226 offset:32768
    ds_read_b64_tr_b16 a[54:55], v226 offset:34816
    ds_read_b64_tr_b16 a[56:57], v227 offset:32768
    ds_read_b64_tr_b16 a[58:59], v227 offset:34816
    s_mov_b32 m0, s96
    s_waitcnt lgkmcnt(0)
    s_branch C_ok2
C_gv2:
    s_mov_b32 m0, s96
    s_mov_b32 s30, 0
    s_branch C_ok2
C_rt3:
    s_waitcnt lgkmcnt(0)
    s_mov_b32 s96, m0
C_rl3:
    s_sub_u32 s30, s30, 1
    s_cbranch_scc1 C_gv3
    s_add_u32 m0, s34, 49152
    s_nop 0
    buffer_load_dwordx4 v252, s[4:7], s47 offen offset:0 sc1 lds
    buffer_load_dwordx4 v252, s[4:7], s47 offen offset:1024 sc1 lds
    buffer_load_dwordx4 v252, s[4:7], s47 offen offset:2048 sc1 lds
    buffer_load_dwordx4 v252, s[4:7], s47 offen offset:3072 sc1 lds
    s_waitcnt vmcnt(0)
    ds_read2st64_b32 v[2:3], v232 offset0:192 offset1:196
    ds_read2st64_b32 v[4:5], v232 offset0:200 offset1:204
    s_waitcnt lgkmcnt(0)
    v_max3_u32 v2, v2, v3, v4
    v_max_u32 v2, v2, v5
    v_cmp_eq_u32 vcc, -1, v2
    s_cbranch_vccnz C_rl3
    ds_read_b64_tr_b16 a[104:105], v224 offset:49152
    ds_read_b64_tr_b16 a[106:107], v224 offset:51200
    ds_read_b64_tr_b16 a[108:109], v225 offset:49152
    ds_read_b64_tr_b16 a[110:111], v225 offset:51200
    ds_read_b64_tr_b16 a[112:113], v226 offset:49152
    ds_read_b64_tr_b16 a[114:115], v226 offset:51200
    ds_read_b64_tr_b16 a[116:117], v227 offset:49152
    ds_read_b64_tr_b16 a[118:119], v227 offset:51200
    s_mov_b32 m0, s96
    s_waitcnt lgkmcnt(0)
    s_branch C_ok3
C_gv3:
    s_mov_b32 m0, s96
    s_mov_b32 s30, 0
    s_branch C_ok3
C_rt4:
    s_waitcnt lgkmcnt(0)
    s_mov_b32 s96, m0
C_rl4:
    s_sub_u32 s30, s30, 1
    s_cbranch_scc1 C_gv4
    s_add_u32 m0, s34, 0
    s_nop 0
    buffer_load_dwordx4 v252, s[4:7], s48 offen offset:0 sc1 lds
    buffer_load_dwordx4 v252, s[4:7], s48 offen offset:1024 sc1 lds
    buffer_load_dwordx4 v252, s[4:7], s48 offen offset:2048 sc1 lds
    buffer_load_dwordx4 v252, s[4:7], s48 offen offset:3072 sc1 lds
    s_waitcnt vmcnt(0)
    ds_read2st64_b32 v[2:3], v232 offset0:0 offset1:4
    ds_read2st64_b32 v[4:5], v232 offset0:8 offset1:12
    s_waitcnt lgkmcnt(0)
    v_max3_u32 v2, v2, v3, v4
    v_max_u32 v2, v2, v5
    v_cmp_eq_u32 vcc, -1, v2
    s_cbranch_vccnz C_rl4
    ds_read_b64_tr_b16 a[44:45], v224 offset:0
    ds_read_b64_tr_b16 a[46:47], v224 offset:2048
    ds_read_b64_tr_b16 a[48:49], v225 offset:0
    ds_read_b64_tr_b16 a[50:51], v225 offset:2048
    ds_read_b64_tr_b16 a[52:53], v226 offset:0
    ds_read_b64_tr_b16 a[54:55], v226 offset:2048
    ds_read_b64_tr_b16 a[56:57], v227 offset:0
    ds_read_b64_tr_b16 a[58:59], v227 offset:2048
    s_mov_b32 m0, s96
    s_waitcnt lgkmcnt(0)
    s_branch C_ok4
C_gv4:
    s_mov_b32 m0, s96
    s_mov_b32 s30, 0
    s_branch C_ok4
C_rt5:
    s_waitcnt lgkmcnt(0)
    s_mov_b32 s96, m0
C_rl5:
    s_sub_u32 s30, s30, 1
    s_cbranch_scc1 C_gv5
    s_add_u32 m0, s34, 16384
    s_nop 0
    buffer_load_dwordx4 v252, s[4:7], s49 offen offset:0 sc1 lds
    buffer_load_dwordx4 v252, s[4:7], s49 offen offset:1024 sc1 lds
    buffer_load_dwordx4 v252, s[4:7], s49 offen offset:2048 sc1 lds
    buffer_load_dwordx4 v252, s[4:7], s49 offen offset:3072 sc1 lds
    s_waitcnt vmcnt(0)
    ds_read2st64_b32 v[2:3], v232 offset0:64 offset1:68
    ds_read2st64_b32 v[4:5], v232 offset0:72 offset1:76
    s_waitcnt lgkmcnt(0)
    v_max3_u32 v2, v2, v3, v4
    v_max_u32 v2, v2, v5
    v_cmp_eq_u32 vcc, -1, v2
    s_cbranch_vccnz C_rl5
    ds_read_b64_tr_b16 a[104:105], v224 offset:16384
    ds_read_b64_tr_b16 a[106:107], v224 offset:18432
    ds_read_b64_tr_b16 a[108:109], v225 offset:16384
    ds_read_b64_tr_b16 a[110:111], v225 offset:18432
    ds_read_b64_tr_b16 a[112:113], v226 offset:16384
    ds_read_b64_tr_b16 a[114:115], v226 offset:18432
    ds_read_b64_tr_b16 a[116:117], v227 offset:16384
    ds_read_b64_tr_b16 a[118:119], v227 offset:18432
    s_mov_b32 m0, s96
    s_waitcnt lgkmcnt(0)
    s_branch C_ok5
C_gv5:
    s_mov_b32 m0, s96
    s_mov_b32 s30, 0
    s_branch C_ok5
C_rt6:
    s_waitcnt lgkmcnt(0)
    s_mov_b32 s96, m0
C_rl6:
    s_sub_u32 s30, s30, 1
    s_cbranch_scc1 C_gv6
    s_add_u32 m0, s34, 32768
    s_nop 0
    buffer_load_dwordx4 v252, s[4:7], s50 offen offset:0 sc1 lds
    buffer_load_dwordx4 v252, s[4:7], s50 offen offset:1024 sc1 lds
    buffer_load_dwordx4 v252, s[4:7], s50 offen offset:2048 sc1 lds
    buffer_load_dwordx4 v252, s[4:7], s50 offen offset:3072 sc1 lds
    s_waitcnt vmcnt(0)
    ds_read2st64_b32 v[2:3], v232 offset0:128 offset1:132
    ds_read2st64_b32 v[4:5], v232 offset0:136 offset1:140
    s_waitcnt lgkmcnt(0)
    v_max3_u32 v2, v2, v3, v4
    v_max_u32 v2, v2, v5
    v_cmp_eq_u32 vcc, -1, v2
    s_cbranch_vccnz C_rl6
    ds_read_b64_tr_b16 a[44:45], v224 offset:32768
    ds_read_b64_tr_b16 a[46:47], v224 offset:34816
    ds_read_b64_tr_b16 a[48:49], v225 offset:32768
    ds_read_b64_tr_b16 a[50:51], v225 offset:34816
    ds_read_b64_tr_b16 a[52:53], v226 offset:32768
    ds_read_b64_tr_b16 a[54:55], v226 offset:34816
    ds_read_b64_tr_b16 a[56:57], v227 offset:32768
    ds_read_b64_tr_b16 a[58:59], v227 offset:34816
    s_mov_b32 m0, s96
    s_waitcnt lgkmcnt(0)
    s_branch C_ok6
C_gv6:
    s_mov_b32 m0, s96
    s_mov_b32 s30, 0
    s_branch C_ok6
C_rt7:
    s_waitcnt lgkmcnt(0)
    s_mov_b32 s96, m0
C_rl7:
    s_sub_u32 s30, s30, 1
    s_cbranch_scc1 C_gv7
    s_add_u32 m0, s34, 49152
    s_nop 0
    buffer_load_dwordx4 v252, s[4:7], s51 offen offset:0 sc1 lds
    buffer_load_dwordx4 v252, s[4:7], s51 offen offset:1024 sc1 lds
    buffer_load_dwordx4 v252, s[4:7], s51 offen offset:2048 sc1 lds
    buffer_load_dwordx4 v252, s[4:7], s51 offen offset:3072 sc1 lds
    s_waitcnt vmcnt(0)
    ds_read2st64_b32 v[2:3], v232 offset0:192 offset1:196
    ds_read2st64_b32 v[4:5], v232 offset0:200 offset1:204
    s_waitcnt lgkmcnt(0)
    v_max3_u32 v2, v2, v3, v4
    v_max_u32 v2, v2, v5
    v_cmp_eq_u32 vcc, -1, v2
    s_cbranch_vccnz C_rl7
    ds_read_b64_tr_b16 a[104:105], v224 offset:49152
    ds_read_b64_tr_b16 a[106:107], v224 offset:51200
    ds_read_b64_tr_b16 a[108:109], v225 offset:49152
    ds_read_b64_tr_b16 a[110:111], v225 offset:51200
    ds_read_b64_tr_b16 a[112:113], v226 offset:49152
    ds_read_b64_tr_b16 a[114:115], v226 offset:51200
    ds_read_b64_tr_b16 a[116:117], v227 offset:49152
    ds_read_b64_tr_b16 a[118:119], v227 offset:51200
    s_mov_b32 m0, s96
    s_waitcnt lgkmcnt(0)
    s_branch C_ok7
C_gv7:
    s_mov_b32 m0, s96
    s_mov_b32 s30, 0
    s_branch C_ok7
C_rt8:
    s_waitcnt lgkmcnt(0)
    s_mov_b32 s96, m0
C_rl8:
    s_sub_u32 s30, s30, 1
    s_cbranch_scc1 C_gv8
    s_add_u32 m0, s34, 0
    s_nop 0
    buffer_load_dwordx4 v250, s[4:7], s44 offen offset:0 sc1 lds
    buffer_load_dwordx4 v250, s[4:7], s44 offen offset:1024 sc1 lds
    buffer_load_dwordx4 v250, s[4:7], s44 offen offset:2048 sc1 lds
    buffer_load_dwordx4 v250, s[4:7], s44 offen offset:3072 sc1 lds
    s_waitcnt vmcnt(0)
    ds_read2st64_b32 v[2:3], v232 offset0:0 offset1:4
    ds_read2st64_b32 v[4:5], v232 offset0:8 offset1:12
    s_waitcnt lgkmcnt(0)
    v_max3_u32 v2, v2, v3, v4
    v_max_u32 v2, v2, v5
    v_cmp_eq_u32 vcc, -1, v2
    s_cbranch_vccnz C_rl8
    ds_read_b64_tr_b16 a[44:45], v224 offset:0
    ds_read_b64_tr_b16 a[46:47], v224 offset:2048
    ds_read_b64_tr_b16 a[48:49], v225 offset:0
    ds_read_b64_tr_b16 a[50:51], v225 offset:2048
    ds_read_b64_tr_b16 a[52:53], v226 offset:0
    ds_read_b64_tr_b16 a[54:55], v226 offset:2048
    ds_read_b64_tr_b16 a[56:57], v227 offset:0
    ds_read_b64_tr_b16 a[58:59], v227 offset:2048
    s_mov_b32 m0, s96
    s_waitcnt lgkmcnt(0)
    s_branch C_ok8
C_gv8:
    s_mov_b32 m0, s96
    s_mov_b32 s30, 0
    s_branch C_ok8
C_rt9:
    s_waitcnt lgkmcnt(0)
    s_mov_b32 s96, m0
C_rl9:
    s_sub_u32 s30, s30, 1
    s_cbranch_scc1 C_gv9
    s_add_u32 m0, s34, 16384
    s_nop 0
    buffer_load_dwordx4 v251, s[4:7], s52 offen offset:0 sc1 lds
    buffer_load_dwordx4 v251, s[4:7], s52 offen offset:1024 sc1 lds
    buffer_load_dwordx4 v251, s[4:7], s52 offen offset:2048 sc1 lds
    buffer_load_dwordx4 v251, s[4:7], s52 offen offset:3072 sc1 lds
    s_waitcnt vmcnt(0)
    ds_read2st64_b32 v[2:3], v232 offset0:64 offset1:68
    ds_read2st64_b32 v[4:5], v232 offset0:72 offset1:76
    s_waitcnt lgkmcnt(0)
    v_max3_u32 v2, v2, v3, v4
    v_max_u32 v2, v2, v5
    v_cmp_eq_u32 vcc, -1, v2
    s_cbranch_vccnz C_rl9
    ds_read_b64_tr_b16 a[104:105], v224 offset:16384
    ds_read_b64_tr_b16 a[106:107], v224 offset:18432
    ds_read_b64_tr_b16 a[108:109], v225 offset:16384
    ds_read_b64_tr_b16 a[110:111], v225 offset:18432
    ds_read_b64_tr_b16 a[112:113], v226 offset:16384
    ds_read_b64_tr_b16 a[114:115], v226 offset:18432
    ds_read_b64_tr_b16 a[116:117], v227 offset:16384
    ds_read_b64_tr_b16 a[118:119], v227 offset:18432
    s_mov_b32 m0, s96
    s_waitcnt lgkmcnt(0)
    s_branch C_ok9
C_gv9:
    s_mov_b32 m0, s96
    s_mov_b32 s30, 0
    s_branch C_ok9
C_rt10:
    s_waitcnt lgkmcnt(0)
    s_mov_b32 s96, m0
C_rl10:
    s_sub_u32 s30, s30, 1
    s_cbranch_scc1 C_gv10
    s_add_u32 m0, s34, 32768
    s_nop 0
    buffer_load_dwordx4 v250, s[4:7], s45 offen offset:0 sc1 lds
    buffer_load_dwordx4 v250, s[4:7], s45 offen offset:1024 sc1 lds
    buffer_load_dwordx4 v250, s[4:7], s45 offen offset:2048 sc1 lds
    buffer_load_dwordx4 v250, s[4:7], s45 offen offset:3072 sc1 lds
    s_waitcnt vmcnt(0)
    ds_read2st64_b32 v[2:3], v232 offset0:128 offset1:132
    ds_read2st64_b32 v[4:5], v232 offset0:136 offset1:140
    s_waitcnt lgkmcnt(0)
    v_max3_u32 v2, v2, v3, v4
    v_max_u32 v2, v2, v5
    v_cmp_eq_u32 vcc, -1, v2
    s_cbranch_vccnz C_rl10
    ds_read_b64_tr_b16 a[44:45], v224 offset:32768
    ds_read_b64_tr_b16 a[46:47], v224 offset:34816
    ds_read_b64_tr_b16 a[48:49], v225 offset:32768
    ds_read_b64_tr_b16 a[50:51], v225 offset:34816
    ds_read_b64_tr_b16 a[52:53], v226 offset:32768
    ds_read_b64_tr_b16 a[54:55], v226 offset:34816
    ds_read_b64_tr_b16 a[56:57], v227 offset:32768
    ds_read_b64_tr_b16 a[58:59], v227 offset:34816
    s_mov_b32 m0, s96
    s_waitcnt lgkmcnt(0)
    s_branch C_ok10
C_gv10:
    s_mov_b32 m0, s96
    s_mov_b32 s30, 0
    s_branch C_ok10
C_rt11:
    s_waitcnt lgkmcnt(0)
    s_mov_b32 s96, m0
C_rl11:
    s_sub_u32 s30, s30, 1
    s_cbranch_scc1 C_gv11
    s_add_u32 m0, s34, 49152
    s_nop 0
    buffer_load_dwordx4 v250, s[4:7], s46 offen offset:0 sc1 lds
    buffer_load_dwordx4 v250, s[4:7], s46 offen offset:1024 sc1 lds
    buffer_load_dwordx4 v250, s[4:7], s46 offen offset:2048 sc1 lds
    buffer_load_dwordx4 v250, s[4:7], s46 offen offset:3072 sc1 lds
    s_waitcnt vmcnt(0)
    ds_read2st64_b32 v[2:3], v232 offset0:192 offset1:196
    ds_read2st64_b32 v[4:5], v232 offset0:200 offset1:204
    s_waitcnt lgkmcnt(0)
    v_max3_u32 v2, v2, v3, v4
    v_max_u32 v2, v2, v5
    v_cmp_eq_u32 vcc, -1, v2
    s_cbranch_vccnz C_rl11
    ds_read_b64_tr_b16 a[104:105], v224 offset:49152
    ds_read_b64_tr_b16 a[106:107], v224 offset:51200
    ds_read_b64_tr_b16 a[108:109], v225 offset:49152
    ds_read_b64_tr_b16 a[110:111], v225 offset:51200
    ds_read_b64_tr_b16 a[112:113], v226 offset:49152
    ds_read_b64_tr_b16 a[114:115], v226 offset:51200
    ds_read_b64_tr_b16 a[116:117], v227 offset:49152
    ds_read_b64_tr_b16 a[118:119], v227 offset:51200
    s_mov_b32 m0, s96
    s_waitcnt lgkmcnt(0)
    s_branch C_ok11
C_gv11:
    s_mov_b32 m0, s96
    s_mov_b32 s30, 0
    s_branch C_ok11
C_rt12:
    s_waitcnt lgkmcnt(0)
    s_mov_b32 s96, m0
C_rl12:
    s_sub_u32 s30, s30, 1
    s_cbranch_scc1 C_gv12
    s_add_u32 m0, s34, 0
    s_nop 0
    buffer_load_dwordx4 v250, s[4:7], s47 offen offset:0 sc1 lds
    buffer_load_dwordx4 v250, s[4:7], s47 offen offset:1024 sc1 lds
    buffer_load_dwordx4 v250, s[4:7], s47 offen offset:2048 sc1 lds
    buffer_load_dwordx4 v250, s[4:7], s47 offen offset:3072 sc1 lds
    s_waitcnt vmcnt(0)
    ds_read2st64_b32 v[2:3], v232 offset0:0 offset1:4
    ds_read2st64_b32 v[4:5], v232 offset0:8 offset1:12
    s_waitcnt lgkmcnt(0)
    v_max3_u32 v2, v2, v3, v4
    v_max_u32 v2, v2, v5
    v_cmp_eq_u32 vcc, -1, v2
    s_cbranch_vccnz C_rl12
    ds_read_b64_tr_b16 a[44:45], v224 offset:0
    ds_read_b64_tr_b16 a[46:47], v224 offset:2048
    ds_read_b64_tr_b16 a[48:49], v225 offset:0
    ds_read_b64_tr_b16 a[50:51], v225 offset:2048
    ds_read_b64_tr_b16 a[52:53], v226 offset:0
    ds_read_b64_tr_b16 a[54:55], v226 offset:2048
    ds_read_b64_tr_b16 a[56:57], v227 offset:0
    ds_read_b64_tr_b16 a[58:59], v227 offset:2048
    s_mov_b32 m0, s96
    s_waitcnt lgkmcnt(0)
    s_branch C_ok12
C_gv12:
    s_mov_b32 m0, s96
    s_mov_b32 s30, 0
    s_branch C_ok12
C_cs_rt:
    s_sub_u32 s30, s30, 1
    s_cbranch_scc1 C_cs_gv
    s_mov_b32 s97, m0
    s_mov_b32 m0, s91
    s_nop 0
    buffer_load_dwordx4 v221, s[4:7], s57 offen sc1 lds
    s_waitcnt vmcnt(0)
    s_mov_b32 m0, s97
    ds_read_b128 v[120:123], v7 offset:0
    ds_read_b128 v[124:127], v7 offset:256
    ds_read_b128 v[128:131], v7 offset:64
    ds_read_b128 v[132:135], v7 offset:320
    ds_read_b128 v[136:139], v7 offset:128
    ds_read_b128 v[140:143], v7 offset:384
    ds_read_b128 v[144:147], v192 offset:192
    ds_read_b128 v[148:151], v192 offset:448
    s_waitcnt lgkmcnt(5)
    v_max3_u32 v193, v120, v124, v128
    s_waitcnt lgkmcnt(3)
    v_max3_u32 v193, v193, v132, v136
    s_waitcnt lgkmcnt(1)
    v_max3_u32 v193, v193, v140, v144
    s_waitcnt lgkmcnt(0)
    v_max_u32 v193, v193, v148
    v_cmp_eq_u32 vcc, -1, v193
    s_cbranch_vccnz C_cs_rt
    s_branch C_cs_ok
C_cs_gv:
    s_mov_b32 s30, 0
    s_branch C_cs_ok
C_rt13:
    s_waitcnt lgkmcnt(0)
    s_mov_b32 s96, m0
C_rl13:
    s_sub_u32 s30, s30, 1
    s_cbranch_scc1 C_gv13
    s_add_u32 m0, s34, 16384
    s_nop 0
    buffer_load_dwordx4 v250, s[4:7], s48 offen offset:0 sc1 lds
    buffer_load_dwordx4 v250, s[4:7], s48 offen offset:1024 sc1 lds
    buffer_load_dwordx4 v250, s[4:7], s48 offen offset:2048 sc1 lds
    buffer_load_dwordx4 v250, s[4:7], s48 offen offset:3072 sc1 lds
    s_waitcnt vmcnt(0)
    ds_read2st64_b32 v[2:3], v232 offset0:64 offset1:68
    ds_read2st64_b32 v[4:5], v232 offset0:72 offset1:76
    s_waitcnt lgkmcnt(0)
    v_max3_u32 v2, v2, v3, v4
    v_max_u32 v2, v2, v5
    v_cmp_eq_u32 vcc, -1, v2
    s_cbranch_vccnz C_rl13
    ds_read_b64_tr_b16 a[104:105], v224 offset:16384
    ds_read_b64_tr_b16 a[106:107], v224 offset:18432
    ds_read_b64_tr_b16 a[108:109], v225 offset:16384
    ds_read_b64_tr_b16 a[110:111], v225 offset:18432
    ds_read_b64_tr_b16 a[112:113], v226 offset:16384
    ds_read_b64_tr_b16 a[114:115], v226 offset:18432
    ds_read_b64_tr_b16 a[116:117], v227 offset:16384
    ds_read_b64_tr_b16 a[118:119], v227 offset:18432
    s_mov_b32 m0, s96
    s_waitcnt lgkmcnt(0)
    s_branch C_ok13
C_gv13:
    s_mov_b32 m0, s96
    s_mov_b32 s30, 0
    s_branch C_ok13
C_rt14:
    s_waitcnt lgkmcnt(0)
    s_mov_b32 s96, m0
C_rl14:
    s_sub_u32 s30, s30, 1
    s_cbranch_scc1 C_gv14
    s_add_u32 m0, s34, 32768
    s_nop 0
    buffer_load_dwordx4 v250, s[4:7], s49 offen offset:0 sc1 lds
    buffer_load_dwordx4 v250, s[4:7], s49 offen offset:1024 sc1 lds
    buffer_load_dwordx4 v250, s[4:7], s49 offen offset:2048 sc1 lds
    buffer_load_dwordx4 v250, s[4:7], s49 offen offset:3072 sc1 lds
    s_waitcnt vmcnt(0)
    ds_read2st64_b32 v[2:3], v232 offset0:128 offset1:132
    ds_read2st64_b32 v[4:5], v232 offset0:136 offset1:140
    s_waitcnt lgkmcnt(0)
    v_max3_u32 v2, v2, v3, v4
    v_max_u32 v2, v2, v5
    v_cmp_eq_u32 vcc, -1, v2
    s_cbranch_vccnz C_rl14
    ds_read_b64_tr_b16 a[44:45], v224 offset:32768
    ds_read_b64_tr_b16 a[46:47], v224 offset:34816
    ds_read_b64_tr_b16 a[48:49], v225 offset:32768
    ds_read_b64_tr_b16 a[50:51], v225 offset:34816
    ds_read_b64_tr_b16 a[52:53], v226 offset:32768
    ds_read_b64_tr_b16 a[54:55], v226 offset:34816
    ds_read_b64_tr_b16 a[56:57], v227 offset:32768
    ds_read_b64_tr_b16 a[58:59], v227 offset:34816
    s_mov_b32 m0, s96
    s_waitcnt lgkmcnt(0)
    s_branch C_ok14
C_gv14:
    s_mov_b32 m0, s96
    s_mov_b32 s30, 0
    s_branch C_ok14
C_rt15:
    s_waitcnt lgkmcnt(0)
    s_mov_b32 s96, m0
C_rl15:
    s_sub_u32 s30, s30, 1
    s_cbranch_scc1 C_gv15
    s_add_u32 m0, s34, 49152
    s_nop 0
    buffer_load_dwordx4 v250, s[4:7], s50 offen offset:0 sc1 lds
    buffer_load_dwordx4 v250, s[4:7], s50 offen offset:1024 sc1 lds
    buffer_load_dwordx4 v250, s[4:7], s50 offen offset:2048 sc1 lds
    buffer_load_dwordx4 v250, s[4:7], s50 offen offset:3072 sc1 lds
    s_waitcnt vmcnt(0)
    ds_read2st64_b32 v[2:3], v232 offset0:192 offset1:196
    ds_read2st64_b32 v[4:5], v232 offset0:200 offset1:204
    s_waitcnt lgkmcnt(0)
    v_max3_u32 v2, v2, v3, v4
    v_max_u32 v2, v2, v5
    v_cmp_eq_u32 vcc, -1, v2
    s_cbranch_vccnz C_rl15
    ds_read_b64_tr_b16 a[104:105], v224 offset:49152
    ds_read_b64_tr_b16 a[106:107], v224 offset:51200
    ds_read_b64_tr_b16 a[108:109], v225 offset:49152
    ds_read_b64_tr_b16 a[110:111], v225 offset:51200
    ds_read_b64_tr_b16 a[112:113], v226 offset:49152
    ds_read_b64_tr_b16 a[114:115], v226 offset:51200
    ds_read_b64_tr_b16 a[116:117], v227 offset:49152
    ds_read_b64_tr_b16 a[118:119], v227 offset:51200
    s_mov_b32 m0, s96
    s_waitcnt lgkmcnt(0)
    s_branch C_ok15
C_gv15:
    s_mov_b32 m0, s96
    s_mov_b32 s30, 0
    s_branch C_ok15
C_rt16:
    s_waitcnt lgkmcnt(0)
    s_mov_b32 s96, m0
C_rl16:
    s_sub_u32 s30, s30, 1
    s_cbranch_scc1 C_gv16
    s_add_u32 m0, s34, 0
    s_nop 0
    buffer_load_dwordx4 v250, s[4:7], s51 offen offset:0 sc1 lds
    buffer_load_dwordx4 v250, s[4:7], s51 offen offset:1024 sc1 lds
    buffer_load_dwordx4 v250, s[4:7], s51 offen offset:2048 sc1 lds
    buffer_load_dwordx4 v250, s[4:7], s51 offen offset:3072 sc1 lds
    s_waitcnt vmcnt(0)
    ds_read2st64_b32 v[2:3], v232 offset0:0 offset1:4
    ds_read2st64_b32 v[4:5], v232 offset0:8 offset1:12
    s_waitcnt lgkmcnt(0)
    v_max3_u32 v2, v2, v3, v4
    v_max_u32 v2, v2, v5
    v_cmp_eq_u32 vcc, -1, v2
    s_cbranch_vccnz C_rl16
    ds_read_b64_tr_b16 a[44:45], v224 offset:0
    ds_read_b64_tr_b16 a[46:47], v224 offset:2048
    ds_read_b64_tr_b16 a[48:49], v225 offset:0
    ds_read_b64_tr_b16 a[50:51], v225 offset:2048
    ds_read_b64_tr_b16 a[52:53], v226 offset:0
    ds_read_b64_tr_b16 a[54:55], v226 offset:2048
    ds_read_b64_tr_b16 a[56:57], v227 offset:0
    ds_read_b64_tr_b16 a[58:59], v227 offset:2048
    s_mov_b32 m0, s96
    s_waitcnt lgkmcnt(0)
    s_branch C_ok16
C_gv16:
    s_mov_b32 m0, s96
    s_mov_b32 s30, 0
    s_branch C_ok16
C_rt17:
    s_waitcnt lgkmcnt(0)
    s_mov_b32 s96, m0
C_rl17:
    s_sub_u32 s30, s30, 1
    s_cbranch_scc1 C_gv17
    s_add_u32 m0, s34, 16384
    s_nop 0
    buffer_load_dwordx4 v251, s[4:7], s53 offen offset:0 sc1 lds
    buffer_load_dwordx4 v251, s[4:7], s53 offen offset:1024 sc1 lds
    buffer_load_dwordx4 v251, s[4:7], s53 offen offset:2048 sc1 lds
    buffer_load_dwordx4 v251, s[4:7], s53 offen offset:3072 sc1 lds
    s_waitcnt vmcnt(0)
    ds_read2st64_b32 v[2:3], v232 offset0:64 offset1:68
    ds_read2st64_b32 v[4:5], v232 offset0:72 offset1:76
    s_waitcnt lgkmcnt(0)
    v_max3_u32 v2, v2, v3, v4
    v_max_u32 v2, v2, v5
    v_cmp_eq_u32 vcc, -1, v2
    s_cbranch_vccnz C_rl17
    ds_read_b64_tr_b16 a[104:105], v224 offset:16384
    ds_read_b64_tr_b16 a[106:107], v224 offset:18432
    ds_read_b64_tr_b16 a[108:109], v225 offset:16384
    ds_read_b64_tr_b16 a[110:111], v225 offset:18432
    ds_read_b64_tr_b16 a[112:113], v226 offset:16384
    ds_read_b64_tr_b16 a[114:115], v226 offset:18432
    ds_read_b64_tr_b16 a[116:117], v227 offset:16384
    ds_read_b64_tr_b16 a[118:119], v227 offset:18432
    s_mov_b32 m0, s96
    s_waitcnt lgkmcnt(0)
    s_branch C_ok17
C_gv17:
    s_mov_b32 m0, s96
    s_mov_b32 s30, 0
    s_branch C_ok17
C_rt18:
    s_waitcnt lgkmcnt(0)
    s_mov_b32 s96, m0
C_rl18:
    s_sub_u32 s30, s30, 1
    s_cbranch_scc1 C_gv18
    s_add_u32 m0, s34, 32768
    s_nop 0
    buffer_load_dwordx4 v251, s[4:7], s54 offen offset:0 sc1 lds
    buffer_load_dwordx4 v251, s[4:7], s54 offen offset:1024 sc1 lds
    buffer_load_dwordx4 v251, s[4:7], s54 offen offset:2048 sc1 lds
    buffer_load_dwordx4 v251, s[4:7], s54 offen offset:3072 sc1 lds
    s_waitcnt vmcnt(0)
    ds_read2st64_b32 v[2:3], v232 offset0:128 offset1:132
    ds_read2st64_b32 v[4:5], v232 offset0:136 offset1:140
    s_waitcnt lgkmcnt(0)
    v_max3_u32 v2, v2, v3, v4
    v_max_u32 v2, v2, v5
    v_cmp_eq_u32 vcc, -1, v2
    s_cbranch_vccnz C_rl18
    ds_read_b64_tr_b16 a[44:45], v224 offset:32768
    ds_read_b64_tr_b16 a[46:47], v224 offset:34816
    ds_read_b64_tr_b16 a[48:49], v225 offset:32768
    ds_read_b64_tr_b16 a[50:51], v225 offset:34816
    ds_read_b64_tr_b16 a[52:53], v226 offset:32768
    ds_read_b64_tr_b16 a[54:55], v226 offset:34816
    ds_read_b64_tr_b16 a[56:57], v227 offset:32768
    ds_read_b64_tr_b16 a[58:59], v227 offset:34816
    s_mov_b32 m0, s96
    s_waitcnt lgkmcnt(0)
    s_branch C_ok18
C_gv18:
    s_mov_b32 m0, s96
    s_mov_b32 s30, 0
    s_branch C_ok18
C_rt19:
    s_waitcnt lgkmcnt(0)
    s_mov_b32 s96, m0
C_rl19:
    s_sub_u32 s30, s30, 1
    s_cbranch_scc1 C_gv19
    s_add_u32 m0, s34, 49152
    s_nop 0
    buffer_load_dwordx4 v251, s[4:7], s55 offen offset:0 sc1 lds
    buffer_load_dwordx4 v251, s[4:7], s55 offen offset:1024 sc1 lds
    buffer_load_dwordx4 v251, s[4:7], s55 offen offset:2048 sc1 lds
    buffer_load_dwordx4 v251, s[4:7], s55 offen offset:3072 sc1 lds
    s_waitcnt vmcnt(0)
    ds_read2st64_b32 v[2:3], v232 offset0:192 offset1:196
    ds_read2st64_b32 v[4:5], v232 offset0:200 offset1:204
    s_waitcnt lgkmcnt(0)
    v_max3_u32 v2, v2, v3, v4
    v_max_u32 v2, v2, v5
    v_cmp_eq_u32 vcc, -1, v2
    s_cbranch_vccnz C_rl19
    ds_read_b64_tr_b16 a[104:105], v224 offset:49152
    ds_read_b64_tr_b16 a[106:107], v224 offset:51200
    ds_read_b64_tr_b16 a[108:109], v225 offset:49152
    ds_read_b64_tr_b16 a[110:111], v225 offset:51200
    ds_read_b64_tr_b16 a[112:113], v226 offset:49152
    ds_read_b64_tr_b16 a[114:115], v226 offset:51200
    ds_read_b64_tr_b16 a[116:117], v227 offset:49152
    ds_read_b64_tr_b16 a[118:119], v227 offset:51200
    s_mov_b32 m0, s96
    s_waitcnt lgkmcnt(0)
    s_branch C_ok19
C_gv19:
    s_mov_b32 m0, s96
    s_mov_b32 s30, 0
    s_branch C_ok19
C_pg_rt:
    s_sub_u32 s30, s30, 1
    s_cbranch_scc1 C_pg_gv
    buffer_load_dwordx4 v[176:179], v196, s[4:7], s56 offen offset:0 sc1
    buffer_load_dwordx4 v[180:183], v196, s[4:7], s56 offen offset:1024 sc1
    buffer_load_dwordx4 v[184:187], v196, s[4:7], s56 offen offset:2048 sc1
    buffer_load_dwordx4 v[188:191], v196, s[4:7], s56 offen offset:3072 sc1
    s_waitcnt vmcnt(0)
    v_add_f32 v176, v176, v178
    v_add_f32 v177, v177, v179
    v_add_f32 v180, v180, v182
    v_add_f32 v181, v181, v183
    v_add_f32 v184, v184, v186
    v_add_f32 v185, v185, v187
    v_add_f32 v188, v188, v190
    v_add_f32 v189, v189, v191
    v_add_f32 v176, v176, v180
    v_add_f32 v177, v177, v181
    v_add_f32 v184, v184, v188
    v_add_f32 v185, v185, v189
    v_add_f32 v176, v176, v184
    v_add_f32 v177, v177, v185
    v_cmp_u_f32 vcc, v176, v177
    s_cbranch_vccnz C_pg_rt
    s_branch C_pg_ok
C_pg_gv:
    s_mov_b32 s30, 0
    s_branch C_pg_ok
D_rt0:
    s_sub_u32 s30, s30, 1
    s_cbranch_scc1 D_gv0
    buffer_load_dwordx4 v[8:11], v2, s[4:7], s44 offen sc1
    buffer_load_dwordx4 v[12:15], v3, s[4:7], s44 offen sc1
    buffer_load_dwordx4 v[16:19], v4, s[4:7], s44 offen sc1
    buffer_load_dwordx4 v[20:23], v5, s[4:7], s44 offen sc1
    buffer_load_dwordx4 v[24:27], v2, s[4:7], s45 offen sc1
    buffer_load_dwordx4 v[28:31], v3, s[4:7], s45 offen sc1
    buffer_load_dwordx4 v[32:35], v4, s[4:7], s45 offen sc1
    buffer_load_dwordx4 v[36:39], v5, s[4:7], s45 offen sc1
    buffer_load_dwordx4 v[40:43], v2, s[4:7], s46 offen sc1
    buffer_load_dwordx4 v[44:47], v3, s[4:7], s46 offen sc1
    buffer_load_dwordx4 v[48:51], v4, s[4:7], s46 offen sc1
    buffer_load_dwordx4 v[52:55], v5, s[4:7], s46 offen sc1
    buffer_load_dwordx4 v[56:59], v2, s[4:7], s47 offen sc1
    buffer_load_dwordx4 v[60:63], v3, s[4:7], s47 offen sc1
    buffer_load_dwordx4 v[64:67], v4, s[4:7], s47 offen sc1
    buffer_load_dwordx4 v[68:71], v5, s[4:7], s47 offen sc1
    s_waitcnt vmcnt(0)
    v_max3_u32 v6, v11, v15, v19
    v_max_u32 v6, v6, v23
    v_cmp_le_u32 vcc, 0xffff0000, v6
    s_cbranch_vccnz D_rt0
    s_branch D_ok0
D_gv0:
    s_mov_b32 s30, 0
    s_branch D_ok0
D_rt1:
    s_sub_u32 s30, s30, 1
    s_cbranch_scc1 D_gv1
    buffer_load_dwordx4 v[28:31], v3, s[4:7], s45 offen sc1
    buffer_load_dwordx4 v[32:35], v4, s[4:7], s45 offen sc1
    buffer_load_dwordx4 v[36:39], v5, s[4:7], s45 offen sc1
    buffer_load_dwordx4 v[24:27], v2, s[4:7], s45 offen sc1
    buffer_load_dwordx4 v[44:47], v3, s[4:7], s46 offen sc1
    buffer_load_dwordx4 v[48:51], v4, s[4:7], s46 offen sc1
    buffer_load_dwordx4 v[52:55], v5, s[4:7], s46 offen sc1
    buffer_load_dwordx4 v[40:43], v2, s[4:7], s46 offen sc1
    buffer_load_dwordx4 v[60:63], v3, s[4:7], s47 offen sc1
    buffer_load_dwordx4 v[64:67], v4, s[4:7], s47 offen sc1
    buffer_load_dwordx4 v[68:71], v5, s[4:7], s47 offen sc1
    buffer_load_dwordx4 v[56:59], v2, s[4:7], s47 offen sc1
    buffer_load_dwordx4 v[156:159], v3, s[4:7], s48 offen sc1
    buffer_load_dwordx4 v[160:163], v4, s[4:7], s48 offen sc1
    buffer_load_dwordx4 v[164:167], v5, s[4:7], s48 offen sc1
    buffer_load_dwordx4 v[152:155], v2, s[4:7], s48 offen sc1
    buffer_load_dwordx4 v[172:175], v3, s[4:7], s49 offen sc1
    s_waitcnt vmcnt(0)
    v_max3_u32 v6, v31, v35, v39
    v_max_u32 v6, v6, v27
    v_cmp_le_u32 vcc, 0xffff0000, v6
    s_cbranch_vccnz D_rt1
    s_branch D_ok1
D_gv1:
    s_mov_b32 s30, 0
    s_branch D_ok1
D_rt2:
    s_sub_u32 s30, s30, 1
    s_cbranch_scc1 D_gv2
    buffer_load_dwordx4 v[44:47], v3, s[4:7], s46 offen sc1
    buffer_load_dwordx4 v[48:51], v4, s[4:7], s46 offen sc1
    buffer_load_dwordx4 v[52:55], v5, s[4:7], s46 offen sc1
    buffer_load_dwordx4 v[40:43], v2, s[4:7], s46 offen sc1
    buffer_load_dwordx4 v[60:63], v3, s[4:7], s47 offen sc1
    buffer_load_dwordx4 v[64:67], v4, s[4:7], s47 offen sc1
    buffer_load_dwordx4 v[68:71], v5, s[4:7], s47 offen sc1
    buffer_load_dwordx4 v[56:59], v2, s[4:7], s47 offen sc1
    buffer_load_dwordx4 v[156:159], v3, s[4:7], s48 offen sc1
    buffer_load_dwordx4 v[160:163], v4, s[4:7], s48 offen sc1
    buffer_load_dwordx4 v[164:167], v5, s[4:7], s48 offen sc1
    buffer_load_dwordx4 v[152:155], v2, s[4:7], s48 offen sc1
    buffer_load_dwordx4 v[172:175], v3, s[4:7], s49 offen sc1
    buffer_load_dwordx4 v[176:179], v4, s[4:7], s49 offen sc1
    buffer_load_dwordx4 v[180:183], v5, s[4:7], s49 offen sc1
    buffer_load_dwordx4 v[168:171], v2, s[4:7], s49 offen sc1
    buffer_load_dwordx4 v[12:15], v3, s[4:7], s50 offen sc1
    buffer_load_dwordx4 v[16:19], v4, s[4:7], s50 offen sc1
    s_waitcnt vmcnt(0)
    v_max3_u32 v6, v47, v51, v55
    v_max_u32 v6, v6, v43
    v_cmp_le_u32 vcc, 0xffff0000, v6
    s_cbranch_vccnz D_rt2
    s_branch D_ok2
D_gv2:
    s_mov_b32 s30, 0
    s_branch D_ok2
D_rt3:
    s_sub_u32 s30, s30, 1
    s_cbranch_scc1 D_gv3
    buffer_load_dwordx4 v[60:63], v3, s[4:7], s47 offen sc1
    buffer_load_dwordx4 v[64:67], v4, s[4:7], s47 offen sc1
    buffer_load_dwordx4 v[68:71], v5, s[4:7], s47 offen sc1
    buffer_load_dwordx4 v[56:59], v2, s[4:7], s47 offen sc1
    buffer_load_dwordx4 v[156:159], v3, s[4:7], s48 offen sc1
    buffer_load_dwordx4 v[160:163], v4, s[4:7], s48 offen sc1
    buffer_load_dwordx4 v[164:167], v5, s[4:7], s48 offen sc1
    buffer_load_dwordx4 v[152:155], v2, s[4:7], s48 offen sc1
    buffer_load_dwordx4 v[172:175], v3, s[4:7], s49 offen sc1
    buffer_load_dwordx4 v[176:179], v4, s[4:7], s49 offen sc1
    buffer_load_dwordx4 v[180:183], v5, s[4:7], s49 offen sc1
    buffer_load_dwordx4 v[168:171], v2, s[4:7], s49 offen sc1
    buffer_load_dwordx4 v[12:15], v3, s[4:7], s50 offen sc1
    buffer_load_dwordx4 v[16:19], v4, s[4:7], s50 offen sc1
    buffer_load_dwordx4 v[20:23], v5, s[4:7], s50 offen sc1
    buffer_load_dwordx4 v[8:11], v2, s[4:7], s50 offen sc1
    buffer_load_dwordx4 v[28:31], v3, s[4:7], s51 offen sc1
    buffer_load_dwordx4 v[32:35], v4, s[4:7], s51 offen sc1
    buffer_load_dwordx4 v[36:39], v5, s[4:7], s51 offen sc1
    s_waitcnt vmcnt(0)
    v_max3_u32 v6, v63, v67, v71
    v_max_u32 v6, v6, v59
    v_cmp_le_u32 vcc, 0xffff0000, v6
    s_cbranch_vccnz D_rt3
    s_branch D_ok3
D_gv3:
    s_mov_b32 s30, 0
    s_branch D_ok3
D_rt4:
    s_sub_u32 s30, s30, 1
    s_cbranch_scc1 D_gv4
    buffer_load_dwordx4 v[156:159], v3, s[4:7], s48 offen sc1
    buffer_load_dwordx4 v[160:163], v4, s[4:7], s48 offen sc1
    buffer_load_dwordx4 v[164:167], v5, s[4:7], s48 offen sc1
    buffer_load_dwordx4 v[152:155], v2, s[4:7], s48 offen sc1
    buffer_load_dwordx4 v[172:175], v3, s[4:7], s49 offen sc1
    buffer_load_dwordx4 v[176:179], v4, s[4:7], s49 offen sc1
    buffer_load_dwordx4 v[180:183], v5, s[4:7], s49 offen sc1
    buffer_load_dwordx4 v[168:171], v2, s[4:7], s49 offen sc1
    buffer_load_dwordx4 v[12:15], v3, s[4:7], s50 offen sc1
    buffer_load_dwordx4 v[16:19], v4, s[4:7], s50 offen sc1
    buffer_load_dwordx4 v[20:23], v5, s[4:7], s50 offen sc1
    buffer_load_dwordx4 v[8:11], v2, s[4:7], s50 offen sc1
    buffer_load_dwordx4 v[28:31], v3, s[4:7], s51 offen sc1
    buffer_load_dwordx4 v[32:35], v4, s[4:7], s51 offen sc1
    buffer_load_dwordx4 v[36:39], v5, s[4:7], s51 offen sc1
    buffer_load_dwordx4 v[24:27], v2, s[4:7], s51 offen sc1
    buffer_load_dwordx4 v[44:47], v3, s[4:7], s52 offen sc1
    buffer_load_dwordx4 v[48:51], v4, s[4:7], s52 offen sc1
    buffer_load_dwordx4 v[52:55], v5, s[4:7], s52 offen sc1
    buffer_load_dwordx4 v[40:43], v2, s[4:7], s52 offen sc1
    s_waitcnt vmcnt(0)
    v_max3_u32 v6, v159, v163, v167
    v_max_u32 v6, v6, v155
    v_cmp_le_u32 vcc, 0xffff0000, v6
    s_cbranch_vccnz D_rt4
    s_branch D_ok4
D_gv4:
    s_mov_b32 s30, 0
    s_branch D_ok4
D_rt5:
    s_sub_u32 s30, s30, 1
    s_cbranch_scc1 D_gv5
    buffer_load_dwordx4 v[172:175], v3, s[4:7], s49 offen sc1
    buffer_load_dwordx4 v[176:179], v4, s[4:7], s49 offen sc1
    buffer_load_dwordx4 v[180:183], v5, s[4:7], s49 offen sc1
    buffer_load_dwordx4 v[168:171], v2, s[4:7], s49 offen sc1
    buffer_load_dwordx4 v[12:15], v3, s[4:7], s50 offen sc1
    buffer_load_dwordx4 v[16:19], v4, s[4:7], s50 offen sc1
    buffer_load_dwordx4 v[20:23], v5, s[4:7], s50 offen sc1
    buffer_load_dwordx4 v[8:11], v2, s[4:7], s50 offen sc1
    buffer_load_dwordx4 v[28:31], v3, s[4:7], s51 offen sc1
    buffer_load_dwordx4 v[32:35], v4, s[4:7], s51 offen sc1
    buffer_load_dwordx4 v[36:39], v5, s[4:7], s51 offen sc1
    buffer_load_dwordx4 v[24:27], v2, s[4:7], s51 offen sc1
    buffer_load_dwordx4 v[44:47], v3, s[4:7], s52 offen sc1
    buffer_load_dwordx4 v[48:51], v4, s[4:7], s52 offen sc1
    buffer_load_dwordx4 v[52:55], v5, s[4:7], s52 offen sc1
    buffer_load_dwordx4 v[40:43], v2, s[4:7], s52 offen sc1
    buffer_load_dwordx4 v[60:63], v3, s[4:7], s53 offen sc1
    buffer_load_dwordx4 v[64:67], v4, s[4:7], s53 offen sc1
    buffer_load_dwordx4 v[68:71], v5, s[4:7], s53 offen sc1
    buffer_load_dwordx4 v[56:59], v2, s[4:7], s53 offen sc1
    s_waitcnt vmcnt(0)
    v_max3_u32 v6, v175, v179, v183
    v_max_u32 v6, v6, v171
    v_cmp_le_u32 vcc, 0xffff0000, v6
    s_cbranch_vccnz D_rt5
    s_branch D_ok5
D_gv5:
    s_mov_b32 s30, 0
    s_branch D_ok5
D_rt6:
    s_sub_u32 s30, s30, 1
    s_cbranch_scc1 D_gv6
    buffer_load_dwordx4 v[12:15], v3, s[4:7], s50 offen sc1
    buffer_load_dwordx4 v[16:19], v4, s[4:7], s50 offen sc1
    buffer_load_dwordx4 v[20:23], v5, s[4:7], s50 offen sc1
    buffer_load_dwordx4 v[8:11], v2, s[4:7], s50 offen sc1
    buffer_load_dwordx4 v[28:31], v3, s[4:7], s51 offen sc1
    buffer_load_dwordx4 v[32:35], v4, s[4:7], s51 offen sc1
    buffer_load_dwordx4 v[36:39], v5, s[4:7], s51 offen sc1
    buffer_load_dwordx4 v[24:27], v2, s[4:7], s51 offen sc1
    buffer_load_dwordx4 v[44:47], v3, s[4:7], s52 offen sc1
    buffer_load_dwordx4 v[48:51], v4, s[4:7], s52 offen sc1
    buffer_load_dwordx4 v[52:55], v5, s[4:7], s52 offen sc1
    buffer_load_dwordx4 v[40:43], v2, s[4:7], s52 offen sc1
    buffer_load_dwordx4 v[60:63], v3, s[4:7], s53 offen sc1
    buffer_load_dwordx4 v[64:67], v4, s[4:7], s53 offen sc1
    buffer_load_dwordx4 v[68:71], v5, s[4:7], s53 offen sc1
    buffer_load_dwordx4 v[56:59], v2, s[4:7], s53 offen sc1
    buffer_load_dwordx4 v[156:159], v3, s[4:7], s54 offen sc1
    s_waitcnt vmcnt(0)
    v_max3_u32 v6, v15, v19, v23
    v_max_u32 v6, v6, v11
    v_cmp_le_u32 vcc, 0xffff0000, v6
    s_cbranch_vccnz D_rt6
    s_branch D_ok6
D_gv6:
    s_mov_b32 s30, 0
    s_branch D_ok6
D_rt7:
    s_sub_u32 s30, s30, 1
    s_cbranch_scc1 D_gv7
    buffer_load_dwordx4 v[28:31], v3, s[4:7], s51 offen sc1
    buffer_load_dwordx4 v[32:35], v4, s[4:7], s51 offen sc1
    buffer_load_dwordx4 v[36:39], v5, s[4:7], s51 offen sc1
    buffer_load_dwordx4 v[24:27], v2, s[4:7], s51 offen sc1
    buffer_load_dwordx4 v[44:47], v3, s[4:7], s52 offen sc1
    buffer_load_dwordx4 v[48:51], v4, s[4:7], s52 offen sc1
    buffer_load_dwordx4 v[52:55], v5, s[4:7], s52 offen sc1
    buffer_load_dwordx4 v[40:43], v2, s[4:7], s52 offen sc1
    buffer_load_dwordx4 v[60:63], v3, s[4:7], s53 offen sc1
    buffer_load_dwordx4 v[64:67], v4, s[4:7], s53 offen sc1
    buffer_load_dwordx4 v[68:71], v5, s[4:7], s53 offen sc1
    buffer_load_dwordx4 v[56:59], v2, s[4:7], s53 offen sc1
    buffer_load_dwordx4 v[156:159], v3, s[4:7], s54 offen sc1
    buffer_load_dwordx4 v[160:163], v4, s[4:7], s54 offen sc1
    buffer_load_dwordx4 v[164:167], v5, s[4:7], s54 offen sc1
    buffer_load_dwordx4 v[152:155], v2, s[4:7], s54 offen sc1
    buffer_load_dwordx4 v[172:175], v3, s[4:7], s55 offen sc1
    buffer_load_dwordx4 v[12:15], v3, s[4:7], s56 offen sc1
    s_waitcnt vmcnt(0)
    v_max3_u32 v6, v31, v35, v39
    v_max_u32 v6, v6, v27
    v_cmp_le_u32 vcc, 0xffff0000, v6
    s_cbranch_vccnz D_rt7
    s_branch D_ok7
D_gv7:
    s_mov_b32 s30, 0
    s_branch D_ok7
D_rt8:
    s_sub_u32 s30, s30, 1
    s_cbranch_scc1 D_gv8
    buffer_load_dwordx4 v[44:47], v3, s[4:7], s52 offen sc1
    buffer_load_dwordx4 v[48:51], v4, s[4:7], s52 offen sc1
    buffer_load_dwordx4 v[52:55], v5, s[4:7], s52 offen sc1
    buffer_load_dwordx4 v[40:43], v2, s[4:7], s52 offen sc1
    buffer_load_dwordx4 v[60:63], v3, s[4:7], s53 offen sc1
    buffer_load_dwordx4 v[64:67], v4, s[4:7], s53 offen sc1
    buffer_load_dwordx4 v[68:71], v5, s[4:7], s53 offen sc1
    buffer_load_dwordx4 v[56:59], v2, s[4:7], s53 offen sc1
    buffer_load_dwordx4 v[156:159], v3, s[4:7], s54 offen sc1
    buffer_load_dwordx4 v[160:163], v4, s[4:7], s54 offen sc1
    buffer_load_dwordx4 v[164:167], v5, s[4:7], s54 offen sc1
    buffer_load_dwordx4 v[152:155], v2, s[4:7], s54 offen sc1
    buffer_load_dwordx4 v[172:175], v3, s[4:7], s55 offen sc1
    buffer_load_dwordx4 v[12:15], v3, s[4:7], s56 offen sc1
    buffer_load_dwordx4 v[28:31], v3, s[4:7], s57 offen sc1
    buffer_load_dwordx4 v[176:179], v4, s[4:7], s55 offen sc1
    s_waitcnt vmcnt(0)
    v_max3_u32 v6, v47, v51, v55
    v_max_u32 v6, v6, v43
    v_cmp_le_u32 vcc, 0xffff0000, v6
    s_cbranch_vccnz D_rt8
    s_branch D_ok8
D_gv8:
    s_mov_b32 s30, 0
    s_branch D_ok8
D_rt9:
    s_sub_u32 s30, s30, 1
    s_cbranch_scc1 D_gv9
    buffer_load_dwordx4 v[60:63], v3, s[4:7], s53 offen sc1
    buffer_load_dwordx4 v[64:67], v4, s[4:7], s53 offen sc1
    buffer_load_dwordx4 v[68:71], v5, s[4:7], s53 offen sc1
    buffer_load_dwordx4 v[56:59], v2, s[4:7], s53 offen sc1
    buffer_load_dwordx4 v[156:159], v3, s[4:7], s54 offen sc1
    buffer_load_dwordx4 v[160:163], v4, s[4:7], s54 offen sc1
    buffer_load_dwordx4 v[164:167], v5, s[4:7], s54 offen sc1
    buffer_load_dwordx4 v[152:155], v2, s[4:7], s54 offen sc1
    buffer_load_dwordx4 v[172:175], v3, s[4:7], s55 offen sc1
    buffer_load_dwordx4 v[12:15], v3, s[4:7], s56 offen sc1
    buffer_load_dwordx4 v[28:31], v3, s[4:7], s57 offen sc1
    buffer_load_dwordx4 v[176:179], v4, s[4:7], s55 offen sc1
    buffer_load_dwordx4 v[16:19], v4, s[4:7], s56 offen sc1
    buffer_load_dwordx4 v[32:35], v4, s[4:7], s57 offen sc1
    s_waitcnt vmcnt(0)
    v_max3_u32 v6, v63, v67, v71
    v_max_u32 v6, v6, v59
    v_cmp_le_u32 vcc, 0xffff0000, v6
    s_cbranch_vccnz D_rt9
    s_branch D_ok9
D_gv9:
    s_mov_b32 s30, 0
    s_branch D_ok9
D_rt10:
    s_sub_u32 s30, s30, 1
    s_cbranch_scc1 D_gv10
    buffer_load_dwordx4 v[156:159], v3, s[4:7], s54 offen sc1
    buffer_load_dwordx4 v[160:163], v4, s[4:7], s54 offen sc1
    buffer_load_dwordx4 v[164:167], v5, s[4:7], s54 offen sc1
    buffer_load_dwordx4 v[152:155], v2, s[4:7], s54 offen sc1
    buffer_load_dwordx4 v[172:175], v3, s[4:7], s55 offen sc1
    buffer_load_dwordx4 v[12:15], v3, s[4:7], s56 offen sc1
    buffer_load_dwordx4 v[28:31], v3, s[4:7], s57 offen sc1
    buffer_load_dwordx4 v[176:179], v4, s[4:7], s55 offen sc1
    buffer_load_dwordx4 v[16:19], v4, s[4:7], s56 offen sc1
    buffer_load_dwordx4 v[32:35], v4, s[4:7], s57 offen sc1
    buffer_load_dwordx4 v[180:183], v5, s[4:7], s55 offen sc1
    buffer_load_dwordx4 v[20:23], v5, s[4:7], s56 offen sc1
    s_waitcnt vmcnt(0)
    v_max3_u32 v6, v159, v163, v167
    v_max_u32 v6, v6, v155
    v_cmp_le_u32 vcc, 0xffff0000, v6
    s_cbranch_vccnz D_rt10
    s_branch D_ok10
D_gv10:
    s_mov_b32 s30, 0
    s_branch D_ok10
D_rt11:
    s_sub_u32 s30, s30, 1
    s_cbranch_scc1 D_gv11
    buffer_load_dwordx4 v[172:175], v3, s[4:7], s55 offen sc1
    buffer_load_dwordx4 v[12:15], v3, s[4:7], s56 offen sc1
    buffer_load_dwordx4 v[28:31], v3, s[4:7], s57 offen sc1
    buffer_load_dwordx4 v[176:179], v4, s[4:7], s55 offen sc1
    buffer_load_dwordx4 v[16:19], v4, s[4:7], s56 offen sc1
    buffer_load_dwordx4 v[32:35], v4, s[4:7], s57 offen sc1
    buffer_load_dwordx4 v[180:183], v5, s[4:7], s55 offen sc1
    buffer_load_dwordx4 v[20:23], v5, s[4:7], s56 offen sc1
    buffer_load_dwordx4 v[36:39], v5, s[4:7], s57 offen sc1
    buffer_load_dwordx4 v[168:171], v2, s[4:7], s55 offen sc1
    buffer_load_dwordx4 v[8:11], v2, s[4:7], s56 offen sc1
    buffer_load_dwordx4 v[24:27], v2, s[4:7], s57 offen sc1
    s_waitcnt vmcnt(0)
    v_max3_u32 v6, v175, v15, v31
    v_cmp_le_u32 vcc, 0xffff0000, v6
    s_cbranch_vccnz D_rt11
    s_branch D_ok11
D_gv11:
    s_mov_b32 s30, 0
    s_branch D_ok11
D_rt12:
    s_sub_u32 s30, s30, 1
    s_cbranch_scc1 D_gv12
    buffer_load_dwordx4 v[176:179], v4, s[4:7], s55 offen sc1
    buffer_load_dwordx4 v[16:19], v4, s[4:7], s56 offen sc1
    buffer_load_dwordx4 v[32:35], v4, s[4:7], s57 offen sc1
    buffer_load_dwordx4 v[180:183], v5, s[4:7], s55 offen sc1
    buffer_load_dwordx4 v[20:23], v5, s[4:7], s56 offen sc1
    buffer_load_dwordx4 v[36:39], v5, s[4:7], s57 offen sc1
    buffer_load_dwordx4 v[168:171], v2, s[4:7], s55 offen sc1
    buffer_load_dwordx4 v[8:11], v2, s[4:7], s56 offen sc1
    buffer_load_dwordx4 v[24:27], v2, s[4:7], s57 offen sc1
    s_waitcnt vmcnt(0)
    v_max3_u32 v6, v179, v19, v35
    v_cmp_le_u32 vcc, 0xffff0000, v6
    s_cbranch_vccnz D_rt12
    s_branch D_ok12
D_gv12:
    s_mov_b32 s30, 0
    s_branch D_ok12
D_rt13:
    s_sub_u32 s30, s30, 1
    s_cbranch_scc1 D_gv13
    buffer_load_dwordx4 v[180:183], v5, s[4:7], s55 offen sc1
    buffer_load_dwordx4 v[20:23], v5, s[4:7], s56 offen sc1
    buffer_load_dwordx4 v[36:39], v5, s[4:7], s57 offen sc1
    buffer_load_dwordx4 v[168:171], v2, s[4:7], s55 offen sc1
    buffer_load_dwordx4 v[8:11], v2, s[4:7], s56 offen sc1
    buffer_load_dwordx4 v[24:27], v2, s[4:7], s57 offen sc1
    s_waitcnt vmcnt(0)
    v_max3_u32 v6, v183, v23, v39
    v_cmp_le_u32 vcc, 0xffff0000, v6
    s_cbranch_vccnz D_rt13
    s_branch D_ok13
D_gv13:
    s_mov_b32 s30, 0
    s_branch D_ok13
D_rt14:
    s_sub_u32 s30, s30, 1
    s_cbranch_scc1 D_gv14
    buffer_load_dwordx4 v[168:171], v2, s[4:7], s55 offen sc1
    buffer_load_dwordx4 v[8:11], v2, s[4:7], s56 offen sc1
    buffer_load_dwordx4 v[24:27], v2, s[4:7], s57 offen sc1
    s_waitcnt vmcnt(0)
    v_max3_u32 v6, v171, v11, v27
    v_cmp_le_u32 vcc, 0xffff0000, v6
    s_cbranch_vccnz D_rt14
    s_branch D_ok14
D_gv14:
    s_mov_b32 s30, 0
    s_branch D_ok14
code_end:
.section .rodata,"a"
.p2align 6
.amdhsa_kernel sequential_preLN__ssm_conv_s4__geglu_ffn__prompt_kernel
  .amdhsa_next_free_vgpr 512
  .amdhsa_next_free_sgpr 102
  .amdhsa_accum_offset 256
  .amdhsa_group_segment_fixed_size 0
  .amdhsa_kernarg_size 128
  .amdhsa_user_sgpr_count 2
  .amdhsa_user_sgpr_kernarg_segment_ptr 1
  .amdhsa_system_sgpr_workgroup_id_x 1
.end_amdhsa_kernel
```
